```python
import torch

def _softmax(x, axis=-1):
    return torch.softmax(x, dim=axis)
def _gelu(x):
    return torch.nn.functional.gelu(x, approximate="tanh")
def _silu(x):
    return torch.nn.functional.silu(x)
def _sigmoid(x):
    return torch.sigmoid(x)
def _layernorm(x, axis=-1, eps=1e-5):
    m = x.mean(dim=axis, keepdim=True)
    v = x.var(dim=axis, keepdim=True, unbiased=False)
    return (x - m) / torch.sqrt(v + eps)
def _scatter_add(tgt, idx, src, axis=0):
    return tgt.clone().index_add_(axis, idx, src)
def _segment_sum(src, seg, n):
    out = torch.zeros((n,) + src.shape[1:], dtype=src.dtype)
    return out.index_add_(0, seg, src)
def _pad(x, pw):
    flat = tuple(v for pair in reversed(pw) for v in pair)
    return torch.nn.functional.pad(x, flat)

kernel_name = 'gated_mix__linear_kernel_hedgehog__dense_activation_gelu__prompt'

def setup_inputs():

    _w = (lambda a: (lambda t: t.to(torch.bfloat16) if t.is_floating_point() else t)(torch.as_tensor(a)))
    def _A_setup():
        B, S, D, H = 1, 2048, 640, 32
        Dh = D // H
        return {
            "x": _w((lambda *s: torch.randn(*s, dtype=torch.bfloat16) * 0.05)(B, S, D)),
            "wqkv": _w((lambda *s: torch.randn(*s, dtype=torch.bfloat16) * 0.8)(D, 3 * D)),
            "w_phi": _w((lambda *s: torch.randn(*s, dtype=torch.bfloat16) * 0.8)(H, Dh, Dh) * (Dh ** -0.5)),
            "wo": _w((lambda *s: torch.randn(*s, dtype=torch.bfloat16) * 0.05)(D, D)),
        }
    _A_in = _A_setup()

    def _B_setup():
        B, S, D, F = 1, 2048, 640, 1728
        return {
            "x": _w((lambda *s: torch.randn(*s, dtype=torch.bfloat16) * 0.05)(B, S, D)),
            "w1": _w((lambda *s: torch.randn(*s, dtype=torch.bfloat16) * 3.2)(D, F) * (D ** -0.5)),
            "b1": _w((lambda *s: torch.randn(*s, dtype=torch.bfloat16) * 3.2)(F) * 0.01),
            "w2": _w((lambda *s: torch.randn(*s, dtype=torch.bfloat16) * 0.4)(F, D) * (F ** -0.5)),
            "b2": _w((lambda *s: torch.randn(*s, dtype=torch.bfloat16) * 0.8)(D) * 0.01),
        }
    _B_in = _B_setup()

    return {
        "A_x": _A_in["x"],
        "A_wqkv": _A_in["wqkv"],
        "A_w_phi": _A_in["w_phi"],
        "A_wo": _A_in["wo"],
        "B_x": _B_in["x"],
        "B_w1": _B_in["w1"],
        "B_b1": _B_in["b1"],
        "B_w2": _B_in["w2"],
        "B_b2": _B_in["b2"],
        "gate_w": _w((lambda *s: torch.randn(*s, dtype=torch.bfloat16) * 0.05)(640) * 16.0),
    }

def reference(A_x, A_wqkv, A_w_phi, A_wo, B_x, B_w1, B_b1, B_w2, B_b2, gate_w):
    def _A_ref(x, wqkv, w_phi, wo):
        B, S, D = x.shape
        H = 32; Dh = D // H
        qkv = (lambda x, *d: x.permute(*d))((x @ wqkv).reshape(B, S, 3, H, Dh), 2, 0, 3, 1, 4)
        q, k, v = qkv[0], qkv[1], qkv[2]
        pq = torch.einsum("bhsd,hdf->bhsf", q, w_phi)
        pk = torch.einsum("bhsd,hdf->bhsf", k, w_phi)
        phi_q = torch.concatenate([_softmax(pq, axis=-1), _softmax(-pq, axis=-1)], axis=-1)
        phi_k = torch.concatenate([_softmax(pk, axis=-1), _softmax(-pk, axis=-1)], axis=-1)
        kv = torch.einsum("bhsf,bhsd->bhfd", phi_k, v)
        z  = torch.einsum("bhsf->bhf", phi_k)
        num = torch.einsum("bhqf,bhfd->bhqd", phi_q, kv)
        den = torch.einsum("bhqf,bhf->bhq", phi_q, z)[..., None] + 1e-6
        o = num / den
        return (lambda x, *d: x.permute(*d))(o, 0, 2, 1, 3).reshape(B, S, D) @ wo

    def _B_ref(x, w1, b1, w2, b2):
        h = torch.einsum("bsd,df->bsf", x, w1) + b1
        h = _gelu(h)
        return torch.einsum("bsf,fd->bsd", h, w2) + b2

    x = A_x
    g = _sigmoid((x * gate_w).sum(-1, keepdims=True))
    a = _A_ref(x, A_wqkv, A_w_phi, A_wo)
    b = _B_ref(x, B_w1, B_b1, B_w2, B_b2)
    return g * a + (1 - g) * b
```

```asm
; @launch grid=(256,1,1) block=(512,1,1) lds=163840
.amdgcn_target "amdgcn-amd-amdhsa--gfx950"
.text
.globl gated_mix__linear_kernel_hedgehog__dense_activation_gelu__prompt_kernel
.p2align 8
.type gated_mix__linear_kernel_hedgehog__dense_activation_gelu__prompt_kernel,@function
gated_mix__linear_kernel_hedgehog__dense_activation_gelu__prompt_kernel:
s_cmp_ge_u32 s2, 256
s_cbranch_scc1 L_end
s_load_dwordx16 s[16:31], s[0:1], 0
s_load_dwordx8 s[32:39], s[0:1], 64
s_load_dwordx2 s[40:41], s[0:1], 96
v_lshrrev_b32 v1, 6, v0
v_and_b32 v0, 63, v0
s_and_b32 s70, s2, 7
s_lshr_b32 s71, s2, 3
v_readfirstlane_b32 s63, v1
s_and_b32 s72, s70, 1
s_and_b32 s73, s71, 7
s_lshl_b32 s74, s72, 3
s_add_u32 s60, s74, s73
s_lshr_b32 s62, s71, 4
s_lshr_b32 s74, s70, 1
s_lshr_b32 s75, s71, 3
s_and_b32 s76, s75, 1
s_lshl_b32 s77, s74, 1
s_add_u32 s61, s76, s77
s_mul_i32 s76, s73, 10
s_mul_i32 s77, s75, 20
s_add_u32 s76, s76, s77
s_mul_i32 s77, s74, 10
s_add_u32 s76, s76, s77
s_mul_i32 s77, s72, 5
s_add_u32 s76, s76, s77
s_lshr_b32 s76, s76, 3
s_mul_i32 s77, s76, 6554
s_lshr_b32 s77, s77, 16
s_mul_i32 s77, s77, 10
s_sub_u32 s64, s76, s77
s_and_b32 s65, s63, 3
s_cmp_ge_u32 s63, 4
s_cbranch_scc1 L_M
s_getpc_b64 s[76:77]
L_pc:
s_sub_u32 s76, s76, L_pc-gated_mix__linear_kernel_hedgehog__dense_activation_gelu__prompt_kernel
s_subb_u32 s77, s77, 0
s_lshl_b32 s78, s71, 2
s_add_u32 s78, s78, s65
s_lshl_b32 s78, s78, 9
v_and_b32 v6, 3, v0
v_lshl_add_u32 v6, v6, 7, s78
s_mov_b32 s78, L_end-gated_mix__linear_kernel_hedgehog__dense_activation_gelu__prompt_kernel
v_min_u32 v6, s78, v6
s_mov_b64 exec, 15
global_load_dword v187, v6, s[76:77]
s_mov_b64 exec, -1
v_lshrrev_b32 v2, 3, v0
s_lshl_b32 s76, s65, 4
v_add_u32 v2, s76, v2
v_lshrrev_b32 v3, 4, v0
v_xor_b32 v3, v3, v0
v_and_b32 v3, 7, v3
v_lshlrev_b32 v3, 4, v3
v_mul_u32_u24 v2, 1280, v2
v_add_u32 v128, v2, v3
v_xor_b32 v3, 64, v3
v_add_u32 v2, 9216, v2
v_add_u32 v129, v2, v3
s_mul_i32 s4, s60, 163840
s_lshl_b32 s5, s65, 11
s_add_u32 s5, s5, 81920
s_lshl_b32 s69, s64, 7
s_lshl_b32 s78, s61, 7
s_mul_i32 s77, s61, 320
s_add_u32 s77, s77, 1024
s_cmp_eq_u32 s62, 1
s_cselect_b32 s78, s77, s78
v_lshlrev_b32 v132, 4, v0
s_mov_b32 m0, 163328
s_waitcnt lgkmcnt(0)
s_mov_b32 s52, s28
s_mov_b32 s53, s29
s_mov_b32 s54, 3456
s_mov_b32 s55, 0x20000
s_mov_b32 s44, s16
s_mov_b32 s45, s17
s_mov_b32 s46, 2621440
s_mov_b32 s47, 0x20000
s_mov_b64 exec, 0xfffff
buffer_load_dwordx4 v132, s[52:55], s78 offen lds
s_mov_b64 exec, -1
s_add_u32 s76, s69, 0
s_add_u32 m0, s5, 0
s_add_u32 s76, s76, s4
buffer_load_dwordx4 v128, s[44:47], s76 offen lds
buffer_load_dwordx4 v129, s[44:47], s76 offen offset:1024 lds
s_add_u32 s76, s69, 81920
s_add_u32 m0, s5, 8192
s_add_u32 s76, s76, s4
buffer_load_dwordx4 v128, s[44:47], s76 offen lds
buffer_load_dwordx4 v129, s[44:47], s76 offen offset:1024 lds
s_add_u32 s69, s69, 128
s_cmp_eq_u32 s69, 1280
s_cmov_b32 s69, 0
s_branch L_C
L_M:
s_setprio 3
s_lshl_b32 s6, s65, 12
s_lshl_b32 s68, s64, 1
s_lshr_b32 s76, s65, 1
s_lshl_b32 s76, s76, 4
s_and_b32 s77, s65, 1
s_lshl_b32 s77, s77, 2
s_add_u32 s78, s76, s77
s_cmp_eq_u32 s62, 1
s_cbranch_scc1 L_MQ
s_mul_i32 s76, s61, 160
s_add_u32 s76, s76, 1280
v_add_u32 v2, 0, v0
v_mul_u32_u24 v3, 6554, v2
v_lshrrev_b32 v3, 16, v3
v_mul_u32_u24 v4, 10, v3
v_sub_u32 v4, v2, v4
v_lshrrev_b32 v6, 3, v3
v_and_b32 v3, 7, v3
v_mul_u32_u24 v6, 1280, v6
v_lshl_add_u32 v4, v4, 4, v6
v_and_b32 v5, 4, v3
v_add3_u32 v5, v5, v3, s78
v_mul_u32_u24 v5, 3840, v5
v_add3_u32 v8, v5, v4, s76
v_add_u32 v2, 64, v0
v_mul_u32_u24 v3, 6554, v2
v_lshrrev_b32 v3, 16, v3
v_mul_u32_u24 v4, 10, v3
v_sub_u32 v4, v2, v4
v_lshrrev_b32 v6, 3, v3
v_and_b32 v3, 7, v3
v_mul_u32_u24 v6, 1280, v6
v_lshl_add_u32 v4, v4, 4, v6
v_and_b32 v5, 4, v3
v_add3_u32 v5, v5, v3, s78
v_mul_u32_u24 v5, 3840, v5
v_add3_u32 v46, v5, v4, s76
v_add_u32 v2, 128, v0
v_mul_u32_u24 v3, 6554, v2
v_lshrrev_b32 v3, 16, v3
v_mul_u32_u24 v4, 10, v3
v_sub_u32 v4, v2, v4
v_lshrrev_b32 v6, 3, v3
v_and_b32 v3, 7, v3
v_mul_u32_u24 v6, 1280, v6
v_lshl_add_u32 v4, v4, 4, v6
v_and_b32 v5, 4, v3
v_add3_u32 v5, v5, v3, s78
v_mul_u32_u24 v5, 3840, v5
v_add3_u32 v10, v5, v4, s76
v_lshrrev_b32 v3, 3, v0
v_and_b32 v4, 6, v3
v_xor_b32 v4, v4, v0
v_and_b32 v4, 7, v4
v_lshlrev_b32 v4, 4, v4
s_lshl_b32 s76, s61, 7
v_and_b32 v5, 4, v3
v_add3_u32 v5, v5, v3, s78
v_mul_u32_u24 v5, 3456, v5
v_add3_u32 v11, v5, v4, s76
v_subrev_u32 v2, 32, v0
v_min_u32 v2, 3, v2
v_lshlrev_b32 v2, 4, v2
v_cmp_gt_u32 s[14:15], 32, v0
v_mov_b32 v26, 122880
v_mov_b32 v27, 122880
v_mov_b32 v29, 110592
v_cndmask_b32 v10, v2, v10, s[14:15]
v_cndmask_b32 v28, 64, v26, s[14:15]
s_waitcnt lgkmcnt(0)
v_mov_b32 v7, 0
v_add_co_u32 v18, vcc, s18, v8
v_mov_b32 v6, s19
s_nop 0
v_addc_co_u32 v19, vcc, v6, v7, vcc
v_subrev_u32 v46, 1024, v46
v_ashrrev_i32 v7, 31, v46
v_add_co_u32 v20, vcc, s18, v46
v_mov_b32 v6, s19
s_nop 0
v_addc_co_u32 v21, vcc, v6, v7, vcc
v_subrev_u32 v11, 3072, v11
v_ashrrev_i32 v7, 31, v11
v_add_co_u32 v24, vcc, s26, v11
v_mov_b32 v6, s27
s_nop 0
v_addc_co_u32 v25, vcc, v6, v7, vcc
v_mov_b32 v2, s34
v_mov_b32 v3, s18
v_cndmask_b32 v2, v2, v3, s[14:15]
v_mov_b32 v3, s35
v_mov_b32 v4, s19
v_cndmask_b32 v3, v3, v4, s[14:15]
v_subrev_u32 v10, 2048, v10
v_ashrrev_i32 v7, 31, v10
v_add_co_u32 v22, vcc, v2, v10
s_nop 1
v_addc_co_u32 v23, vcc, v3, v7, vcc
s_branch L_Mgo
L_MQ:
s_mul_i32 s79, s61, 160
s_mul_i32 s76, s61, 320
s_add_u32 s76, s76, 1024
s_cmp_eq_u32 s61, 7
s_cselect_b32 s77, 11, 19
v_add_u32 v2, 0, v0
v_mul_u32_u24 v3, 6554, v2
v_lshrrev_b32 v3, 16, v3
v_mul_u32_u24 v4, 10, v3
v_sub_u32 v4, v2, v4
v_lshlrev_b32 v4, 4, v4
v_and_b32 v5, 4, v3
v_add3_u32 v5, v5, v3, s78
v_mul_u32_u24 v5, 3840, v5
v_add3_u32 v8, v5, v4, s79
v_add_u32 v2, 64, v0
v_mul_u32_u24 v3, 6554, v2
v_lshrrev_b32 v3, 16, v3
v_mul_u32_u24 v4, 10, v3
v_sub_u32 v4, v2, v4
v_lshlrev_b32 v4, 4, v4
v_and_b32 v5, 4, v3
v_add3_u32 v5, v5, v3, s78
v_mul_u32_u24 v5, 3840, v5
v_add3_u32 v46, v5, v4, s79
v_add_u32 v2, -16, v0
v_min_i32 v2, 159, v2
v_max_i32 v2, 0, v2
v_mul_u32_u24 v3, 3277, v2
v_lshrrev_b32 v3, 16, v3
v_mul_u32_u24 v4, 20, v3
v_sub_u32 v4, v2, v4
v_lshrrev_b32 v6, 1, v3
v_and_b32 v6, 2, v6
v_xor_b32 v4, v4, v6
v_min_u32 v4, s77, v4
v_lshlrev_b32 v4, 4, v4
v_and_b32 v5, 4, v3
v_add3_u32 v5, v5, v3, s78
v_mul_u32_u24 v5, 3456, v5
v_add3_u32 v12, v5, v4, s76
v_add_u32 v2, 48, v0
v_min_i32 v2, 159, v2
v_max_i32 v2, 0, v2
v_mul_u32_u24 v3, 3277, v2
v_lshrrev_b32 v3, 16, v3
v_mul_u32_u24 v4, 20, v3
v_sub_u32 v4, v2, v4
v_lshrrev_b32 v6, 1, v3
v_and_b32 v6, 2, v6
v_xor_b32 v4, v4, v6
v_min_u32 v4, s77, v4
v_lshlrev_b32 v4, 4, v4
v_and_b32 v5, 4, v3
v_add3_u32 v5, v5, v3, s78
v_mul_u32_u24 v5, 3456, v5
v_add3_u32 v10, v5, v4, s76
v_add_u32 v2, 112, v0
v_min_i32 v2, 159, v2
v_max_i32 v2, 0, v2
v_mul_u32_u24 v3, 3277, v2
v_lshrrev_b32 v3, 16, v3
v_mul_u32_u24 v4, 20, v3
v_sub_u32 v4, v2, v4
v_lshrrev_b32 v6, 1, v3
v_and_b32 v6, 2, v6
v_xor_b32 v4, v4, v6
v_min_u32 v4, s77, v4
v_lshlrev_b32 v4, 4, v4
v_and_b32 v5, 4, v3
v_add3_u32 v5, v5, v3, s78
v_mul_u32_u24 v5, 3456, v5
v_add3_u32 v11, v5, v4, s76
v_cmp_gt_u32 s[14:15], 16, v0
v_mov_b32 v26, 122880
v_mov_b32 v28, 110592
v_mov_b32 v29, 110592
v_cndmask_b32 v46, v12, v46, s[14:15]
v_cndmask_b32 v27, v28, v26, s[14:15]
s_waitcnt lgkmcnt(0)
v_mov_b32 v7, 0
v_add_co_u32 v18, vcc, s18, v8
v_mov_b32 v6, s19
s_nop 0
v_addc_co_u32 v19, vcc, v6, v7, vcc
v_subrev_u32 v10, 2048, v10
v_ashrrev_i32 v7, 31, v10
v_add_co_u32 v22, vcc, s26, v10
v_mov_b32 v6, s27
s_nop 0
v_addc_co_u32 v23, vcc, v6, v7, vcc
v_subrev_u32 v11, 3072, v11
v_ashrrev_i32 v7, 31, v11
v_add_co_u32 v24, vcc, s26, v11
v_mov_b32 v6, s27
s_nop 0
v_addc_co_u32 v25, vcc, v6, v7, vcc
v_mov_b32 v2, s26
v_mov_b32 v3, s18
v_cndmask_b32 v2, v2, v3, s[14:15]
v_mov_b32 v3, s27
v_mov_b32 v4, s19
v_cndmask_b32 v3, v3, v4, s[14:15]
v_subrev_u32 v46, 1024, v46
v_ashrrev_i32 v7, 31, v46
v_add_co_u32 v20, vcc, v2, v46
s_nop 1
v_addc_co_u32 v21, vcc, v3, v7, vcc
L_Mgo:
v_mad_u64_u32 v[30:31], vcc, v26, s68, v[18:19]
v_mad_u64_u32 v[32:33], vcc, v27, s68, v[20:21]
v_mad_u64_u32 v[34:35], vcc, v28, s68, v[22:23]
v_mad_u64_u32 v[36:37], vcc, v29, s68, v[24:25]
s_add_u32 m0, s6, 0
s_add_u32 s68, s68, 1
s_cmp_eq_u32 s68, 20
s_cmov_b32 s68, 0
global_load_lds_dwordx4 v[30:31], off offset:0
global_load_lds_dwordx4 v[32:33], off offset:1024
global_load_lds_dwordx4 v[34:35], off offset:2048
global_load_lds_dwordx4 v[36:37], off offset:3072
v_mad_u64_u32 v[30:31], vcc, v26, s68, v[18:19]
v_mad_u64_u32 v[32:33], vcc, v27, s68, v[20:21]
v_mad_u64_u32 v[34:35], vcc, v28, s68, v[22:23]
v_mad_u64_u32 v[36:37], vcc, v29, s68, v[24:25]
s_add_u32 m0, s6, 16384
s_add_u32 s68, s68, 1
s_cmp_eq_u32 s68, 20
s_cmov_b32 s68, 0
global_load_lds_dwordx4 v[30:31], off offset:0
global_load_lds_dwordx4 v[32:33], off offset:1024
global_load_lds_dwordx4 v[34:35], off offset:2048
global_load_lds_dwordx4 v[36:37], off offset:3072
v_lshrrev_b32 v2, 3, v0
s_lshl_b32 s76, s65, 4
v_add_u32 v2, s76, v2
v_lshrrev_b32 v3, 4, v0
v_xor_b32 v3, v3, v0
v_and_b32 v3, 7, v3
v_lshlrev_b32 v3, 4, v3
v_mul_u32_u24 v2, 1280, v2
v_add_u32 v16, v2, v3
v_xor_b32 v3, 64, v3
v_add_u32 v2, 9216, v2
v_add_u32 v17, v2, v3
s_mul_i32 s4, s60, 163840
s_lshl_b32 s5, s65, 11
s_add_u32 s5, s5, 81920
s_lshl_b32 s69, s64, 7
s_mov_b32 s44, s16
s_mov_b32 s45, s17
s_mov_b32 s46, 2621440
s_mov_b32 s47, 0x20000
s_add_u32 s69, s69, 128
s_cmp_eq_u32 s69, 1280
s_cmov_b32 s69, 0
s_setprio 0
s_and_b32 s76, s70, 3
s_lshl_b32 s76, s76, 3
s_add_u32 s66, s76, s73
s_and_b32 s76, s70, 4
s_add_u32 s67, s76, s75
s_mul_i32 s7, s73, 5
s_mul_i32 s76, s75, 10
s_add_u32 s7, s7, s76
s_lshr_b32 s7, s7, 2
s_mov_b32 s48, s40
s_mov_b32 s49, s41
s_mov_b32 s50, 20971520
s_mov_b32 s51, 0x20000
s_mov_b32 s56, s38
s_mov_b32 s57, s39
s_mov_b32 s58, 256
s_mov_b32 s59, 0x20000
v_mov_b32 v1, 0
v_lshlrev_b32 v15, 4, v0
s_lshl_b32 s70, s61, 4
s_add_u32 s70, s70, s60
s_sub_u32 s71, 127, s70
s_lshl_b32 s71, s71, 2
s_add_u32 s71, s71, s65
s_lshl_b32 s72, s65, 7
s_add_u32 s72, s72, s70
s_add_u32 s72, s72, 432
s_cmp_eq_u32 s62, 0
s_cselect_b32 s72, s72, s71
s_mov_b32 s71, 432
s_cmov_b32 s71, 592
s_sub_u32 s70, s72, s71
s_lshr_b32 s71, s72, 3
s_and_b32 s72, s72, 7
s_sub_u32 s73, s71, 54
s_mul_i32 s77, s73, 6554
s_lshr_b32 s77, s77, 15
s_mul_i32 s78, s77, 5
s_sub_u32 s78, s73, s78
s_mul_i32 s73, s77, 160
s_lshr_b32 s77, s78, 1
s_mul_i32 s77, s77, 80
s_and_b32 s79, s78, 1
s_lshl_b32 s79, s79, 3
s_add_u32 s77, s77, s79
s_cmp_eq_u32 s78, 4
s_cselect_b32 s77, 16, s77
s_cselect_b32 s75, 80, 4
s_add_u32 s73, s73, s77
s_mov_b32 s74, 20
s_lshl_b32 s77, s71, 5
s_cmp_lt_u32 s71, 54
s_cselect_b32 s73, s77, s73
s_cselect_b32 s74, 4, s74
s_cselect_b32 s75, 16, s75
s_cselect_b32 s52, s30, s22
s_cselect_b32 s53, s31, s23
s_mov_b32 s54, 819200
s_cmov_b32 s54, 2211840
s_mov_b32 s55, 0x20000
s_mul_i32 s12, s73, 1280
s_mul_i32 s77, s72, 160
s_add_u32 s12, s12, s77
s_mul_i32 s13, s72, 74
s_add_u32 s13, s13, s71
s_mul_i32 s13, s13, 5120
s_add_u32 s13, s13, 10485760
s_and_b32 s77, s60, 3
s_lshl_b32 s78, s62, 2
s_add_u32 s77, s77, s78
s_lshl_b32 s77, s77, 7
s_add_u32 s77, s77, 14974976
s_add_u32 s14, s40, s77
s_addc_u32 s15, s41, 0
s_cmp_lt_i32 s70, 0
s_cselect_b32 s12, s12, 1073741824
s_cselect_b32 s13, s13, 1073741824
s_mul_i32 s3, s65, 5120
s_add_u32 s3, s3, 141824
v_lshrrev_b32 v2, 2, v0
v_mul_u32_u24 v2, 160, v2
v_and_b32 v3, 3, v0
v_mul_u32_u24 v3, 40, v3
v_add3_u32 v43, v2, v3, s3
v_add_u32 v44, 4096, v15
v_add_u32 v2, 0, v0
v_mul_u32_u24 v3, 6554, v2
v_lshrrev_b32 v3, 16, v3
v_mul_u32_u24 v4, 10, v3
v_sub_u32 v4, v2, v4
v_bfe_u32 v5, v3, 2, 2
v_mul_u32_u24 v5, s74, v5
v_lshrrev_b32 v6, 4, v3
v_mul_u32_u24 v6, s75, v6
v_and_b32 v3, 3, v3
v_add3_u32 v3, v3, v5, v6
v_mul_u32_u24 v3, 1280, v3
v_lshl_add_u32 v38, v4, 4, v3
v_add_u32 v2, 64, v0
v_mul_u32_u24 v3, 6554, v2
v_lshrrev_b32 v3, 16, v3
v_mul_u32_u24 v4, 10, v3
v_sub_u32 v4, v2, v4
v_bfe_u32 v5, v3, 2, 2
v_mul_u32_u24 v5, s74, v5
v_lshrrev_b32 v6, 4, v3
v_mul_u32_u24 v6, s75, v6
v_and_b32 v3, 3, v3
v_add3_u32 v3, v3, v5, v6
v_mul_u32_u24 v3, 1280, v3
v_lshl_add_u32 v39, v4, 4, v3
v_add_u32 v2, 128, v0
v_mul_u32_u24 v3, 6554, v2
v_lshrrev_b32 v3, 16, v3
v_mul_u32_u24 v4, 10, v3
v_sub_u32 v4, v2, v4
v_bfe_u32 v5, v3, 2, 2
v_mul_u32_u24 v5, s74, v5
v_lshrrev_b32 v6, 4, v3
v_mul_u32_u24 v6, s75, v6
v_and_b32 v3, 3, v3
v_add3_u32 v3, v3, v5, v6
v_mul_u32_u24 v3, 1280, v3
v_lshl_add_u32 v40, v4, 4, v3
v_add_u32 v2, 192, v0
v_mul_u32_u24 v3, 6554, v2
v_lshrrev_b32 v3, 16, v3
v_mul_u32_u24 v4, 10, v3
v_sub_u32 v4, v2, v4
v_bfe_u32 v5, v3, 2, 2
v_mul_u32_u24 v5, s74, v5
v_lshrrev_b32 v6, 4, v3
v_mul_u32_u24 v6, s75, v6
v_and_b32 v3, 3, v3
v_add3_u32 v3, v3, v5, v6
v_mul_u32_u24 v3, 1280, v3
v_lshl_add_u32 v41, v4, 4, v3
v_add_u32 v2, 256, v0
v_mul_u32_u24 v3, 6554, v2
v_lshrrev_b32 v3, 16, v3
v_mul_u32_u24 v4, 10, v3
v_sub_u32 v4, v2, v4
v_bfe_u32 v5, v3, 2, 2
v_mul_u32_u24 v5, s74, v5
v_lshrrev_b32 v6, 4, v3
v_mul_u32_u24 v6, s75, v6
v_and_b32 v3, 3, v3
v_add3_u32 v3, v3, v5, v6
v_mul_u32_u24 v3, 1280, v3
v_lshl_add_u32 v42, v4, 4, v3
s_cmp_eq_u32 s65, 3
s_cselect_b32 s70, 8, 10
s_mul_i32 s71, s65, 10
s_add_u32 s71, s71, 16
s_cmp_ge_u32 s7, s70
s_cselect_b32 s72, s70, 0
s_sub_u32 s7, s7, s72
s_cmp_ge_u32 s7, s70
s_cselect_b32 s72, s70, 0
s_sub_u32 s7, s7, s72
s_mul_i32 s74, s66, 54
s_add_u32 s72, s74, s71
s_lshl_b32 s18, s72, 12
s_lshl_b32 s73, s70, 12
s_add_u32 s17, s18, s73
s_lshl_b32 s73, s7, 12
s_add_u32 s16, s18, s73
s_mul_i32 s75, s67, 74
s_add_u32 s73, s75, s71
s_mul_i32 s73, s73, 5120
s_add_u32 s25, s73, 10485760
s_mul_i32 s73, s70, 5120
s_add_u32 s24, s25, s73
s_mul_i32 s73, s7, 5120
s_add_u32 s19, s25, s73
s_lshl_b32 s70, s65, 2
s_add_u32 s71, s74, s70
s_lshl_b32 s26, s71, 12
s_add_u32 s71, s75, s70
s_mul_i32 s71, s71, 5120
s_add_u32 s27, s71, 10485760
s_mul_i32 s70, s65, 5
s_add_u32 s70, s70, s75
s_add_u32 s70, s70, 54
s_mul_i32 s70, s70, 5120
s_add_u32 s29, s70, 10485760
s_mul_i32 s70, s66, 81920
s_add_u32 s28, s70, 7340032
s_lshl_b32 s70, s66, 3
s_add_u32 s70, s70, s67
s_lshl_b32 s70, s70, 2
s_add_u32 s70, s70, s65
s_lshl_b32 s70, s70, 7
s_add_u32 s70, s70, 14811136
s_add_u32 s34, s40, s70
s_addc_u32 s35, s41, 0
s_mov_b32 s8, 14976000
s_lshl_b32 s70, s66, 8
s_lshl_b32 s71, s65, 14
s_add_u32 s70, s70, s71
s_add_u32 s10, s70, 13631488
s_mul_i32 s11, s65, 20480
s_add_u32 s11, s11, 49152
s_cmp_eq_u32 s65, 3
s_cmov_b32 s11, 141824
v_add_u32 v13, 4096, v15
s_and_b32 s70, s67, 3
s_xor_b32 s43, s70, s65
s_xor_b32 s70, s43, 0
s_lshl_b32 s70, s70, 10
v_add_u32 v10, s70, v15
s_xor_b32 s70, s43, 1
s_lshl_b32 s70, s70, 10
v_add_u32 v11, s70, v15
s_xor_b32 s70, s43, 2
s_lshl_b32 s70, s70, 10
v_add_u32 v12, s70, v15
s_xor_b32 s70, s43, 3
s_lshl_b32 s70, s70, 10
v_add_u32 v3, s70, v15
v_min_u32 v4, 144, v15
s_mul_i32 s70, s67, 160
v_add_u32 v4, s70, v4
v_and_b32 v8, 7, v0
v_lshlrev_b32 v8, 7, v8
s_lshl_b32 s76, s2, 12
v_lshl_add_u32 v2, v0, 7, s76
s_lshl_b32 s76, s2, 10
s_add_u32 s76, s76, 126976
v_lshl_add_u32 v6, v0, 7, s76
v_cmp_gt_u32 vcc, 32, v0
v_mov_b32 v168, 0
v_mov_b32 v169, 0
v_cndmask_b32 v2, v6, v2, vcc
v_mov_b32 v6, 1073741824
v_cmp_gt_u32 vcc, 40, v0
v_mov_b32 v170, 0
v_mov_b32 v171, 0
v_cndmask_b32 v2, v6, v2, vcc
s_add_u32 s76, s2, 1280
s_lshl_b32 s76, s76, 7
s_cmp_lt_u32 s2, 16
s_cselect_b32 s76, s76, 1073741824
v_writelane_b32 v2, s76, 40
s_lshl_b32 s76, s65, 8
s_or_b32 s76, s76, s2
s_cmp_lt_u32 s76, 32
s_mov_b32 s76, 1073741824
s_cmov_b32 s76, 14811136
buffer_store_dwordx4 v[168:171], v2, s[48:51], s76 offen sc1
s_mov_b32 m0, 162304
s_nop 0
global_load_lds_dwordx4 v4, s[32:33]
s_mul_i32 s76, s61, 3200
s_lshl_b32 s77, s65, 10
s_add_u32 m0, s77, 133376
s_add_u32 s76, s76, s77
s_add_u32 s76, s76, s20
s_addc_u32 s77, s21, 0
s_cmp_eq_u32 s65, 3
s_mov_b32 s78, 1008
s_cmov_b32 s78, 112
v_min_u32 v6, s78, v15
global_load_lds_dwordx4 v6, s[76:77]
s_add_u32 m0, s3, 0
s_nop 0
buffer_load_dwordx4 v38, s[52:55], s12 offen nt lds
s_add_u32 m0, s3, 1024
s_nop 0
buffer_load_dwordx4 v39, s[52:55], s12 offen nt lds
s_add_u32 m0, s3, 2048
s_nop 0
buffer_load_dwordx4 v40, s[52:55], s12 offen nt lds
s_add_u32 m0, s3, 3072
s_nop 0
buffer_load_dwordx4 v41, s[52:55], s12 offen nt lds
s_add_u32 m0, s3, 4096
s_nop 0
buffer_load_dwordx4 v42, s[52:55], s12 offen nt lds
s_xor_b32 s70, s43, 0
s_lshr_b32 s71, s70, 1
s_lshl_b32 s71, s71, 10
s_and_b32 s70, s70, 1
s_lshl_b32 s70, s70, 3
s_add_u32 s70, s70, s71
s_add_u32 s70, s70, 8192
v_add_u32 v4, s70, v15
s_xor_b32 s70, s43, 1
s_lshr_b32 s71, s70, 1
s_lshl_b32 s71, s71, 10
s_and_b32 s70, s70, 1
s_lshl_b32 s70, s70, 3
s_add_u32 s70, s70, s71
s_add_u32 s70, s70, 8192
v_add_u32 v5, s70, v15
s_xor_b32 s70, s43, 2
s_lshr_b32 s71, s70, 1
s_lshl_b32 s71, s71, 10
s_and_b32 s70, s70, 1
s_lshl_b32 s70, s70, 3
s_add_u32 s70, s70, s71
s_add_u32 s70, s70, 8192
v_add_u32 v6, s70, v15
s_xor_b32 s70, s43, 3
s_lshr_b32 s71, s70, 1
s_lshl_b32 s71, s71, 10
s_and_b32 s70, s70, 1
s_lshl_b32 s70, s70, 3
s_add_u32 s70, s70, s71
s_add_u32 s70, s70, 8192
v_add_u32 v7, s70, v15
s_mov_b32 s52, s36
s_mov_b32 s53, s37
s_mov_b32 s54, 2621440
s_mov_b32 s55, 0x20000
v_and_b32 v169, 15, v0
v_mul_u32_u24 v169, 1280, v169
v_lshrrev_b32 v170, 4, v0
v_mul_u32_u24 v170, 40, v170
v_add_u32 v169, v169, v170
v_add_u32 v171, s11, v15
s_lshl_b32 s70, s66, 2
s_add_u32 s70, s70, s43
s_mul_i32 s70, s70, 20480
s_mul_i32 s71, s67, 160
s_add_u32 s42, s70, s71
s_mul_i32 s70, s65, 20480
s_add_u32 s28, s28, s70
v_and_b32 v173, 15, v0
v_lshlrev_b32 v173, 2, v173
s_waitcnt vmcnt(12)
s_barrier
s_add_u32 s76, s69, 0
s_add_u32 m0, s5, 16384
s_add_u32 s76, s76, s4
buffer_load_dwordx4 v16, s[44:47], s76 offen lds
buffer_load_dwordx4 v17, s[44:47], s76 offen offset:1024 lds
s_add_u32 s76, s69, 81920
s_add_u32 m0, s5, 24576
s_add_u32 s76, s76, s4
buffer_load_dwordx4 v16, s[44:47], s76 offen lds
buffer_load_dwordx4 v17, s[44:47], s76 offen offset:1024 lds
s_add_u32 s69, s69, 128
s_cmp_eq_u32 s69, 1280
s_cmov_b32 s69, 0
v_mad_u64_u32 v[30:31], vcc, v26, s68, v[18:19]
v_mad_u64_u32 v[32:33], vcc, v27, s68, v[20:21]
v_mad_u64_u32 v[34:35], vcc, v28, s68, v[22:23]
v_mad_u64_u32 v[36:37], vcc, v29, s68, v[24:25]
s_add_u32 m0, s6, 32768
s_add_u32 s68, s68, 1
s_cmp_eq_u32 s68, 20
s_cmov_b32 s68, 0
global_load_lds_dwordx4 v[30:31], off offset:0
global_load_lds_dwordx4 v[32:33], off offset:1024
global_load_lds_dwordx4 v[34:35], off offset:2048
global_load_lds_dwordx4 v[36:37], off offset:3072
s_waitcnt vmcnt(16)
s_barrier
s_add_u32 s76, s69, 0
s_add_u32 m0, s5, 32768
s_add_u32 s76, s76, s4
buffer_load_dwordx4 v16, s[44:47], s76 offen lds
buffer_load_dwordx4 v17, s[44:47], s76 offen offset:1024 lds
v_mad_u64_u32 v[30:31], vcc, v26, s68, v[18:19]
v_mad_u64_u32 v[32:33], vcc, v27, s68, v[20:21]
v_mad_u64_u32 v[34:35], vcc, v28, s68, v[22:23]
v_mad_u64_u32 v[36:37], vcc, v29, s68, v[24:25]
s_add_u32 m0, s6, 49152
s_add_u32 s68, s68, 1
s_cmp_eq_u32 s68, 20
s_cmov_b32 s68, 0
global_load_lds_dwordx4 v[30:31], off offset:0
global_load_lds_dwordx4 v[32:33], off offset:1024
global_load_lds_dwordx4 v[34:35], off offset:2048
global_load_lds_dwordx4 v[36:37], off offset:3072
s_waitcnt vmcnt(6)
s_barrier
s_add_u32 s76, s69, 81920
s_add_u32 m0, s5, 40960
s_add_u32 s76, s76, s4
buffer_load_dwordx4 v16, s[44:47], s76 offen lds
buffer_load_dwordx4 v17, s[44:47], s76 offen offset:1024 lds
s_add_u32 s69, s69, 128
s_cmp_eq_u32 s69, 1280
s_cmov_b32 s69, 0
s_lshl_b32 s77, s65, 8
s_or_b32 s77, s77, s2
s_cmp_ge_u32 s77, 32
s_cbranch_scc1 L_ini_1
s_mov_b32 s21, 1
s_atomic_add s21, s[38:39], 0 glc
L_ini_1:
ds_read_b64_tr_b16 v[48:49], v43 offset:0
ds_read_b64_tr_b16 v[50:51], v43 offset:2560
ds_read_b64_tr_b16 v[52:53], v43 offset:8
ds_read_b64_tr_b16 v[54:55], v43 offset:2568
ds_read_b64_tr_b16 v[56:57], v43 offset:16
ds_read_b64_tr_b16 v[58:59], v43 offset:2576
ds_read_b64_tr_b16 v[60:61], v43 offset:24
ds_read_b64_tr_b16 v[62:63], v43 offset:2584
ds_read_b64_tr_b16 v[64:65], v43 offset:32
ds_read_b64_tr_b16 v[66:67], v43 offset:2592
v_mad_u64_u32 v[30:31], vcc, v26, s68, v[18:19]
v_mad_u64_u32 v[32:33], vcc, v27, s68, v[20:21]
v_mad_u64_u32 v[34:35], vcc, v28, s68, v[22:23]
v_mad_u64_u32 v[36:37], vcc, v29, s68, v[24:25]
s_add_u32 m0, s6, 65536
s_add_u32 s68, s68, 1
s_cmp_eq_u32 s68, 20
s_cmov_b32 s68, 0
global_load_lds_dwordx4 v[30:31], off offset:0
global_load_lds_dwordx4 v[32:33], off offset:1024
global_load_lds_dwordx4 v[34:35], off offset:2048
global_load_lds_dwordx4 v[36:37], off offset:3072
s_waitcnt lgkmcnt(0)
buffer_store_dwordx4 v[48:51], v15, s[48:51], s13 offen offset:0 sc1
buffer_store_dwordx4 v[52:55], v15, s[48:51], s13 offen offset:1024 sc1
buffer_store_dwordx4 v[56:59], v15, s[48:51], s13 offen offset:2048 sc1
buffer_store_dwordx4 v[60:63], v15, s[48:51], s13 offen offset:3072 sc1
buffer_store_dwordx4 v[64:67], v44, s[48:51], s13 offen sc1
s_waitcnt vmcnt(11)
s_barrier
s_add_u32 s76, s69, 0
s_add_u32 m0, s5, 0
s_add_u32 s76, s76, s4
buffer_load_dwordx4 v16, s[44:47], s76 offen lds
buffer_load_dwordx4 v17, s[44:47], s76 offen offset:1024 lds
v_mad_u64_u32 v[30:31], vcc, v26, s68, v[18:19]
v_mad_u64_u32 v[32:33], vcc, v27, s68, v[20:21]
v_mad_u64_u32 v[34:35], vcc, v28, s68, v[22:23]
v_mad_u64_u32 v[36:37], vcc, v29, s68, v[24:25]
s_add_u32 m0, s6, 0
s_add_u32 s68, s68, 1
s_cmp_eq_u32 s68, 20
s_cmov_b32 s68, 0
global_load_lds_dwordx4 v[30:31], off offset:0
global_load_lds_dwordx4 v[32:33], off offset:1024
global_load_lds_dwordx4 v[34:35], off offset:2048
global_load_lds_dwordx4 v[36:37], off offset:3072
s_waitcnt vmcnt(11)
s_barrier
s_add_u32 s76, s69, 81920
s_add_u32 m0, s5, 8192
s_add_u32 s76, s76, s4
buffer_load_dwordx4 v16, s[44:47], s76 offen lds
buffer_load_dwordx4 v17, s[44:47], s76 offen offset:1024 lds
s_add_u32 s69, s69, 128
s_cmp_eq_u32 s69, 1280
s_cmov_b32 s69, 0
v_mad_u64_u32 v[30:31], vcc, v26, s68, v[18:19]
v_mad_u64_u32 v[32:33], vcc, v27, s68, v[20:21]
v_mad_u64_u32 v[34:35], vcc, v28, s68, v[22:23]
v_mad_u64_u32 v[36:37], vcc, v29, s68, v[24:25]
s_add_u32 m0, s6, 16384
s_add_u32 s68, s68, 1
s_cmp_eq_u32 s68, 20
s_cmov_b32 s68, 0
global_load_lds_dwordx4 v[30:31], off offset:0
global_load_lds_dwordx4 v[32:33], off offset:1024
global_load_lds_dwordx4 v[34:35], off offset:2048
global_load_lds_dwordx4 v[36:37], off offset:3072
s_waitcnt vmcnt(6)
s_barrier
s_add_u32 s76, s69, 0
s_add_u32 m0, s5, 16384
s_add_u32 s76, s76, s4
buffer_load_dwordx4 v16, s[44:47], s76 offen lds
buffer_load_dwordx4 v17, s[44:47], s76 offen offset:1024 lds
v_mad_u64_u32 v[30:31], vcc, v26, s68, v[18:19]
v_mad_u64_u32 v[32:33], vcc, v27, s68, v[20:21]
v_mad_u64_u32 v[34:35], vcc, v28, s68, v[22:23]
v_mad_u64_u32 v[36:37], vcc, v29, s68, v[24:25]
s_add_u32 m0, s6, 32768
s_add_u32 s68, s68, 1
s_cmp_eq_u32 s68, 20
s_cmov_b32 s68, 0
global_load_lds_dwordx4 v[30:31], off offset:0
global_load_lds_dwordx4 v[32:33], off offset:1024
global_load_lds_dwordx4 v[34:35], off offset:2048
global_load_lds_dwordx4 v[36:37], off offset:3072
s_waitcnt vmcnt(6)
s_barrier
s_add_u32 s76, s69, 81920
s_add_u32 m0, s5, 24576
s_add_u32 s76, s76, s4
buffer_load_dwordx4 v16, s[44:47], s76 offen lds
buffer_load_dwordx4 v17, s[44:47], s76 offen offset:1024 lds
s_add_u32 s69, s69, 128
s_cmp_eq_u32 s69, 1280
s_cmov_b32 s69, 0
v_mad_u64_u32 v[30:31], vcc, v26, s68, v[18:19]
v_mad_u64_u32 v[32:33], vcc, v27, s68, v[20:21]
v_mad_u64_u32 v[34:35], vcc, v28, s68, v[22:23]
v_mad_u64_u32 v[36:37], vcc, v29, s68, v[24:25]
s_add_u32 m0, s6, 49152
s_add_u32 s68, s68, 1
s_cmp_eq_u32 s68, 20
s_cmov_b32 s68, 0
global_load_lds_dwordx4 v[30:31], off offset:0
global_load_lds_dwordx4 v[32:33], off offset:1024
global_load_lds_dwordx4 v[34:35], off offset:2048
global_load_lds_dwordx4 v[36:37], off offset:3072
s_waitcnt vmcnt(6)
s_barrier
s_add_u32 s76, s69, 0
s_add_u32 m0, s5, 32768
s_add_u32 s76, s76, s4
buffer_load_dwordx4 v16, s[44:47], s76 offen lds
buffer_load_dwordx4 v17, s[44:47], s76 offen offset:1024 lds
s_load_dword s31, s[38:39], 0
v_mad_u64_u32 v[30:31], vcc, v26, s68, v[18:19]
v_mad_u64_u32 v[32:33], vcc, v27, s68, v[20:21]
v_mad_u64_u32 v[34:35], vcc, v28, s68, v[22:23]
v_mad_u64_u32 v[36:37], vcc, v29, s68, v[24:25]
s_add_u32 m0, s6, 65536
s_add_u32 s68, s68, 1
s_cmp_eq_u32 s68, 20
s_cmov_b32 s68, 0
global_load_lds_dwordx4 v[30:31], off offset:0
global_load_lds_dwordx4 v[32:33], off offset:1024
global_load_lds_dwordx4 v[34:35], off offset:2048
global_load_lds_dwordx4 v[36:37], off offset:3072
s_waitcnt vmcnt(6)
s_barrier
s_add_u32 s76, s69, 81920
s_add_u32 m0, s5, 40960
s_add_u32 s76, s76, s4
buffer_load_dwordx4 v16, s[44:47], s76 offen lds
buffer_load_dwordx4 v17, s[44:47], s76 offen offset:1024 lds
s_add_u32 s69, s69, 128
s_cmp_eq_u32 s69, 1280
s_cmov_b32 s69, 0
s_waitcnt lgkmcnt(0)
s_cmp_ge_u32 s31, 32
s_cbranch_scc1 L_sc_2
v_mov_b32 v14, 0
s_mov_b32 s79, 0
L_vp_3:
v_cmp_gt_u32 vcc, 32, v14
s_nop 1
s_cmp_eq_u64 vcc, 0
s_cbranch_scc1 L_vpd_4
s_add_u32 s79, s79, 1
s_cmp_ge_u32 s79, 0x100000
s_cbranch_scc1 L_end
s_sleep 8
buffer_load_dword v14, v1, s[56:59], 0 offen sc1
s_waitcnt vmcnt(0)
s_branch L_vp_3
L_vpd_4:
L_sc_2:
s_mov_b64 exec, 1
v_mov_b32 v174, 133132
v_mov_b32 v175, 1
ds_add_rtn_u32 v174, v174, v175
s_mov_b64 exec, -1
s_mov_b32 s22, 0
v_mad_u64_u32 v[30:31], vcc, v26, s68, v[18:19]
v_mad_u64_u32 v[32:33], vcc, v27, s68, v[20:21]
v_mad_u64_u32 v[34:35], vcc, v28, s68, v[22:23]
v_mad_u64_u32 v[36:37], vcc, v29, s68, v[24:25]
s_add_u32 m0, s6, 0
s_add_u32 s68, s68, 1
s_cmp_eq_u32 s68, 20
s_cmov_b32 s68, 0
global_load_lds_dwordx4 v[30:31], off offset:0
global_load_lds_dwordx4 v[32:33], off offset:1024
global_load_lds_dwordx4 v[34:35], off offset:2048
global_load_lds_dwordx4 v[36:37], off offset:3072
s_waitcnt vmcnt(6)
s_barrier
s_add_u32 s76, s69, 0
s_add_u32 m0, s5, 0
s_add_u32 s76, s76, s4
buffer_load_dwordx4 v16, s[44:47], s76 offen lds
buffer_load_dwordx4 v17, s[44:47], s76 offen offset:1024 lds
s_waitcnt lgkmcnt(0)
v_readfirstlane_b32 s78, v174
s_nop 1
s_cmp_lg_u32 s78, 3
s_cbranch_scc1 L_w1_5
s_mov_b32 s22, 1
s_atomic_add s22, s[14:15], 0 glc
L_w1_5:
v_mad_u64_u32 v[30:31], vcc, v26, s68, v[18:19]
v_mad_u64_u32 v[32:33], vcc, v27, s68, v[20:21]
v_mad_u64_u32 v[34:35], vcc, v28, s68, v[22:23]
v_mad_u64_u32 v[36:37], vcc, v29, s68, v[24:25]
s_add_u32 m0, s6, 16384
s_add_u32 s68, s68, 1
s_cmp_eq_u32 s68, 20
s_cmov_b32 s68, 0
global_load_lds_dwordx4 v[30:31], off offset:0
global_load_lds_dwordx4 v[32:33], off offset:1024
global_load_lds_dwordx4 v[34:35], off offset:2048
global_load_lds_dwordx4 v[36:37], off offset:3072
s_waitcnt vmcnt(6)
s_barrier
s_add_u32 s76, s69, 81920
s_add_u32 m0, s5, 8192
s_add_u32 s76, s76, s4
buffer_load_dwordx4 v16, s[44:47], s76 offen lds
buffer_load_dwordx4 v17, s[44:47], s76 offen offset:1024 lds
s_add_u32 s69, s69, 128
s_cmp_eq_u32 s69, 1280
s_cmov_b32 s69, 0
s_waitcnt lgkmcnt(0)
s_cmp_lg_u32 s22, 31
s_cbranch_scc1 L_w2_6
s_mov_b32 s23, 1
s_atomic_add s23, s[14:15], 1024 glc
L_w2_6:
v_mad_u64_u32 v[30:31], vcc, v26, s68, v[18:19]
v_mad_u64_u32 v[32:33], vcc, v27, s68, v[20:21]
v_mad_u64_u32 v[34:35], vcc, v28, s68, v[22:23]
v_mad_u64_u32 v[36:37], vcc, v29, s68, v[24:25]
s_add_u32 m0, s6, 32768
s_add_u32 s68, s68, 1
s_cmp_eq_u32 s68, 20
s_cmov_b32 s68, 0
global_load_lds_dwordx4 v[30:31], off offset:0
global_load_lds_dwordx4 v[32:33], off offset:1024
global_load_lds_dwordx4 v[34:35], off offset:2048
global_load_lds_dwordx4 v[36:37], off offset:3072
s_waitcnt vmcnt(6)
s_barrier
s_add_u32 s76, s69, 0
s_add_u32 m0, s5, 16384
s_add_u32 s76, s76, s4
buffer_load_dwordx4 v16, s[44:47], s76 offen lds
buffer_load_dwordx4 v17, s[44:47], s76 offen offset:1024 lds
v_mad_u64_u32 v[30:31], vcc, v26, s68, v[18:19]
v_mad_u64_u32 v[32:33], vcc, v27, s68, v[20:21]
v_mad_u64_u32 v[34:35], vcc, v28, s68, v[22:23]
v_mad_u64_u32 v[36:37], vcc, v29, s68, v[24:25]
s_add_u32 m0, s6, 49152
s_add_u32 s68, s68, 1
s_cmp_eq_u32 s68, 20
s_cmov_b32 s68, 0
global_load_lds_dwordx4 v[30:31], off offset:0
global_load_lds_dwordx4 v[32:33], off offset:1024
global_load_lds_dwordx4 v[34:35], off offset:2048
global_load_lds_dwordx4 v[36:37], off offset:3072
s_waitcnt vmcnt(6)
s_barrier
s_add_u32 s76, s69, 81920
s_add_u32 m0, s5, 24576
s_add_u32 s76, s76, s4
buffer_load_dwordx4 v16, s[44:47], s76 offen lds
buffer_load_dwordx4 v17, s[44:47], s76 offen offset:1024 lds
s_add_u32 s69, s69, 128
s_cmp_eq_u32 s69, 1280
s_cmov_b32 s69, 0
v_mad_u64_u32 v[30:31], vcc, v26, s68, v[18:19]
v_mad_u64_u32 v[32:33], vcc, v27, s68, v[20:21]
v_mad_u64_u32 v[34:35], vcc, v28, s68, v[22:23]
v_mad_u64_u32 v[36:37], vcc, v29, s68, v[24:25]
s_add_u32 m0, s6, 65536
s_add_u32 s68, s68, 1
s_cmp_eq_u32 s68, 20
s_cmov_b32 s68, 0
global_load_lds_dwordx4 v[30:31], off offset:0
global_load_lds_dwordx4 v[32:33], off offset:1024
global_load_lds_dwordx4 v[34:35], off offset:2048
global_load_lds_dwordx4 v[36:37], off offset:3072
s_waitcnt vmcnt(6)
s_barrier
s_add_u32 s76, s69, 0
s_add_u32 m0, s5, 32768
s_add_u32 s76, s76, s4
buffer_load_dwordx4 v16, s[44:47], s76 offen lds
buffer_load_dwordx4 v17, s[44:47], s76 offen offset:1024 lds
v_mad_u64_u32 v[30:31], vcc, v26, s68, v[18:19]
v_mad_u64_u32 v[32:33], vcc, v27, s68, v[20:21]
v_mad_u64_u32 v[34:35], vcc, v28, s68, v[22:23]
v_mad_u64_u32 v[36:37], vcc, v29, s68, v[24:25]
s_add_u32 m0, s6, 0
s_add_u32 s68, s68, 1
s_cmp_eq_u32 s68, 20
s_cmov_b32 s68, 0
global_load_lds_dwordx4 v[30:31], off offset:0
global_load_lds_dwordx4 v[32:33], off offset:1024
global_load_lds_dwordx4 v[34:35], off offset:2048
global_load_lds_dwordx4 v[36:37], off offset:3072
s_waitcnt vmcnt(6)
s_barrier
s_add_u32 s76, s69, 81920
s_add_u32 m0, s5, 40960
s_add_u32 s76, s76, s4
buffer_load_dwordx4 v16, s[44:47], s76 offen lds
buffer_load_dwordx4 v17, s[44:47], s76 offen offset:1024 lds
s_add_u32 s69, s69, 128
s_cmp_eq_u32 s69, 1280
s_cmov_b32 s69, 0
v_mad_u64_u32 v[30:31], vcc, v26, s68, v[18:19]
v_mad_u64_u32 v[32:33], vcc, v27, s68, v[20:21]
v_mad_u64_u32 v[34:35], vcc, v28, s68, v[22:23]
v_mad_u64_u32 v[36:37], vcc, v29, s68, v[24:25]
s_add_u32 m0, s6, 16384
s_add_u32 s68, s68, 1
s_cmp_eq_u32 s68, 20
s_cmov_b32 s68, 0
global_load_lds_dwordx4 v[30:31], off offset:0
global_load_lds_dwordx4 v[32:33], off offset:1024
global_load_lds_dwordx4 v[34:35], off offset:2048
global_load_lds_dwordx4 v[36:37], off offset:3072
s_waitcnt vmcnt(6)
s_barrier
s_add_u32 s76, s69, 0
s_add_u32 m0, s5, 0
s_add_u32 s76, s76, s4
buffer_load_dwordx4 v16, s[44:47], s76 offen lds
buffer_load_dwordx4 v17, s[44:47], s76 offen offset:1024 lds
v_mad_u64_u32 v[30:31], vcc, v26, s68, v[18:19]
v_mad_u64_u32 v[32:33], vcc, v27, s68, v[20:21]
v_mad_u64_u32 v[34:35], vcc, v28, s68, v[22:23]
v_mad_u64_u32 v[36:37], vcc, v29, s68, v[24:25]
s_add_u32 m0, s6, 32768
s_add_u32 s68, s68, 1
s_cmp_eq_u32 s68, 20
s_cmov_b32 s68, 0
global_load_lds_dwordx4 v[30:31], off offset:0
global_load_lds_dwordx4 v[32:33], off offset:1024
global_load_lds_dwordx4 v[34:35], off offset:2048
global_load_lds_dwordx4 v[36:37], off offset:3072
s_waitcnt vmcnt(6)
s_barrier
s_add_u32 s76, s69, 81920
s_add_u32 m0, s5, 8192
s_add_u32 s76, s76, s4
buffer_load_dwordx4 v16, s[44:47], s76 offen lds
buffer_load_dwordx4 v17, s[44:47], s76 offen offset:1024 lds
s_add_u32 s69, s69, 128
s_cmp_eq_u32 s69, 1280
s_cmov_b32 s69, 0
v_mad_u64_u32 v[30:31], vcc, v26, s68, v[18:19]
v_mad_u64_u32 v[32:33], vcc, v27, s68, v[20:21]
v_mad_u64_u32 v[34:35], vcc, v28, s68, v[22:23]
v_mad_u64_u32 v[36:37], vcc, v29, s68, v[24:25]
s_add_u32 m0, s6, 49152
s_add_u32 s68, s68, 1
s_cmp_eq_u32 s68, 20
s_cmov_b32 s68, 0
global_load_lds_dwordx4 v[30:31], off offset:0
global_load_lds_dwordx4 v[32:33], off offset:1024
global_load_lds_dwordx4 v[34:35], off offset:2048
global_load_lds_dwordx4 v[36:37], off offset:3072
s_waitcnt vmcnt(6)
s_barrier
v_mad_u64_u32 v[30:31], vcc, v26, s68, v[18:19]
v_mad_u64_u32 v[32:33], vcc, v27, s68, v[20:21]
v_mad_u64_u32 v[34:35], vcc, v28, s68, v[22:23]
v_mad_u64_u32 v[36:37], vcc, v29, s68, v[24:25]
s_add_u32 m0, s6, 65536
s_add_u32 s68, s68, 1
s_cmp_eq_u32 s68, 20
s_cmov_b32 s68, 0
global_load_lds_dwordx4 v[30:31], off offset:0
global_load_lds_dwordx4 v[32:33], off offset:1024
global_load_lds_dwordx4 v[34:35], off offset:2048
global_load_lds_dwordx4 v[36:37], off offset:3072
s_waitcnt vmcnt(4)
s_barrier
s_add_u32 s76, s40, s8
s_addc_u32 s77, s41, 0
s_load_dword s20, s[76:77], 0
s_load_dword s22, s[76:77], 128
s_load_dword s23, s[76:77], 256
s_load_dword s30, s[76:77], 384
s_load_dword s31, s[76:77], 512
s_load_dword s32, s[76:77], 640
s_load_dword s33, s[76:77], 768
s_load_dword s12, s[76:77], 896
s_waitcnt vmcnt(0)
s_barrier
s_waitcnt lgkmcnt(0)
s_min_u32 s20, s20, s22
s_min_u32 s20, s20, s23
s_min_u32 s20, s20, s30
s_min_u32 s20, s20, s31
s_min_u32 s20, s20, s32
s_min_u32 s20, s20, s33
s_min_u32 s20, s20, s12
s_cmp_ge_u32 s20, 1
s_cbranch_scc1 L_sc_7
v_mov_b32 v14, 0
s_mov_b32 s79, 0
L_vp_8:
v_cmp_gt_u32 vcc, 1, v14
s_nop 1
s_cmp_eq_u64 vcc, 0
s_cbranch_scc1 L_vpd_9
s_add_u32 s79, s79, 1
s_cmp_ge_u32 s79, 0x100000
s_cbranch_scc1 L_end
s_sleep 8
buffer_load_dword v14, v8, s[48:51], s8 offen sc1
s_waitcnt vmcnt(0)
s_branch L_vp_8
L_vpd_9:
L_sc_7:
s_setprio 0
buffer_load_dwordx4 v[16:19], v15, s[48:51], s19 offen sc1
buffer_load_dwordx4 v[20:23], v15, s[48:51], s19 offen offset:1024 sc1
buffer_load_dwordx4 v[24:27], v15, s[48:51], s19 offen offset:2048 sc1
buffer_load_dwordx4 v[28:31], v15, s[48:51], s19 offen offset:3072 sc1
buffer_load_dwordx4 v[32:35], v13, s[48:51], s19 offen sc1
s_add_u32 s19, s19, 5120
s_cmp_eq_u32 s19, s24
s_cmov_b32 s19, s25
buffer_load_dwordx4 v[36:39], v15, s[48:51], s19 offen sc1
buffer_load_dwordx4 v[40:43], v15, s[48:51], s19 offen offset:1024 sc1
buffer_load_dwordx4 v[44:47], v15, s[48:51], s19 offen offset:2048 sc1
buffer_load_dwordx4 v[48:51], v15, s[48:51], s19 offen offset:3072 sc1
buffer_load_dwordx4 v[52:55], v13, s[48:51], s19 offen sc1
s_add_u32 s19, s19, 5120
s_cmp_eq_u32 s19, s24
s_cmov_b32 s19, s25
s_setprio 3
v_mov_b32 v174, 133152
s_mov_b32 s79, 0
L_lw_10:
ds_read_b32 v175, v174
s_waitcnt lgkmcnt(0)
v_readfirstlane_b32 s78, v175
s_nop 1
s_cmp_ge_u32 s78, 4
s_cbranch_scc1 L_lwd_11
s_add_u32 s79, s79, 1
s_cmp_ge_u32 s79, 0x1000000
s_cbranch_scc1 L_end
s_sleep 1
s_branch L_lw_10
L_lwd_11:
s_setprio 0
buffer_load_dwordx4 v[56:59], v15, s[48:51], s19 offen sc1
buffer_load_dwordx4 v[60:63], v15, s[48:51], s19 offen offset:1024 sc1
buffer_load_dwordx4 v[64:67], v15, s[48:51], s19 offen offset:2048 sc1
buffer_load_dwordx4 v[68:71], v15, s[48:51], s19 offen offset:3072 sc1
buffer_load_dwordx4 v[72:75], v13, s[48:51], s19 offen sc1
s_add_u32 s19, s19, 5120
s_cmp_eq_u32 s19, s24
s_cmov_b32 s19, s25
s_waitcnt vmcnt(10)
buffer_load_dwordx4 v[76:79], v15, s[48:51], s19 offen sc1
buffer_load_dwordx4 v[80:83], v15, s[48:51], s19 offen offset:1024 sc1
buffer_load_dwordx4 v[84:87], v15, s[48:51], s19 offen offset:2048 sc1
buffer_load_dwordx4 v[88:91], v15, s[48:51], s19 offen offset:3072 sc1
buffer_load_dwordx4 v[92:95], v13, s[48:51], s19 offen sc1
s_add_u32 s19, s19, 5120
s_cmp_eq_u32 s19, s24
s_cmov_b32 s19, s25
s_waitcnt vmcnt(10)
buffer_load_dwordx4 v[96:99], v15, s[48:51], s19 offen sc1
buffer_load_dwordx4 v[100:103], v15, s[48:51], s19 offen offset:1024 sc1
buffer_load_dwordx4 v[104:107], v15, s[48:51], s19 offen offset:2048 sc1
buffer_load_dwordx4 v[108:111], v15, s[48:51], s19 offen offset:3072 sc1
buffer_load_dwordx4 v[112:115], v13, s[48:51], s19 offen sc1
s_add_u32 s19, s19, 5120
s_cmp_eq_u32 s19, s24
s_cmov_b32 s19, s25
s_waitcnt vmcnt(10)
s_add_u32 s12, s66, 0
s_and_b32 s12, s12, 3
s_mul_i32 s12, s12, 5120
s_add_u32 s13, s12, s29
s_add_u32 s12, s12, s11
s_add_u32 m0, s12, 0
s_add_u32 s77, s13, 0
buffer_load_dwordx4 v15, s[48:51], s77 offen sc1 lds
s_waitcnt vmcnt(2)
s_add_u32 m0, s12, 1024
s_add_u32 s77, s13, 1024
buffer_load_dwordx4 v15, s[48:51], s77 offen sc1 lds
s_waitcnt vmcnt(2)
s_add_u32 m0, s12, 2048
s_add_u32 s77, s13, 2048
buffer_load_dwordx4 v15, s[48:51], s77 offen sc1 lds
s_waitcnt vmcnt(2)
s_add_u32 m0, s12, 3072
s_add_u32 s77, s13, 3072
buffer_load_dwordx4 v15, s[48:51], s77 offen sc1 lds
s_waitcnt vmcnt(2)
s_add_u32 m0, s12, 4096
s_add_u32 s77, s13, 4096
buffer_load_dwordx4 v15, s[48:51], s77 offen sc1 lds
s_waitcnt vmcnt(2)
s_add_u32 s12, s66, 1
s_and_b32 s12, s12, 3
s_mul_i32 s12, s12, 5120
s_add_u32 s13, s12, s29
s_add_u32 s12, s12, s11
s_add_u32 m0, s12, 0
s_add_u32 s77, s13, 0
buffer_load_dwordx4 v15, s[48:51], s77 offen sc1 lds
s_waitcnt vmcnt(2)
s_add_u32 m0, s12, 1024
s_add_u32 s77, s13, 1024
buffer_load_dwordx4 v15, s[48:51], s77 offen sc1 lds
s_waitcnt vmcnt(2)
s_add_u32 m0, s12, 2048
s_add_u32 s77, s13, 2048
buffer_load_dwordx4 v15, s[48:51], s77 offen sc1 lds
s_waitcnt vmcnt(2)
s_add_u32 m0, s12, 3072
s_add_u32 s77, s13, 3072
buffer_load_dwordx4 v15, s[48:51], s77 offen sc1 lds
s_waitcnt vmcnt(2)
s_add_u32 m0, s12, 4096
s_add_u32 s77, s13, 4096
buffer_load_dwordx4 v15, s[48:51], s77 offen sc1 lds
s_waitcnt vmcnt(2)
s_add_u32 s12, s66, 2
s_and_b32 s12, s12, 3
s_mul_i32 s12, s12, 5120
s_add_u32 s13, s12, s29
s_add_u32 s12, s12, s11
s_add_u32 m0, s12, 0
s_add_u32 s77, s13, 0
buffer_load_dwordx4 v15, s[48:51], s77 offen sc1 lds
s_waitcnt vmcnt(2)
s_add_u32 m0, s12, 1024
s_add_u32 s77, s13, 1024
buffer_load_dwordx4 v15, s[48:51], s77 offen sc1 lds
s_waitcnt vmcnt(2)
s_add_u32 m0, s12, 2048
s_add_u32 s77, s13, 2048
buffer_load_dwordx4 v15, s[48:51], s77 offen sc1 lds
s_waitcnt vmcnt(2)
s_add_u32 m0, s12, 3072
s_add_u32 s77, s13, 3072
buffer_load_dwordx4 v15, s[48:51], s77 offen sc1 lds
s_waitcnt vmcnt(2)
s_add_u32 m0, s12, 4096
s_add_u32 s77, s13, 4096
buffer_load_dwordx4 v15, s[48:51], s77 offen sc1 lds
s_waitcnt vmcnt(2)
s_add_u32 s12, s66, 3
s_and_b32 s12, s12, 3
s_mul_i32 s12, s12, 5120
s_add_u32 s13, s12, s29
s_add_u32 s12, s12, s11
s_add_u32 m0, s12, 0
s_add_u32 s77, s13, 0
buffer_load_dwordx4 v15, s[48:51], s77 offen sc1 lds
s_waitcnt vmcnt(2)
s_add_u32 m0, s12, 1024
s_add_u32 s77, s13, 1024
buffer_load_dwordx4 v15, s[48:51], s77 offen sc1 lds
s_waitcnt vmcnt(2)
s_add_u32 m0, s12, 2048
s_add_u32 s77, s13, 2048
buffer_load_dwordx4 v15, s[48:51], s77 offen sc1 lds
s_waitcnt vmcnt(2)
s_add_u32 m0, s12, 3072
s_add_u32 s77, s13, 3072
buffer_load_dwordx4 v15, s[48:51], s77 offen sc1 lds
s_waitcnt vmcnt(2)
s_add_u32 m0, s12, 4096
s_add_u32 s77, s13, 4096
buffer_load_dwordx4 v15, s[48:51], s77 offen sc1 lds
s_waitcnt vmcnt(2)
s_mov_b32 s79, 0
L_sp_12:
s_load_dword s20, s[34:35], 0 glc
s_waitcnt lgkmcnt(0)
s_cmp_ge_u32 s20, 2
s_cbranch_scc1 L_spd_14
s_add_u32 s79, s79, 1
s_cmp_ge_u32 s79, 0x200000
s_cbranch_scc1 L_end
s_branch L_sp_12
L_spd_14:
buffer_load_dwordx4 v[116:119], v10, s[48:51], s16 offen sc1
buffer_load_dwordx4 v[120:123], v11, s[48:51], s16 offen sc1
buffer_load_dwordx4 v[124:127], v12, s[48:51], s16 offen sc1
buffer_load_dwordx4 v[128:131], v3, s[48:51], s16 offen sc1
s_add_u32 s16, s16, 4096
s_cmp_eq_u32 s16, s17
s_cmov_b32 s16, s18
buffer_load_dwordx4 v[132:135], v10, s[48:51], s16 offen sc1
buffer_load_dwordx4 v[136:139], v11, s[48:51], s16 offen sc1
buffer_load_dwordx4 v[140:143], v12, s[48:51], s16 offen sc1
buffer_load_dwordx4 v[144:147], v3, s[48:51], s16 offen sc1
s_add_u32 s16, s16, 4096
s_cmp_eq_u32 s16, s17
s_cmov_b32 s16, s18
s_waitcnt vmcnt(4)
v_mfma_f32_16x16x32_bf16 v[176:179], v[16:19], v[116:119], 0
v_mfma_f32_16x16x32_bf16 v[192:195], v[20:23], v[116:119], 0
buffer_load_dwordx4 v[148:151], v10, s[48:51], s16 offen sc1
v_mfma_f32_16x16x32_bf16 v[208:211], v[24:27], v[116:119], 0
v_mfma_f32_16x16x32_bf16 v[224:227], v[28:31], v[116:119], 0
buffer_load_dwordx4 v[152:155], v11, s[48:51], s16 offen sc1
v_mfma_f32_16x16x32_bf16 v[240:243], v[32:35], v[116:119], 0
v_mfma_f32_16x16x32_bf16 v[180:183], v[16:19], v[120:123], 0
buffer_load_dwordx4 v[156:159], v12, s[48:51], s16 offen sc1
v_mfma_f32_16x16x32_bf16 v[196:199], v[20:23], v[120:123], 0
v_mfma_f32_16x16x32_bf16 v[212:215], v[24:27], v[120:123], 0
buffer_load_dwordx4 v[160:163], v3, s[48:51], s16 offen sc1
s_add_u32 s16, s16, 4096
s_cmp_eq_u32 s16, s17
s_cmov_b32 s16, s18
v_mfma_f32_16x16x32_bf16 v[228:231], v[28:31], v[120:123], 0
v_mfma_f32_16x16x32_bf16 v[244:247], v[32:35], v[120:123], 0
v_mfma_f32_16x16x32_bf16 v[184:187], v[16:19], v[124:127], 0
v_mfma_f32_16x16x32_bf16 v[200:203], v[20:23], v[124:127], 0
v_mfma_f32_16x16x32_bf16 v[216:219], v[24:27], v[124:127], 0
v_mfma_f32_16x16x32_bf16 v[232:235], v[28:31], v[124:127], 0
v_mfma_f32_16x16x32_bf16 v[248:251], v[32:35], v[124:127], 0
v_mfma_f32_16x16x32_bf16 v[188:191], v[16:19], v[128:131], 0
v_mfma_f32_16x16x32_bf16 v[204:207], v[20:23], v[128:131], 0
v_mfma_f32_16x16x32_bf16 v[220:223], v[24:27], v[128:131], 0
v_mfma_f32_16x16x32_bf16 v[236:239], v[28:31], v[128:131], 0
v_mfma_f32_16x16x32_bf16 v[252:255], v[32:35], v[128:131], 0
s_waitcnt vmcnt(4)
v_mfma_f32_16x16x32_bf16 v[176:179], v[36:39], v[132:135], v[176:179]
v_mfma_f32_16x16x32_bf16 v[192:195], v[40:43], v[132:135], v[192:195]
buffer_load_dwordx4 v[164:167], v10, s[48:51], s16 offen sc1
v_mfma_f32_16x16x32_bf16 v[208:211], v[44:47], v[132:135], v[208:211]
v_mfma_f32_16x16x32_bf16 v[224:227], v[48:51], v[132:135], v[224:227]
buffer_load_dwordx4 v[116:119], v11, s[48:51], s16 offen sc1
v_mfma_f32_16x16x32_bf16 v[240:243], v[52:55], v[132:135], v[240:243]
v_mfma_f32_16x16x32_bf16 v[180:183], v[36:39], v[136:139], v[180:183]
buffer_load_dwordx4 v[120:123], v12, s[48:51], s16 offen sc1
v_mfma_f32_16x16x32_bf16 v[196:199], v[40:43], v[136:139], v[196:199]
v_mfma_f32_16x16x32_bf16 v[212:215], v[44:47], v[136:139], v[212:215]
buffer_load_dwordx4 v[124:127], v3, s[48:51], s16 offen sc1
s_add_u32 s16, s16, 4096
s_cmp_eq_u32 s16, s17
s_cmov_b32 s16, s18
v_mfma_f32_16x16x32_bf16 v[228:231], v[48:51], v[136:139], v[228:231]
v_mfma_f32_16x16x32_bf16 v[244:247], v[52:55], v[136:139], v[244:247]
v_mfma_f32_16x16x32_bf16 v[184:187], v[36:39], v[140:143], v[184:187]
v_mfma_f32_16x16x32_bf16 v[200:203], v[40:43], v[140:143], v[200:203]
v_mfma_f32_16x16x32_bf16 v[216:219], v[44:47], v[140:143], v[216:219]
v_mfma_f32_16x16x32_bf16 v[232:235], v[48:51], v[140:143], v[232:235]
v_mfma_f32_16x16x32_bf16 v[248:251], v[52:55], v[140:143], v[248:251]
v_mfma_f32_16x16x32_bf16 v[188:191], v[36:39], v[144:147], v[188:191]
v_mfma_f32_16x16x32_bf16 v[204:207], v[40:43], v[144:147], v[204:207]
v_mfma_f32_16x16x32_bf16 v[220:223], v[44:47], v[144:147], v[220:223]
v_mfma_f32_16x16x32_bf16 v[236:239], v[48:51], v[144:147], v[236:239]
v_mfma_f32_16x16x32_bf16 v[252:255], v[52:55], v[144:147], v[252:255]
s_waitcnt vmcnt(4)
v_mfma_f32_16x16x32_bf16 v[176:179], v[56:59], v[148:151], v[176:179]
v_mfma_f32_16x16x32_bf16 v[192:195], v[60:63], v[148:151], v[192:195]
buffer_load_dwordx4 v[128:131], v10, s[48:51], s16 offen sc1
v_mfma_f32_16x16x32_bf16 v[208:211], v[64:67], v[148:151], v[208:211]
v_mfma_f32_16x16x32_bf16 v[224:227], v[68:71], v[148:151], v[224:227]
buffer_load_dwordx4 v[16:19], v11, s[48:51], s16 offen sc1
v_mfma_f32_16x16x32_bf16 v[240:243], v[72:75], v[148:151], v[240:243]
v_mfma_f32_16x16x32_bf16 v[180:183], v[56:59], v[152:155], v[180:183]
buffer_load_dwordx4 v[20:23], v12, s[48:51], s16 offen sc1
v_mfma_f32_16x16x32_bf16 v[196:199], v[60:63], v[152:155], v[196:199]
v_mfma_f32_16x16x32_bf16 v[212:215], v[64:67], v[152:155], v[212:215]
buffer_load_dwordx4 v[24:27], v3, s[48:51], s16 offen sc1
s_add_u32 s16, s16, 4096
s_cmp_eq_u32 s16, s17
s_cmov_b32 s16, s18
v_mfma_f32_16x16x32_bf16 v[228:231], v[68:71], v[152:155], v[228:231]
v_mfma_f32_16x16x32_bf16 v[244:247], v[72:75], v[152:155], v[244:247]
v_mfma_f32_16x16x32_bf16 v[184:187], v[56:59], v[156:159], v[184:187]
v_mfma_f32_16x16x32_bf16 v[200:203], v[60:63], v[156:159], v[200:203]
v_mfma_f32_16x16x32_bf16 v[216:219], v[64:67], v[156:159], v[216:219]
v_mfma_f32_16x16x32_bf16 v[232:235], v[68:71], v[156:159], v[232:235]
v_mfma_f32_16x16x32_bf16 v[248:251], v[72:75], v[156:159], v[248:251]
v_mfma_f32_16x16x32_bf16 v[188:191], v[56:59], v[160:163], v[188:191]
v_mfma_f32_16x16x32_bf16 v[204:207], v[60:63], v[160:163], v[204:207]
v_mfma_f32_16x16x32_bf16 v[220:223], v[64:67], v[160:163], v[220:223]
v_mfma_f32_16x16x32_bf16 v[236:239], v[68:71], v[160:163], v[236:239]
v_mfma_f32_16x16x32_bf16 v[252:255], v[72:75], v[160:163], v[252:255]
s_waitcnt vmcnt(4)
v_mfma_f32_16x16x32_bf16 v[176:179], v[76:79], v[164:167], v[176:179]
v_mfma_f32_16x16x32_bf16 v[192:195], v[80:83], v[164:167], v[192:195]
buffer_load_dwordx4 v[28:31], v10, s[48:51], s16 offen sc1
v_mfma_f32_16x16x32_bf16 v[208:211], v[84:87], v[164:167], v[208:211]
v_mfma_f32_16x16x32_bf16 v[224:227], v[88:91], v[164:167], v[224:227]
buffer_load_dwordx4 v[32:35], v11, s[48:51], s16 offen sc1
v_mfma_f32_16x16x32_bf16 v[240:243], v[92:95], v[164:167], v[240:243]
v_mfma_f32_16x16x32_bf16 v[180:183], v[76:79], v[116:119], v[180:183]
buffer_load_dwordx4 v[132:135], v12, s[48:51], s16 offen sc1
v_mfma_f32_16x16x32_bf16 v[196:199], v[80:83], v[116:119], v[196:199]
v_mfma_f32_16x16x32_bf16 v[212:215], v[84:87], v[116:119], v[212:215]
buffer_load_dwordx4 v[136:139], v3, s[48:51], s16 offen sc1
s_add_u32 s16, s16, 4096
s_cmp_eq_u32 s16, s17
s_cmov_b32 s16, s18
v_mfma_f32_16x16x32_bf16 v[228:231], v[88:91], v[116:119], v[228:231]
v_mfma_f32_16x16x32_bf16 v[244:247], v[92:95], v[116:119], v[244:247]
buffer_load_dwordx4 v[140:143], v15, s[48:51], s19 offen sc1
v_mfma_f32_16x16x32_bf16 v[184:187], v[76:79], v[120:123], v[184:187]
v_mfma_f32_16x16x32_bf16 v[200:203], v[80:83], v[120:123], v[200:203]
buffer_load_dwordx4 v[144:147], v15, s[48:51], s19 offen offset:1024 sc1
v_mfma_f32_16x16x32_bf16 v[216:219], v[84:87], v[120:123], v[216:219]
v_mfma_f32_16x16x32_bf16 v[232:235], v[88:91], v[120:123], v[232:235]
buffer_load_dwordx4 v[36:39], v15, s[48:51], s19 offen offset:2048 sc1
v_mfma_f32_16x16x32_bf16 v[248:251], v[92:95], v[120:123], v[248:251]
v_mfma_f32_16x16x32_bf16 v[188:191], v[76:79], v[124:127], v[188:191]
buffer_load_dwordx4 v[40:43], v15, s[48:51], s19 offen offset:3072 sc1
v_mfma_f32_16x16x32_bf16 v[204:207], v[80:83], v[124:127], v[204:207]
v_mfma_f32_16x16x32_bf16 v[220:223], v[84:87], v[124:127], v[220:223]
buffer_load_dwordx4 v[44:47], v13, s[48:51], s19 offen sc1
s_add_u32 s19, s19, 5120
s_cmp_eq_u32 s19, s24
s_cmov_b32 s19, s25
v_mfma_f32_16x16x32_bf16 v[236:239], v[88:91], v[124:127], v[236:239]
v_mfma_f32_16x16x32_bf16 v[252:255], v[92:95], v[124:127], v[252:255]
s_waitcnt vmcnt(9)
v_mfma_f32_16x16x32_bf16 v[176:179], v[96:99], v[128:131], v[176:179]
v_mfma_f32_16x16x32_bf16 v[192:195], v[100:103], v[128:131], v[192:195]
buffer_load_dwordx4 v[48:51], v10, s[48:51], s16 offen sc1
v_mfma_f32_16x16x32_bf16 v[208:211], v[104:107], v[128:131], v[208:211]
v_mfma_f32_16x16x32_bf16 v[224:227], v[108:111], v[128:131], v[224:227]
buffer_load_dwordx4 v[52:55], v11, s[48:51], s16 offen sc1
v_mfma_f32_16x16x32_bf16 v[240:243], v[112:115], v[128:131], v[240:243]
v_mfma_f32_16x16x32_bf16 v[180:183], v[96:99], v[16:19], v[180:183]
buffer_load_dwordx4 v[148:151], v12, s[48:51], s16 offen sc1
v_mfma_f32_16x16x32_bf16 v[196:199], v[100:103], v[16:19], v[196:199]
v_mfma_f32_16x16x32_bf16 v[212:215], v[104:107], v[16:19], v[212:215]
buffer_load_dwordx4 v[152:155], v3, s[48:51], s16 offen sc1
s_add_u32 s16, s16, 4096
s_cmp_eq_u32 s16, s17
s_cmov_b32 s16, s18
v_mfma_f32_16x16x32_bf16 v[228:231], v[108:111], v[16:19], v[228:231]
v_mfma_f32_16x16x32_bf16 v[244:247], v[112:115], v[16:19], v[244:247]
buffer_load_dwordx4 v[156:159], v15, s[48:51], s19 offen sc1
v_mfma_f32_16x16x32_bf16 v[184:187], v[96:99], v[20:23], v[184:187]
v_mfma_f32_16x16x32_bf16 v[200:203], v[100:103], v[20:23], v[200:203]
buffer_load_dwordx4 v[160:163], v15, s[48:51], s19 offen offset:1024 sc1
v_mfma_f32_16x16x32_bf16 v[216:219], v[104:107], v[20:23], v[216:219]
v_mfma_f32_16x16x32_bf16 v[232:235], v[108:111], v[20:23], v[232:235]
buffer_load_dwordx4 v[56:59], v15, s[48:51], s19 offen offset:2048 sc1
v_mfma_f32_16x16x32_bf16 v[248:251], v[112:115], v[20:23], v[248:251]
v_mfma_f32_16x16x32_bf16 v[188:191], v[96:99], v[24:27], v[188:191]
buffer_load_dwordx4 v[60:63], v15, s[48:51], s19 offen offset:3072 sc1
v_mfma_f32_16x16x32_bf16 v[204:207], v[100:103], v[24:27], v[204:207]
v_mfma_f32_16x16x32_bf16 v[220:223], v[104:107], v[24:27], v[220:223]
buffer_load_dwordx4 v[64:67], v13, s[48:51], s19 offen sc1
s_add_u32 s19, s19, 5120
s_cmp_eq_u32 s19, s24
s_cmov_b32 s19, s25
v_mfma_f32_16x16x32_bf16 v[236:239], v[108:111], v[24:27], v[236:239]
v_mfma_f32_16x16x32_bf16 v[252:255], v[112:115], v[24:27], v[252:255]
s_waitcnt vmcnt(9)
v_mfma_f32_16x16x32_bf16 v[176:179], v[140:143], v[28:31], v[176:179]
v_mfma_f32_16x16x32_bf16 v[192:195], v[144:147], v[28:31], v[192:195]
buffer_load_dwordx4 v[68:71], v10, s[48:51], s16 offen sc1
v_mfma_f32_16x16x32_bf16 v[208:211], v[36:39], v[28:31], v[208:211]
v_mfma_f32_16x16x32_bf16 v[224:227], v[40:43], v[28:31], v[224:227]
buffer_load_dwordx4 v[72:75], v11, s[48:51], s16 offen sc1
v_mfma_f32_16x16x32_bf16 v[240:243], v[44:47], v[28:31], v[240:243]
v_mfma_f32_16x16x32_bf16 v[180:183], v[140:143], v[32:35], v[180:183]
buffer_load_dwordx4 v[164:167], v12, s[48:51], s16 offen sc1
v_mfma_f32_16x16x32_bf16 v[196:199], v[144:147], v[32:35], v[196:199]
v_mfma_f32_16x16x32_bf16 v[212:215], v[36:39], v[32:35], v[212:215]
buffer_load_dwordx4 v[116:119], v3, s[48:51], s16 offen sc1
s_add_u32 s16, s16, 4096
s_cmp_eq_u32 s16, s17
s_cmov_b32 s16, s18
v_mfma_f32_16x16x32_bf16 v[228:231], v[40:43], v[32:35], v[228:231]
v_mfma_f32_16x16x32_bf16 v[244:247], v[44:47], v[32:35], v[244:247]
buffer_load_dwordx4 v[120:123], v15, s[48:51], s19 offen sc1
v_mfma_f32_16x16x32_bf16 v[184:187], v[140:143], v[132:135], v[184:187]
v_mfma_f32_16x16x32_bf16 v[200:203], v[144:147], v[132:135], v[200:203]
buffer_load_dwordx4 v[124:127], v15, s[48:51], s19 offen offset:1024 sc1
v_mfma_f32_16x16x32_bf16 v[216:219], v[36:39], v[132:135], v[216:219]
v_mfma_f32_16x16x32_bf16 v[232:235], v[40:43], v[132:135], v[232:235]
buffer_load_dwordx4 v[76:79], v15, s[48:51], s19 offen offset:2048 sc1
v_mfma_f32_16x16x32_bf16 v[248:251], v[44:47], v[132:135], v[248:251]
v_mfma_f32_16x16x32_bf16 v[188:191], v[140:143], v[136:139], v[188:191]
buffer_load_dwordx4 v[80:83], v15, s[48:51], s19 offen offset:3072 sc1
v_mfma_f32_16x16x32_bf16 v[204:207], v[144:147], v[136:139], v[204:207]
v_mfma_f32_16x16x32_bf16 v[220:223], v[36:39], v[136:139], v[220:223]
buffer_load_dwordx4 v[84:87], v13, s[48:51], s19 offen sc1
s_add_u32 s19, s19, 5120
s_cmp_eq_u32 s19, s24
s_cmov_b32 s19, s25
v_mfma_f32_16x16x32_bf16 v[236:239], v[40:43], v[136:139], v[236:239]
v_mfma_f32_16x16x32_bf16 v[252:255], v[44:47], v[136:139], v[252:255]
s_waitcnt vmcnt(9)
v_mfma_f32_16x16x32_bf16 v[176:179], v[156:159], v[48:51], v[176:179]
v_mfma_f32_16x16x32_bf16 v[192:195], v[160:163], v[48:51], v[192:195]
s_cmp_eq_u32 s65, 3
s_cmov_b32 s16, 1073741824
buffer_load_dwordx4 v[88:91], v10, s[48:51], s16 offen sc1
v_mfma_f32_16x16x32_bf16 v[208:211], v[56:59], v[48:51], v[208:211]
v_mfma_f32_16x16x32_bf16 v[224:227], v[60:63], v[48:51], v[224:227]
buffer_load_dwordx4 v[92:95], v11, s[48:51], s16 offen sc1
v_mfma_f32_16x16x32_bf16 v[240:243], v[64:67], v[48:51], v[240:243]
v_mfma_f32_16x16x32_bf16 v[180:183], v[156:159], v[52:55], v[180:183]
buffer_load_dwordx4 v[128:131], v12, s[48:51], s16 offen sc1
v_mfma_f32_16x16x32_bf16 v[196:199], v[160:163], v[52:55], v[196:199]
v_mfma_f32_16x16x32_bf16 v[212:215], v[56:59], v[52:55], v[212:215]
buffer_load_dwordx4 v[16:19], v3, s[48:51], s16 offen sc1
s_add_u32 s16, s16, 4096
s_cmp_eq_u32 s16, s17
s_cmov_b32 s16, s18
v_mfma_f32_16x16x32_bf16 v[228:231], v[60:63], v[52:55], v[228:231]
v_mfma_f32_16x16x32_bf16 v[244:247], v[64:67], v[52:55], v[244:247]
s_cmp_eq_u32 s65, 3
s_cmov_b32 s19, 1073741824
buffer_load_dwordx4 v[20:23], v15, s[48:51], s19 offen sc1
v_mfma_f32_16x16x32_bf16 v[184:187], v[156:159], v[148:151], v[184:187]
v_mfma_f32_16x16x32_bf16 v[200:203], v[160:163], v[148:151], v[200:203]
buffer_load_dwordx4 v[24:27], v15, s[48:51], s19 offen offset:1024 sc1
v_mfma_f32_16x16x32_bf16 v[216:219], v[56:59], v[148:151], v[216:219]
v_mfma_f32_16x16x32_bf16 v[232:235], v[60:63], v[148:151], v[232:235]
buffer_load_dwordx4 v[96:99], v15, s[48:51], s19 offen offset:2048 sc1
v_mfma_f32_16x16x32_bf16 v[248:251], v[64:67], v[148:151], v[248:251]
v_mfma_f32_16x16x32_bf16 v[188:191], v[156:159], v[152:155], v[188:191]
buffer_load_dwordx4 v[100:103], v15, s[48:51], s19 offen offset:3072 sc1
v_mfma_f32_16x16x32_bf16 v[204:207], v[160:163], v[152:155], v[204:207]
v_mfma_f32_16x16x32_bf16 v[220:223], v[56:59], v[152:155], v[220:223]
buffer_load_dwordx4 v[104:107], v13, s[48:51], s19 offen sc1
s_add_u32 s19, s19, 5120
s_cmp_eq_u32 s19, s24
s_cmov_b32 s19, s25
v_mfma_f32_16x16x32_bf16 v[236:239], v[60:63], v[152:155], v[236:239]
v_mfma_f32_16x16x32_bf16 v[252:255], v[64:67], v[152:155], v[252:255]
s_add_u32 s34, s34, 4
s_load_dword s20, s[34:35], 0 glc
s_waitcnt vmcnt(9)
v_mfma_f32_16x16x32_bf16 v[176:179], v[120:123], v[68:71], v[176:179]
v_mfma_f32_16x16x32_bf16 v[192:195], v[124:127], v[68:71], v[192:195]
buffer_load_dwordx4 v[108:111], v10, s[48:51], s16 offen sc1
v_mfma_f32_16x16x32_bf16 v[208:211], v[76:79], v[68:71], v[208:211]
v_mfma_f32_16x16x32_bf16 v[224:227], v[80:83], v[68:71], v[224:227]
buffer_load_dwordx4 v[112:115], v11, s[48:51], s16 offen sc1
v_mfma_f32_16x16x32_bf16 v[240:243], v[84:87], v[68:71], v[240:243]
v_mfma_f32_16x16x32_bf16 v[180:183], v[120:123], v[72:75], v[180:183]
buffer_load_dwordx4 v[28:31], v12, s[48:51], s16 offen sc1
v_mfma_f32_16x16x32_bf16 v[196:199], v[124:127], v[72:75], v[196:199]
v_mfma_f32_16x16x32_bf16 v[212:215], v[76:79], v[72:75], v[212:215]
buffer_load_dwordx4 v[32:35], v3, s[48:51], s16 offen sc1
s_add_u32 s16, s16, 4096
s_cmp_eq_u32 s16, s17
s_cmov_b32 s16, s18
v_mfma_f32_16x16x32_bf16 v[228:231], v[80:83], v[72:75], v[228:231]
v_mfma_f32_16x16x32_bf16 v[244:247], v[84:87], v[72:75], v[244:247]
buffer_load_dwordx4 v[132:135], v15, s[48:51], s19 offen sc1
v_mfma_f32_16x16x32_bf16 v[184:187], v[120:123], v[164:167], v[184:187]
v_mfma_f32_16x16x32_bf16 v[200:203], v[124:127], v[164:167], v[200:203]
buffer_load_dwordx4 v[136:139], v15, s[48:51], s19 offen offset:1024 sc1
v_mfma_f32_16x16x32_bf16 v[216:219], v[76:79], v[164:167], v[216:219]
v_mfma_f32_16x16x32_bf16 v[232:235], v[80:83], v[164:167], v[232:235]
buffer_load_dwordx4 v[140:143], v15, s[48:51], s19 offen offset:2048 sc1
v_mfma_f32_16x16x32_bf16 v[248:251], v[84:87], v[164:167], v[248:251]
v_mfma_f32_16x16x32_bf16 v[188:191], v[120:123], v[116:119], v[188:191]
buffer_load_dwordx4 v[144:147], v15, s[48:51], s19 offen offset:3072 sc1
v_mfma_f32_16x16x32_bf16 v[204:207], v[124:127], v[116:119], v[204:207]
v_mfma_f32_16x16x32_bf16 v[220:223], v[76:79], v[116:119], v[220:223]
buffer_load_dwordx4 v[36:39], v13, s[48:51], s19 offen sc1
s_add_u32 s19, s19, 5120
s_cmp_eq_u32 s19, s24
s_cmov_b32 s19, s25
v_mfma_f32_16x16x32_bf16 v[236:239], v[80:83], v[116:119], v[236:239]
v_mfma_f32_16x16x32_bf16 v[252:255], v[84:87], v[116:119], v[252:255]
s_mov_b32 s79, 0
s_waitcnt lgkmcnt(0)
s_cmp_ge_u32 s20, 2
s_cbranch_scc1 L_spd_17
L_sp_15:
s_load_dword s20, s[34:35], 0 glc
s_waitcnt lgkmcnt(0)
s_cmp_ge_u32 s20, 2
s_cbranch_scc1 L_spd_17
s_add_u32 s79, s79, 1
s_cmp_ge_u32 s79, 0x200000
s_cbranch_scc1 L_end
s_branch L_sp_15
L_spd_17:
s_xor_b32 s76, s43, 0
s_lshl_b32 s76, s76, 6
s_add_u32 s76, s76, s10
buffer_load_dword v2, v173, s[48:51], s76 offen sc1
s_xor_b32 s76, s43, 1
s_lshl_b32 s76, s76, 6
s_add_u32 s76, s76, s10
buffer_load_dword v168, v173, s[48:51], s76 offen sc1
s_xor_b32 s76, s43, 2
s_lshl_b32 s76, s76, 6
s_add_u32 s76, s76, s10
buffer_load_dword v170, v173, s[48:51], s76 offen sc1
s_xor_b32 s76, s43, 3
s_lshl_b32 s76, s76, 6
s_add_u32 s76, s76, s10
buffer_load_dword v172, v173, s[48:51], s76 offen sc1
s_waitcnt vmcnt(13)
v_mfma_f32_16x16x32_bf16 v[176:179], v[20:23], v[88:91], v[176:179]
v_mfma_f32_16x16x32_bf16 v[192:195], v[24:27], v[88:91], v[192:195]
buffer_load_dwordx4 v[40:43], v10, s[48:51], s26 offen sc1
v_mfma_f32_16x16x32_bf16 v[208:211], v[96:99], v[88:91], v[208:211]
v_mfma_f32_16x16x32_bf16 v[224:227], v[100:103], v[88:91], v[224:227]
buffer_load_dwordx4 v[44:47], v11, s[48:51], s26 offen sc1
v_mfma_f32_16x16x32_bf16 v[240:243], v[104:107], v[88:91], v[240:243]
v_mfma_f32_16x16x32_bf16 v[180:183], v[20:23], v[92:95], v[180:183]
buffer_load_dwordx4 v[48:51], v12, s[48:51], s26 offen sc1
v_mfma_f32_16x16x32_bf16 v[196:199], v[24:27], v[92:95], v[196:199]
v_mfma_f32_16x16x32_bf16 v[212:215], v[96:99], v[92:95], v[212:215]
buffer_load_dwordx4 v[52:55], v3, s[48:51], s26 offen sc1
s_add_u32 s26, s26, 4096
v_mfma_f32_16x16x32_bf16 v[228:231], v[100:103], v[92:95], v[228:231]
v_mfma_f32_16x16x32_bf16 v[244:247], v[104:107], v[92:95], v[244:247]
buffer_load_dwordx4 v[148:151], v15, s[48:51], s27 offen sc1
v_mfma_f32_16x16x32_bf16 v[184:187], v[20:23], v[128:131], v[184:187]
v_mfma_f32_16x16x32_bf16 v[200:203], v[24:27], v[128:131], v[200:203]
buffer_load_dwordx4 v[152:155], v15, s[48:51], s27 offen offset:1024 sc1
v_mfma_f32_16x16x32_bf16 v[216:219], v[96:99], v[128:131], v[216:219]
v_mfma_f32_16x16x32_bf16 v[232:235], v[100:103], v[128:131], v[232:235]
buffer_load_dwordx4 v[156:159], v15, s[48:51], s27 offen offset:2048 sc1
v_mfma_f32_16x16x32_bf16 v[248:251], v[104:107], v[128:131], v[248:251]
v_mfma_f32_16x16x32_bf16 v[188:191], v[20:23], v[16:19], v[188:191]
buffer_load_dwordx4 v[160:163], v15, s[48:51], s27 offen offset:3072 sc1
v_mfma_f32_16x16x32_bf16 v[204:207], v[24:27], v[16:19], v[204:207]
v_mfma_f32_16x16x32_bf16 v[220:223], v[96:99], v[16:19], v[220:223]
buffer_load_dwordx4 v[56:59], v13, s[48:51], s27 offen sc1
s_add_u32 s27, s27, 5120
v_mfma_f32_16x16x32_bf16 v[236:239], v[100:103], v[16:19], v[236:239]
v_mfma_f32_16x16x32_bf16 v[252:255], v[104:107], v[16:19], v[252:255]
s_waitcnt vmcnt(13)
v_mfma_f32_16x16x32_bf16 v[176:179], v[132:135], v[108:111], v[176:179]
v_mfma_f32_16x16x32_bf16 v[192:195], v[136:139], v[108:111], v[192:195]
buffer_load_dwordx4 v[60:63], v10, s[48:51], s26 offen sc1
v_mfma_f32_16x16x32_bf16 v[208:211], v[140:143], v[108:111], v[208:211]
v_mfma_f32_16x16x32_bf16 v[224:227], v[144:147], v[108:111], v[224:227]
buffer_load_dwordx4 v[64:67], v11, s[48:51], s26 offen sc1
v_mfma_f32_16x16x32_bf16 v[240:243], v[36:39], v[108:111], v[240:243]
v_mfma_f32_16x16x32_bf16 v[180:183], v[132:135], v[112:115], v[180:183]
buffer_load_dwordx4 v[68:71], v12, s[48:51], s26 offen sc1
v_mfma_f32_16x16x32_bf16 v[196:199], v[136:139], v[112:115], v[196:199]
v_mfma_f32_16x16x32_bf16 v[212:215], v[140:143], v[112:115], v[212:215]
buffer_load_dwordx4 v[72:75], v3, s[48:51], s26 offen sc1
s_add_u32 s26, s26, 4096
v_mfma_f32_16x16x32_bf16 v[228:231], v[144:147], v[112:115], v[228:231]
v_mfma_f32_16x16x32_bf16 v[244:247], v[36:39], v[112:115], v[244:247]
buffer_load_dwordx4 v[164:167], v15, s[48:51], s27 offen sc1
v_mfma_f32_16x16x32_bf16 v[184:187], v[132:135], v[28:31], v[184:187]
v_mfma_f32_16x16x32_bf16 v[200:203], v[136:139], v[28:31], v[200:203]
buffer_load_dwordx4 v[116:119], v15, s[48:51], s27 offen offset:1024 sc1
v_mfma_f32_16x16x32_bf16 v[216:219], v[140:143], v[28:31], v[216:219]
v_mfma_f32_16x16x32_bf16 v[232:235], v[144:147], v[28:31], v[232:235]
buffer_load_dwordx4 v[120:123], v15, s[48:51], s27 offen offset:2048 sc1
v_mfma_f32_16x16x32_bf16 v[248:251], v[36:39], v[28:31], v[248:251]
v_mfma_f32_16x16x32_bf16 v[188:191], v[132:135], v[32:35], v[188:191]
buffer_load_dwordx4 v[124:127], v15, s[48:51], s27 offen offset:3072 sc1
v_mfma_f32_16x16x32_bf16 v[204:207], v[136:139], v[32:35], v[204:207]
v_mfma_f32_16x16x32_bf16 v[220:223], v[140:143], v[32:35], v[220:223]
buffer_load_dwordx4 v[76:79], v13, s[48:51], s27 offen sc1
s_add_u32 s27, s27, 5120
v_mfma_f32_16x16x32_bf16 v[236:239], v[144:147], v[32:35], v[236:239]
v_mfma_f32_16x16x32_bf16 v[252:255], v[36:39], v[32:35], v[252:255]
s_waitcnt vmcnt(9)
v_mfma_f32_16x16x32_bf16 v[176:179], v[148:151], v[40:43], v[176:179]
v_mfma_f32_16x16x32_bf16 v[192:195], v[152:155], v[40:43], v[192:195]
buffer_load_dwordx4 v[80:83], v10, s[48:51], s26 offen sc1
v_mfma_f32_16x16x32_bf16 v[208:211], v[156:159], v[40:43], v[208:211]
v_mfma_f32_16x16x32_bf16 v[224:227], v[160:163], v[40:43], v[224:227]
buffer_load_dwordx4 v[84:87], v11, s[48:51], s26 offen sc1
v_mfma_f32_16x16x32_bf16 v[240:243], v[56:59], v[40:43], v[240:243]
v_mfma_f32_16x16x32_bf16 v[180:183], v[148:151], v[44:47], v[180:183]
buffer_load_dwordx4 v[88:91], v12, s[48:51], s26 offen sc1
v_mfma_f32_16x16x32_bf16 v[196:199], v[152:155], v[44:47], v[196:199]
v_mfma_f32_16x16x32_bf16 v[212:215], v[156:159], v[44:47], v[212:215]
buffer_load_dwordx4 v[92:95], v3, s[48:51], s26 offen sc1
s_add_u32 s26, s26, 4096
v_mfma_f32_16x16x32_bf16 v[228:231], v[160:163], v[44:47], v[228:231]
v_mfma_f32_16x16x32_bf16 v[244:247], v[56:59], v[44:47], v[244:247]
buffer_load_dwordx4 v[128:131], v15, s[48:51], s27 offen sc1
v_mfma_f32_16x16x32_bf16 v[184:187], v[148:151], v[48:51], v[184:187]
v_mfma_f32_16x16x32_bf16 v[200:203], v[152:155], v[48:51], v[200:203]
buffer_load_dwordx4 v[16:19], v15, s[48:51], s27 offen offset:1024 sc1
v_mfma_f32_16x16x32_bf16 v[216:219], v[156:159], v[48:51], v[216:219]
v_mfma_f32_16x16x32_bf16 v[232:235], v[160:163], v[48:51], v[232:235]
buffer_load_dwordx4 v[20:23], v15, s[48:51], s27 offen offset:2048 sc1
v_mfma_f32_16x16x32_bf16 v[248:251], v[56:59], v[48:51], v[248:251]
v_mfma_f32_16x16x32_bf16 v[188:191], v[148:151], v[52:55], v[188:191]
buffer_load_dwordx4 v[24:27], v15, s[48:51], s27 offen offset:3072 sc1
v_mfma_f32_16x16x32_bf16 v[204:207], v[152:155], v[52:55], v[204:207]
v_mfma_f32_16x16x32_bf16 v[220:223], v[156:159], v[52:55], v[220:223]
buffer_load_dwordx4 v[96:99], v13, s[48:51], s27 offen sc1
s_add_u32 s27, s27, 5120
v_mfma_f32_16x16x32_bf16 v[236:239], v[160:163], v[52:55], v[236:239]
v_mfma_f32_16x16x32_bf16 v[252:255], v[56:59], v[52:55], v[252:255]
s_waitcnt vmcnt(9)
v_mfma_f32_16x16x32_bf16 v[176:179], v[164:167], v[60:63], v[176:179]
v_mfma_f32_16x16x32_bf16 v[192:195], v[116:119], v[60:63], v[192:195]
buffer_load_dwordx4 v[100:103], v10, s[48:51], s26 offen sc1
v_mfma_f32_16x16x32_bf16 v[208:211], v[120:123], v[60:63], v[208:211]
v_mfma_f32_16x16x32_bf16 v[224:227], v[124:127], v[60:63], v[224:227]
buffer_load_dwordx4 v[104:107], v11, s[48:51], s26 offen sc1
v_mfma_f32_16x16x32_bf16 v[240:243], v[76:79], v[60:63], v[240:243]
v_mfma_f32_16x16x32_bf16 v[180:183], v[164:167], v[64:67], v[180:183]
buffer_load_dwordx4 v[108:111], v12, s[48:51], s26 offen sc1
v_mfma_f32_16x16x32_bf16 v[196:199], v[116:119], v[64:67], v[196:199]
v_mfma_f32_16x16x32_bf16 v[212:215], v[120:123], v[64:67], v[212:215]
buffer_load_dwordx4 v[112:115], v3, s[48:51], s26 offen sc1
s_add_u32 s26, s26, 4096
v_mfma_f32_16x16x32_bf16 v[228:231], v[124:127], v[64:67], v[228:231]
v_mfma_f32_16x16x32_bf16 v[244:247], v[76:79], v[64:67], v[244:247]
buffer_load_dwordx4 v[28:31], v15, s[48:51], s27 offen sc1
v_mfma_f32_16x16x32_bf16 v[184:187], v[164:167], v[68:71], v[184:187]
v_mfma_f32_16x16x32_bf16 v[200:203], v[116:119], v[68:71], v[200:203]
buffer_load_dwordx4 v[32:35], v15, s[48:51], s27 offen offset:1024 sc1
v_mfma_f32_16x16x32_bf16 v[216:219], v[120:123], v[68:71], v[216:219]
v_mfma_f32_16x16x32_bf16 v[232:235], v[124:127], v[68:71], v[232:235]
buffer_load_dwordx4 v[132:135], v15, s[48:51], s27 offen offset:2048 sc1
v_mfma_f32_16x16x32_bf16 v[248:251], v[76:79], v[68:71], v[248:251]
v_mfma_f32_16x16x32_bf16 v[188:191], v[164:167], v[72:75], v[188:191]
buffer_load_dwordx4 v[136:139], v15, s[48:51], s27 offen offset:3072 sc1
v_mfma_f32_16x16x32_bf16 v[204:207], v[116:119], v[72:75], v[204:207]
v_mfma_f32_16x16x32_bf16 v[220:223], v[120:123], v[72:75], v[220:223]
buffer_load_dwordx4 v[140:143], v13, s[48:51], s27 offen sc1
s_add_u32 s27, s27, 5120
v_mfma_f32_16x16x32_bf16 v[236:239], v[124:127], v[72:75], v[236:239]
v_mfma_f32_16x16x32_bf16 v[252:255], v[76:79], v[72:75], v[252:255]
s_waitcnt vmcnt(9)
v_mfma_f32_16x16x32_bf16 v[176:179], v[128:131], v[80:83], v[176:179]
v_mfma_f32_16x16x32_bf16 v[192:195], v[16:19], v[80:83], v[192:195]
s_add_u32 s77, s29, 20480
buffer_load_dwordx4 v[144:147], v15, s[48:51], s77 offen sc1
v_mfma_f32_16x16x32_bf16 v[208:211], v[20:23], v[80:83], v[208:211]
v_mfma_f32_16x16x32_bf16 v[224:227], v[24:27], v[80:83], v[224:227]
buffer_load_dwordx4 v[36:39], v15, s[48:51], s77 offen offset:1024 sc1
v_mfma_f32_16x16x32_bf16 v[240:243], v[96:99], v[80:83], v[240:243]
v_mfma_f32_16x16x32_bf16 v[180:183], v[128:131], v[84:87], v[180:183]
buffer_load_dwordx4 v[40:43], v15, s[48:51], s77 offen offset:2048 sc1
v_mfma_f32_16x16x32_bf16 v[196:199], v[16:19], v[84:87], v[196:199]
v_mfma_f32_16x16x32_bf16 v[212:215], v[20:23], v[84:87], v[212:215]
buffer_load_dwordx4 v[44:47], v15, s[48:51], s77 offen offset:3072 sc1
v_mfma_f32_16x16x32_bf16 v[228:231], v[24:27], v[84:87], v[228:231]
v_mfma_f32_16x16x32_bf16 v[244:247], v[96:99], v[84:87], v[244:247]
buffer_load_dwordx4 v[48:51], v13, s[48:51], s77 offen sc1
v_mfma_f32_16x16x32_bf16 v[184:187], v[128:131], v[88:91], v[184:187]
v_mfma_f32_16x16x32_bf16 v[200:203], v[16:19], v[88:91], v[200:203]
v_mfma_f32_16x16x32_bf16 v[216:219], v[20:23], v[88:91], v[216:219]
v_mfma_f32_16x16x32_bf16 v[232:235], v[24:27], v[88:91], v[232:235]
v_mfma_f32_16x16x32_bf16 v[248:251], v[96:99], v[88:91], v[248:251]
v_mfma_f32_16x16x32_bf16 v[188:191], v[128:131], v[92:95], v[188:191]
v_mfma_f32_16x16x32_bf16 v[204:207], v[16:19], v[92:95], v[204:207]
v_mfma_f32_16x16x32_bf16 v[220:223], v[20:23], v[92:95], v[220:223]
v_mfma_f32_16x16x32_bf16 v[236:239], v[24:27], v[92:95], v[236:239]
v_mfma_f32_16x16x32_bf16 v[252:255], v[96:99], v[92:95], v[252:255]
s_waitcnt vmcnt(5)
v_mfma_f32_16x16x32_bf16 v[176:179], v[28:31], v[100:103], v[176:179]
v_mfma_f32_16x16x32_bf16 v[192:195], v[32:35], v[100:103], v[192:195]
v_mfma_f32_16x16x32_bf16 v[208:211], v[132:135], v[100:103], v[208:211]
v_mfma_f32_16x16x32_bf16 v[224:227], v[136:139], v[100:103], v[224:227]
v_mfma_f32_16x16x32_bf16 v[240:243], v[140:143], v[100:103], v[240:243]
v_mfma_f32_16x16x32_bf16 v[180:183], v[28:31], v[104:107], v[180:183]
v_mfma_f32_16x16x32_bf16 v[196:199], v[32:35], v[104:107], v[196:199]
v_mfma_f32_16x16x32_bf16 v[212:215], v[132:135], v[104:107], v[212:215]
v_mfma_f32_16x16x32_bf16 v[228:231], v[136:139], v[104:107], v[228:231]
v_mfma_f32_16x16x32_bf16 v[244:247], v[140:143], v[104:107], v[244:247]
v_mfma_f32_16x16x32_bf16 v[184:187], v[28:31], v[108:111], v[184:187]
v_mfma_f32_16x16x32_bf16 v[200:203], v[32:35], v[108:111], v[200:203]
v_mfma_f32_16x16x32_bf16 v[216:219], v[132:135], v[108:111], v[216:219]
v_mfma_f32_16x16x32_bf16 v[232:235], v[136:139], v[108:111], v[232:235]
v_mfma_f32_16x16x32_bf16 v[248:251], v[140:143], v[108:111], v[248:251]
v_mfma_f32_16x16x32_bf16 v[188:191], v[28:31], v[112:115], v[188:191]
v_mfma_f32_16x16x32_bf16 v[204:207], v[32:35], v[112:115], v[204:207]
v_mfma_f32_16x16x32_bf16 v[220:223], v[132:135], v[112:115], v[220:223]
v_mfma_f32_16x16x32_bf16 v[236:239], v[136:139], v[112:115], v[236:239]
v_mfma_f32_16x16x32_bf16 v[252:255], v[140:143], v[112:115], v[252:255]
s_add_u32 s34, s34, 4
s_setprio 3
v_mov_b32 v174, 133168
s_mov_b32 s79, 0
L_lw_18:
ds_read_b32 v175, v174
s_waitcnt lgkmcnt(0)
v_readfirstlane_b32 s78, v175
s_nop 1
s_cmp_ge_u32 s78, 4
s_cbranch_scc1 L_lwd_19
s_add_u32 s79, s79, 1
s_cmp_ge_u32 s79, 0x1000000
s_cbranch_scc1 L_end
s_sleep 1
s_branch L_lw_18
L_lwd_19:
s_setprio 0
v_lshrrev_b32 v173, 4, v0
v_mul_u32_u24 v173, 40, v173
v_add_u32 v173, 162304, v173
ds_read_b64 v[52:53], v173 offset:0
ds_read_b64 v[54:55], v173 offset:8
ds_read_b64 v[148:149], v173 offset:16
ds_read_b64 v[150:151], v173 offset:24
ds_read_b64 v[152:153], v173 offset:32
s_waitcnt lgkmcnt(0)
v_lshlrev_b32 v174, 16, v52
v_and_b32 v175, 0xffff0000, v52
v_pk_add_f32 v[176:177], v[176:177], v[174:175]
v_lshlrev_b32 v174, 16, v53
v_and_b32 v175, 0xffff0000, v53
v_pk_add_f32 v[178:179], v[178:179], v[174:175]
v_lshlrev_b32 v174, 16, v54
v_and_b32 v175, 0xffff0000, v54
v_pk_add_f32 v[192:193], v[192:193], v[174:175]
v_lshlrev_b32 v174, 16, v55
v_and_b32 v175, 0xffff0000, v55
v_pk_add_f32 v[194:195], v[194:195], v[174:175]
v_lshlrev_b32 v174, 16, v148
v_and_b32 v175, 0xffff0000, v148
v_pk_add_f32 v[208:209], v[208:209], v[174:175]
v_lshlrev_b32 v174, 16, v149
v_and_b32 v175, 0xffff0000, v149
v_pk_add_f32 v[210:211], v[210:211], v[174:175]
v_lshlrev_b32 v174, 16, v150
v_and_b32 v175, 0xffff0000, v150
v_pk_add_f32 v[224:225], v[224:225], v[174:175]
v_lshlrev_b32 v174, 16, v151
v_and_b32 v175, 0xffff0000, v151
v_pk_add_f32 v[226:227], v[226:227], v[174:175]
v_lshlrev_b32 v174, 16, v152
v_and_b32 v175, 0xffff0000, v152
v_pk_add_f32 v[240:241], v[240:241], v[174:175]
v_lshlrev_b32 v174, 16, v153
v_and_b32 v175, 0xffff0000, v153
v_pk_add_f32 v[242:243], v[242:243], v[174:175]
s_load_dword s20, s[34:35], 0 glc
ds_read_b128 v[156:159], v171 offset:0
ds_read_b128 v[160:163], v171 offset:1024
ds_read_b128 v[56:59], v171 offset:2048
ds_read_b128 v[60:63], v171 offset:3072
ds_read_b128 v[64:67], v171 offset:4096
ds_read_b128 v[68:71], v171 offset:5120
ds_read_b128 v[72:75], v171 offset:6144
ds_read_b128 v[164:167], v171 offset:7168
ds_read_b128 v[116:119], v171 offset:8192
ds_read_b128 v[120:123], v171 offset:9216
ds_read_b128 v[124:127], v171 offset:10240
ds_read_b128 v[76:79], v171 offset:11264
ds_read_b128 v[80:83], v171 offset:12288
v_sub_f32 v2, 1.0, v2
v_sub_f32 v168, 1.0, v168
v_sub_f32 v170, 1.0, v170
v_sub_f32 v172, 1.0, v172
v_pk_mul_f32 v[188:189], v[188:189], v[172:173] op_sel_hi:[1,0]
v_pk_mul_f32 v[190:191], v[190:191], v[172:173] op_sel_hi:[1,0]
v_pk_mul_f32 v[204:205], v[204:205], v[172:173] op_sel_hi:[1,0]
v_pk_mul_f32 v[206:207], v[206:207], v[172:173] op_sel_hi:[1,0]
v_pk_mul_f32 v[220:221], v[220:221], v[172:173] op_sel_hi:[1,0]
v_pk_mul_f32 v[222:223], v[222:223], v[172:173] op_sel_hi:[1,0]
v_pk_mul_f32 v[236:237], v[236:237], v[172:173] op_sel_hi:[1,0]
v_pk_mul_f32 v[238:239], v[238:239], v[172:173] op_sel_hi:[1,0]
v_pk_mul_f32 v[252:253], v[252:253], v[172:173] op_sel_hi:[1,0]
v_pk_mul_f32 v[254:255], v[254:255], v[172:173] op_sel_hi:[1,0]
v_pk_mul_f32 v[184:185], v[184:185], v[170:171] op_sel_hi:[1,0]
v_pk_mul_f32 v[186:187], v[186:187], v[170:171] op_sel_hi:[1,0]
v_pk_mul_f32 v[200:201], v[200:201], v[170:171] op_sel_hi:[1,0]
v_pk_mul_f32 v[202:203], v[202:203], v[170:171] op_sel_hi:[1,0]
v_pk_mul_f32 v[216:217], v[216:217], v[170:171] op_sel_hi:[1,0]
v_pk_mul_f32 v[218:219], v[218:219], v[170:171] op_sel_hi:[1,0]
v_pk_mul_f32 v[232:233], v[232:233], v[170:171] op_sel_hi:[1,0]
v_pk_mul_f32 v[234:235], v[234:235], v[170:171] op_sel_hi:[1,0]
v_pk_mul_f32 v[248:249], v[248:249], v[170:171] op_sel_hi:[1,0]
v_pk_mul_f32 v[250:251], v[250:251], v[170:171] op_sel_hi:[1,0]
v_pk_mul_f32 v[180:181], v[180:181], v[168:169] op_sel_hi:[1,0]
v_pk_mul_f32 v[182:183], v[182:183], v[168:169] op_sel_hi:[1,0]
v_pk_mul_f32 v[196:197], v[196:197], v[168:169] op_sel_hi:[1,0]
v_pk_mul_f32 v[198:199], v[198:199], v[168:169] op_sel_hi:[1,0]
v_pk_mul_f32 v[212:213], v[212:213], v[168:169] op_sel_hi:[1,0]
v_pk_mul_f32 v[214:215], v[214:215], v[168:169] op_sel_hi:[1,0]
v_pk_mul_f32 v[228:229], v[228:229], v[168:169] op_sel_hi:[1,0]
v_pk_mul_f32 v[230:231], v[230:231], v[168:169] op_sel_hi:[1,0]
v_pk_mul_f32 v[244:245], v[244:245], v[168:169] op_sel_hi:[1,0]
v_pk_mul_f32 v[246:247], v[246:247], v[168:169] op_sel_hi:[1,0]
v_pk_mul_f32 v[176:177], v[176:177], v[2:3] op_sel_hi:[1,0]
v_pk_mul_f32 v[178:179], v[178:179], v[2:3] op_sel_hi:[1,0]
v_pk_mul_f32 v[192:193], v[192:193], v[2:3] op_sel_hi:[1,0]
v_pk_mul_f32 v[194:195], v[194:195], v[2:3] op_sel_hi:[1,0]
v_pk_mul_f32 v[208:209], v[208:209], v[2:3] op_sel_hi:[1,0]
v_pk_mul_f32 v[210:211], v[210:211], v[2:3] op_sel_hi:[1,0]
v_pk_mul_f32 v[224:225], v[224:225], v[2:3] op_sel_hi:[1,0]
v_pk_mul_f32 v[226:227], v[226:227], v[2:3] op_sel_hi:[1,0]
v_pk_mul_f32 v[240:241], v[240:241], v[2:3] op_sel_hi:[1,0]
v_pk_mul_f32 v[242:243], v[242:243], v[2:3] op_sel_hi:[1,0]
s_xor_b32 s76, s65, 0
s_mul_i32 s77, s76, 15360
s_cmp_eq_u32 s76, 3
s_cmov_b32 s77, 114688
v_add_u32 v2, s77, v15
s_xor_b32 s76, s65, 1
s_mul_i32 s77, s76, 15360
s_cmp_eq_u32 s76, 3
s_cmov_b32 s77, 114688
v_add_u32 v168, s77, v15
s_xor_b32 s76, s65, 2
s_mul_i32 s77, s76, 15360
s_cmp_eq_u32 s76, 3
s_cmov_b32 s77, 114688
v_add_u32 v170, s77, v15
s_xor_b32 s76, s65, 3
s_mul_i32 s77, s76, 15360
s_cmp_eq_u32 s76, 3
s_cmov_b32 s77, 114688
v_add_u32 v172, s77, v15
s_mov_b32 s79, 0
s_waitcnt lgkmcnt(0)
s_cmp_ge_u32 s20, 2
s_cbranch_scc1 L_spd_22
L_sp_20:
s_load_dword s20, s[34:35], 0 glc
s_waitcnt lgkmcnt(0)
s_cmp_ge_u32 s20, 2
s_cbranch_scc1 L_spd_22
s_add_u32 s79, s79, 1
s_cmp_ge_u32 s79, 0x200000
s_cbranch_scc1 L_end
s_branch L_sp_20
L_spd_22:
s_add_u32 s76, s28, 0
buffer_load_dwordx4 v[84:87], v3, s[48:51], s76 offen sc1
s_add_u32 s76, s28, 4096
buffer_load_dwordx4 v[88:91], v3, s[48:51], s76 offen sc1
s_add_u32 s76, s28, 10240
buffer_load_dwordx4 v[92:95], v3, s[48:51], s76 offen sc1
s_add_u32 s76, s28, 14336
buffer_load_dwordx4 v[128:131], v3, s[48:51], s76 offen sc1
s_add_u32 s76, s28, 0
buffer_load_dwordx2 v[16:17], v7, s[48:51], s76 offen sc1
s_add_u32 s76, s28, 10240
buffer_load_dwordx2 v[18:19], v7, s[48:51], s76 offen sc1
s_add_u32 s76, s28, 14336
buffer_load_dwordx4 v[20:23], v12, s[48:51], s76 offen sc1
s_add_u32 s76, s28, 10240
buffer_load_dwordx4 v[24:27], v12, s[48:51], s76 offen sc1
s_add_u32 s76, s28, 0
buffer_load_dwordx2 v[96:97], v6, s[48:51], s76 offen sc1
s_add_u32 s76, s28, 10240
buffer_load_dwordx2 v[98:99], v6, s[48:51], s76 offen sc1
s_add_u32 s76, s28, 4096
buffer_load_dwordx4 v[100:103], v12, s[48:51], s76 offen sc1
s_add_u32 s76, s28, 0
buffer_load_dwordx4 v[104:107], v12, s[48:51], s76 offen sc1
s_xor_b32 s76, s65, 1
s_lshl_b32 s76, s76, 4
s_add_u32 s72, s76, 133216
s_xor_b32 s76, s65, 2
s_lshl_b32 s76, s76, 4
s_add_u32 s73, s76, 133220
s_xor_b32 s76, s65, 3
s_lshl_b32 s76, s76, 4
s_add_u32 s74, s76, 133224
s_lshl_b32 s76, s65, 4
s_add_u32 s76, s76, 133216
v_mov_b32 v173, s76
v_mov_b32 v175, 1
s_waitcnt vmcnt(11)
v_mfma_f32_16x16x32_bf16 v[188:191], v[156:159], v[84:87], v[188:191]
s_add_u32 s76, s28, 0
buffer_load_dwordx4 v[108:111], v11, s[48:51], s76 offen sc1
v_mfma_f32_16x16x32_bf16 v[204:207], v[160:163], v[84:87], v[204:207]
ds_read_b128 v[156:159], v171 offset:13312
v_mfma_f32_16x16x32_bf16 v[220:223], v[56:59], v[84:87], v[220:223]
s_add_u32 s76, s28, 4096
buffer_load_dwordx4 v[112:115], v11, s[48:51], s76 offen sc1
ds_read_b128 v[160:163], v171 offset:14336
v_mfma_f32_16x16x32_bf16 v[236:239], v[60:63], v[84:87], v[236:239]
ds_read_b128 v[56:59], v171 offset:15360
v_mfma_f32_16x16x32_bf16 v[252:255], v[64:67], v[84:87], v[252:255]
ds_read_b128 v[60:63], v171 offset:16384
s_waitcnt vmcnt(12)
v_mfma_f32_16x16x32_bf16 v[188:191], v[68:71], v[88:91], v[188:191]
s_add_u32 s76, s28, 10240
buffer_load_dwordx4 v[28:31], v11, s[48:51], s76 offen sc1
ds_read_b128 v[64:67], v171 offset:17408
v_mfma_f32_16x16x32_bf16 v[204:207], v[72:75], v[88:91], v[204:207]
ds_read_b128 v[84:87], v171 offset:18432
v_mfma_f32_16x16x32_bf16 v[220:223], v[164:167], v[88:91], v[220:223]
s_add_u32 s76, s28, 14336
buffer_load_dwordx4 v[32:35], v11, s[48:51], s76 offen sc1
ds_read_b128 v[68:71], v171 offset:19456
v_mfma_f32_16x16x32_bf16 v[236:239], v[116:119], v[88:91], v[236:239]
ds_read_b128 v[72:75], v171 offset:5120
v_mfma_f32_16x16x32_bf16 v[252:255], v[120:123], v[88:91], v[252:255]
ds_read_b128 v[164:167], v171 offset:6144
s_waitcnt vmcnt(13)
s_waitcnt lgkmcnt(7)
v_mfma_f32_16x16x32_bf16 v[188:191], v[124:127], v[92:95], v[188:191]
s_add_u32 s76, s28, 0
buffer_load_dwordx2 v[132:133], v5, s[48:51], s76 offen sc1
ds_read_b128 v[116:119], v171 offset:7168
v_mfma_f32_16x16x32_bf16 v[204:207], v[76:79], v[92:95], v[204:207]
ds_read_b128 v[120:123], v171 offset:8192
v_mfma_f32_16x16x32_bf16 v[220:223], v[80:83], v[92:95], v[220:223]
s_add_u32 s76, s28, 10240
buffer_load_dwordx2 v[134:135], v5, s[48:51], s76 offen sc1
ds_read_b128 v[88:91], v171 offset:9216
v_mfma_f32_16x16x32_bf16 v[236:239], v[156:159], v[92:95], v[236:239]
v_mfma_f32_16x16x32_bf16 v[252:255], v[160:163], v[92:95], v[252:255]
s_waitcnt vmcnt(14)
s_waitcnt lgkmcnt(5)
v_mfma_f32_16x16x32_bf16 v[188:191], v[56:59], v[128:131], v[188:191]
s_add_u32 s76, s28, 0
buffer_load_dwordx4 v[136:139], v10, s[48:51], s76 offen sc1
ds_read_b128 v[92:95], v171 offset:0
v_mfma_f32_16x16x32_bf16 v[204:207], v[60:63], v[128:131], v[204:207]
v_mfma_f32_16x16x32_bf16 v[220:223], v[64:67], v[128:131], v[220:223]
s_add_u32 s76, s28, 4096
buffer_load_dwordx4 v[140:143], v10, s[48:51], s76 offen sc1
v_mfma_f32_16x16x32_bf16 v[236:239], v[84:87], v[128:131], v[236:239]
v_mfma_f32_16x16x32_bf16 v[252:255], v[68:71], v[128:131], v[252:255]
s_waitcnt vmcnt(14)
v_mfma_f32_16x16x32_bf16 v[188:191], v[144:147], v[16:19], v[188:191]
s_add_u32 s76, s28, 10240
buffer_load_dwordx4 v[52:55], v10, s[48:51], s76 offen sc1
ds_read_b128 v[128:131], v171 offset:1024
v_mfma_f32_16x16x32_bf16 v[204:207], v[36:39], v[16:19], v[204:207]
v_mfma_f32_16x16x32_bf16 v[220:223], v[40:43], v[16:19], v[220:223]
s_add_u32 s76, s28, 14336
buffer_load_dwordx4 v[148:151], v10, s[48:51], s76 offen sc1
v_mfma_f32_16x16x32_bf16 v[236:239], v[44:47], v[16:19], v[236:239]
v_mfma_f32_16x16x32_bf16 v[252:255], v[48:51], v[16:19], v[252:255]
s_waitcnt vmcnt(15)
v_mfma_f32_16x16x32_bf16 v[184:187], v[56:59], v[20:23], v[184:187]
s_add_u32 s76, s28, 0
buffer_load_dwordx2 v[152:153], v4, s[48:51], s76 offen sc1
ds_read_b128 v[16:19], v171 offset:2048
v_mfma_f32_16x16x32_bf16 v[200:203], v[60:63], v[20:23], v[200:203]
v_mfma_f32_16x16x32_bf16 v[216:219], v[64:67], v[20:23], v[216:219]
s_add_u32 s76, s28, 10240
buffer_load_dwordx2 v[154:155], v4, s[48:51], s76 offen sc1
v_mfma_f32_16x16x32_bf16 v[232:235], v[84:87], v[20:23], v[232:235]
ds_write_b128 v172, v[188:191] offset:10240
v_mfma_f32_16x16x32_bf16 v[248:251], v[68:71], v[20:23], v[248:251]
s_waitcnt vmcnt(16)
v_mfma_f32_16x16x32_bf16 v[184:187], v[124:127], v[24:27], v[184:187]
ds_read_b128 v[20:23], v171 offset:3072
v_mfma_f32_16x16x32_bf16 v[200:203], v[76:79], v[24:27], v[200:203]
v_mfma_f32_16x16x32_bf16 v[216:219], v[80:83], v[24:27], v[216:219]
v_mfma_f32_16x16x32_bf16 v[232:235], v[156:159], v[24:27], v[232:235]
ds_write_b128 v172, v[204:207] offset:11264
v_mfma_f32_16x16x32_bf16 v[248:251], v[160:163], v[24:27], v[248:251]
s_waitcnt vmcnt(14)
v_mfma_f32_16x16x32_bf16 v[184:187], v[144:147], v[96:99], v[184:187]
ds_read_b128 v[24:27], v171 offset:4096
v_mfma_f32_16x16x32_bf16 v[200:203], v[36:39], v[96:99], v[200:203]
v_mfma_f32_16x16x32_bf16 v[216:219], v[40:43], v[96:99], v[216:219]
v_mfma_f32_16x16x32_bf16 v[232:235], v[44:47], v[96:99], v[232:235]
ds_write_b128 v172, v[220:223] offset:12288
v_mfma_f32_16x16x32_bf16 v[248:251], v[48:51], v[96:99], v[248:251]
s_waitcnt vmcnt(13)
s_waitcnt lgkmcnt(8)
v_mfma_f32_16x16x32_bf16 v[184:187], v[72:75], v[100:103], v[184:187]
v_mfma_f32_16x16x32_bf16 v[200:203], v[164:167], v[100:103], v[200:203]
v_mfma_f32_16x16x32_bf16 v[216:219], v[116:119], v[100:103], v[216:219]
v_mfma_f32_16x16x32_bf16 v[232:235], v[120:123], v[100:103], v[232:235]
ds_write_b128 v172, v[236:239] offset:13312
v_mfma_f32_16x16x32_bf16 v[248:251], v[88:91], v[100:103], v[248:251]
s_waitcnt vmcnt(12)
s_waitcnt lgkmcnt(2)
v_mfma_f32_16x16x32_bf16 v[184:187], v[92:95], v[104:107], v[184:187]
v_mfma_f32_16x16x32_bf16 v[200:203], v[128:131], v[104:107], v[200:203]
v_mfma_f32_16x16x32_bf16 v[216:219], v[16:19], v[104:107], v[216:219]
v_mfma_f32_16x16x32_bf16 v[232:235], v[20:23], v[104:107], v[232:235]
ds_write_b128 v172, v[252:255] offset:14336
s_mov_b64 exec, 1
v_mov_b32 v174, s74
ds_add_u32 v174, v175
s_mov_b64 exec, -1
v_mfma_f32_16x16x32_bf16 v[248:251], v[24:27], v[104:107], v[248:251]
s_waitcnt vmcnt(11)
v_mfma_f32_16x16x32_bf16 v[180:183], v[92:95], v[108:111], v[180:183]
v_mfma_f32_16x16x32_bf16 v[196:199], v[128:131], v[108:111], v[196:199]
v_mfma_f32_16x16x32_bf16 v[212:215], v[16:19], v[108:111], v[212:215]
v_mfma_f32_16x16x32_bf16 v[228:231], v[20:23], v[108:111], v[228:231]
ds_write_b128 v170, v[184:187] offset:5120
v_mfma_f32_16x16x32_bf16 v[244:247], v[24:27], v[108:111], v[244:247]
s_waitcnt vmcnt(10)
v_mfma_f32_16x16x32_bf16 v[180:183], v[72:75], v[112:115], v[180:183]
v_mfma_f32_16x16x32_bf16 v[196:199], v[164:167], v[112:115], v[196:199]
v_mfma_f32_16x16x32_bf16 v[212:215], v[116:119], v[112:115], v[212:215]
v_mfma_f32_16x16x32_bf16 v[228:231], v[120:123], v[112:115], v[228:231]
ds_write_b128 v170, v[200:203] offset:6144
v_mfma_f32_16x16x32_bf16 v[244:247], v[88:91], v[112:115], v[244:247]
s_waitcnt vmcnt(9)
v_mfma_f32_16x16x32_bf16 v[180:183], v[124:127], v[28:31], v[180:183]
v_mfma_f32_16x16x32_bf16 v[196:199], v[76:79], v[28:31], v[196:199]
v_mfma_f32_16x16x32_bf16 v[212:215], v[80:83], v[28:31], v[212:215]
v_mfma_f32_16x16x32_bf16 v[228:231], v[156:159], v[28:31], v[228:231]
ds_write_b128 v170, v[216:219] offset:7168
v_mfma_f32_16x16x32_bf16 v[244:247], v[160:163], v[28:31], v[244:247]
s_waitcnt vmcnt(8)
v_mfma_f32_16x16x32_bf16 v[180:183], v[56:59], v[32:35], v[180:183]
v_mfma_f32_16x16x32_bf16 v[196:199], v[60:63], v[32:35], v[196:199]
v_mfma_f32_16x16x32_bf16 v[212:215], v[64:67], v[32:35], v[212:215]
v_mfma_f32_16x16x32_bf16 v[228:231], v[84:87], v[32:35], v[228:231]
ds_write_b128 v170, v[232:235] offset:8192
v_mfma_f32_16x16x32_bf16 v[244:247], v[68:71], v[32:35], v[244:247]
s_waitcnt vmcnt(6)
v_mfma_f32_16x16x32_bf16 v[180:183], v[144:147], v[132:135], v[180:183]
ds_read_b96 v[12:14], v173
v_mfma_f32_16x16x32_bf16 v[196:199], v[36:39], v[132:135], v[196:199]
v_mfma_f32_16x16x32_bf16 v[212:215], v[40:43], v[132:135], v[212:215]
v_mfma_f32_16x16x32_bf16 v[228:231], v[44:47], v[132:135], v[228:231]
ds_write_b128 v170, v[248:251] offset:9216
s_mov_b64 exec, 1
v_mov_b32 v174, s73
ds_add_u32 v174, v175
s_mov_b64 exec, -1
v_mfma_f32_16x16x32_bf16 v[244:247], v[48:51], v[132:135], v[244:247]
s_waitcnt lgkmcnt(2)
v_min3_u32 v14, v12, v13, v14
s_nop 0
v_readfirstlane_b32 s78, v14
s_nop 1
s_cmp_lt_u32 s78, 1
s_cbranch_scc1 L_rs_23
s_waitcnt vmcnt(5)
v_mfma_f32_16x16x32_bf16 v[176:179], v[92:95], v[136:139], v[176:179]
ds_read_b128 v[188:191], v2 offset:10240
ds_read_b128 v[204:207], v2 offset:11264
v_mfma_f32_16x16x32_bf16 v[192:195], v[128:131], v[136:139], v[192:195]
ds_write_b128 v168, v[180:183] offset:0
ds_read_b128 v[220:223], v2 offset:12288
ds_read_b128 v[236:239], v2 offset:13312
v_mfma_f32_16x16x32_bf16 v[208:211], v[16:19], v[136:139], v[208:211]
ds_read_b128 v[252:255], v2 offset:14336
ds_read_b128 v[184:187], v2 offset:5120
v_mfma_f32_16x16x32_bf16 v[224:227], v[20:23], v[136:139], v[224:227]
ds_write_b128 v168, v[196:199] offset:1024
ds_read_b128 v[200:203], v2 offset:6144
ds_read_b128 v[216:219], v2 offset:7168
v_mfma_f32_16x16x32_bf16 v[240:243], v[24:27], v[136:139], v[240:243]
ds_read_b128 v[232:235], v2 offset:8192
ds_read_b128 v[248:251], v2 offset:9216
s_waitcnt vmcnt(4)
v_mfma_f32_16x16x32_bf16 v[176:179], v[72:75], v[140:143], v[176:179]
s_waitcnt lgkmcnt(9)
ds_read_b128 v[96:99], v2 offset:0
ds_read_b128 v[100:103], v2 offset:1024
v_mfma_f32_16x16x32_bf16 v[192:195], v[164:167], v[140:143], v[192:195]
ds_write_b128 v168, v[212:215] offset:2048
ds_read_b128 v[104:107], v2 offset:2048
ds_read_b128 v[108:111], v2 offset:3072
v_mfma_f32_16x16x32_bf16 v[208:211], v[116:119], v[140:143], v[208:211]
s_waitcnt lgkmcnt(9)
ds_read_b128 v[112:115], v2 offset:4096
v_mfma_f32_16x16x32_bf16 v[224:227], v[120:123], v[140:143], v[224:227]
ds_write_b128 v168, v[228:231] offset:3072
v_mfma_f32_16x16x32_bf16 v[240:243], v[88:91], v[140:143], v[240:243]
s_waitcnt vmcnt(3)
v_mfma_f32_16x16x32_bf16 v[176:179], v[124:127], v[52:55], v[176:179]
v_mfma_f32_16x16x32_bf16 v[192:195], v[76:79], v[52:55], v[192:195]
ds_write_b128 v168, v[244:247] offset:4096
s_mov_b64 exec, 1
v_mov_b32 v174, s72
ds_add_u32 v174, v175
s_mov_b64 exec, -1
s_waitcnt lgkmcnt(0)
v_add_f32 v188, v188, v184
v_add_f32 v189, v189, v185
v_add_f32 v190, v190, v186
v_mfma_f32_16x16x32_bf16 v[208:211], v[80:83], v[52:55], v[208:211]
v_add_f32 v191, v191, v187
v_add_f32 v204, v204, v200
v_add_f32 v205, v205, v201
v_mfma_f32_16x16x32_bf16 v[224:227], v[156:159], v[52:55], v[224:227]
v_add_f32 v206, v206, v202
v_add_f32 v207, v207, v203
v_add_f32 v220, v220, v216
v_mfma_f32_16x16x32_bf16 v[240:243], v[160:163], v[52:55], v[240:243]
v_add_f32 v221, v221, v217
v_add_f32 v222, v222, v218
v_add_f32 v223, v223, v219
s_waitcnt vmcnt(2)
v_mfma_f32_16x16x32_bf16 v[176:179], v[56:59], v[148:151], v[176:179]
v_add_f32 v236, v236, v232
v_add_f32 v237, v237, v233
v_add_f32 v238, v238, v234
v_mfma_f32_16x16x32_bf16 v[192:195], v[60:63], v[148:151], v[192:195]
v_add_f32 v239, v239, v235
v_add_f32 v252, v252, v248
v_add_f32 v253, v253, v249
v_mfma_f32_16x16x32_bf16 v[208:211], v[64:67], v[148:151], v[208:211]
v_add_f32 v254, v254, v250
v_add_f32 v255, v255, v251
v_add_f32 v188, v188, v96
v_mfma_f32_16x16x32_bf16 v[224:227], v[84:87], v[148:151], v[224:227]
v_add_f32 v189, v189, v97
v_add_f32 v190, v190, v98
v_add_f32 v191, v191, v99
v_mfma_f32_16x16x32_bf16 v[240:243], v[68:71], v[148:151], v[240:243]
v_add_f32 v204, v204, v100
v_add_f32 v205, v205, v101
v_add_f32 v206, v206, v102
s_waitcnt vmcnt(0)
v_mfma_f32_16x16x32_bf16 v[176:179], v[144:147], v[152:155], v[176:179]
v_add_f32 v207, v207, v103
v_add_f32 v220, v220, v104
v_add_f32 v221, v221, v105
v_mfma_f32_16x16x32_bf16 v[192:195], v[36:39], v[152:155], v[192:195]
v_add_f32 v222, v222, v106
v_add_f32 v223, v223, v107
v_add_f32 v236, v236, v108
v_mfma_f32_16x16x32_bf16 v[208:211], v[40:43], v[152:155], v[208:211]
v_add_f32 v237, v237, v109
v_add_f32 v238, v238, v110
v_add_f32 v239, v239, v111
v_mfma_f32_16x16x32_bf16 v[224:227], v[44:47], v[152:155], v[224:227]
v_add_f32 v252, v252, v112
v_add_f32 v253, v253, v113
v_add_f32 v254, v254, v114
v_mfma_f32_16x16x32_bf16 v[240:243], v[48:51], v[152:155], v[240:243]
v_add_f32 v255, v255, v115
s_branch L_rj_24
L_rs_23:
s_waitcnt vmcnt(5)
v_mfma_f32_16x16x32_bf16 v[176:179], v[92:95], v[136:139], v[176:179]
v_mfma_f32_16x16x32_bf16 v[192:195], v[128:131], v[136:139], v[192:195]
ds_write_b128 v168, v[180:183] offset:0
v_mfma_f32_16x16x32_bf16 v[208:211], v[16:19], v[136:139], v[208:211]
v_mfma_f32_16x16x32_bf16 v[224:227], v[20:23], v[136:139], v[224:227]
ds_write_b128 v168, v[196:199] offset:1024
v_mfma_f32_16x16x32_bf16 v[240:243], v[24:27], v[136:139], v[240:243]
s_waitcnt vmcnt(4)
v_mfma_f32_16x16x32_bf16 v[176:179], v[72:75], v[140:143], v[176:179]
v_mfma_f32_16x16x32_bf16 v[192:195], v[164:167], v[140:143], v[192:195]
ds_write_b128 v168, v[212:215] offset:2048
v_mfma_f32_16x16x32_bf16 v[208:211], v[116:119], v[140:143], v[208:211]
v_mfma_f32_16x16x32_bf16 v[224:227], v[120:123], v[140:143], v[224:227]
ds_write_b128 v168, v[228:231] offset:3072
v_mfma_f32_16x16x32_bf16 v[240:243], v[88:91], v[140:143], v[240:243]
s_waitcnt vmcnt(3)
v_mfma_f32_16x16x32_bf16 v[176:179], v[124:127], v[52:55], v[176:179]
v_mfma_f32_16x16x32_bf16 v[192:195], v[76:79], v[52:55], v[192:195]
ds_write_b128 v168, v[244:247] offset:4096
s_mov_b64 exec, 1
v_mov_b32 v174, s72
ds_add_u32 v174, v175
s_mov_b64 exec, -1
v_mfma_f32_16x16x32_bf16 v[208:211], v[80:83], v[52:55], v[208:211]
v_mfma_f32_16x16x32_bf16 v[224:227], v[156:159], v[52:55], v[224:227]
v_mfma_f32_16x16x32_bf16 v[240:243], v[160:163], v[52:55], v[240:243]
s_waitcnt vmcnt(2)
v_mfma_f32_16x16x32_bf16 v[176:179], v[56:59], v[148:151], v[176:179]
v_mfma_f32_16x16x32_bf16 v[192:195], v[60:63], v[148:151], v[192:195]
v_mfma_f32_16x16x32_bf16 v[208:211], v[64:67], v[148:151], v[208:211]
v_mfma_f32_16x16x32_bf16 v[224:227], v[84:87], v[148:151], v[224:227]
v_mfma_f32_16x16x32_bf16 v[240:243], v[68:71], v[148:151], v[240:243]
s_waitcnt vmcnt(0)
v_mfma_f32_16x16x32_bf16 v[176:179], v[144:147], v[152:155], v[176:179]
v_mfma_f32_16x16x32_bf16 v[192:195], v[36:39], v[152:155], v[192:195]
v_mfma_f32_16x16x32_bf16 v[208:211], v[40:43], v[152:155], v[208:211]
v_mfma_f32_16x16x32_bf16 v[224:227], v[44:47], v[152:155], v[224:227]
v_mfma_f32_16x16x32_bf16 v[240:243], v[48:51], v[152:155], v[240:243]
s_mov_b32 s79, 0
L_rw_25:
ds_read_b32 v14, v173 offset:8
s_waitcnt lgkmcnt(0)
v_readfirstlane_b32 s78, v14
s_add_u32 s79, s79, 1
s_cmp_ge_u32 s79, 0x1000000
s_cbranch_scc1 L_end
s_cmp_lt_u32 s78, 1
s_cbranch_scc1 L_rw_25
ds_read_b128 v[188:191], v2 offset:10240
ds_read_b128 v[204:207], v2 offset:11264
ds_read_b128 v[220:223], v2 offset:12288
ds_read_b128 v[236:239], v2 offset:13312
ds_read_b128 v[252:255], v2 offset:14336
s_mov_b32 s79, 0
L_rw_26:
ds_read_b32 v14, v173 offset:4
s_waitcnt lgkmcnt(0)
v_readfirstlane_b32 s78, v14
s_add_u32 s79, s79, 1
s_cmp_ge_u32 s79, 0x1000000
s_cbranch_scc1 L_end
s_cmp_lt_u32 s78, 1
s_cbranch_scc1 L_rw_26
ds_read_b128 v[184:187], v2 offset:5120
ds_read_b128 v[200:203], v2 offset:6144
ds_read_b128 v[216:219], v2 offset:7168
ds_read_b128 v[232:235], v2 offset:8192
ds_read_b128 v[248:251], v2 offset:9216
s_mov_b32 s79, 0
L_rw_27:
ds_read_b32 v14, v173 offset:0
s_waitcnt lgkmcnt(0)
v_readfirstlane_b32 s78, v14
s_add_u32 s79, s79, 1
s_cmp_ge_u32 s79, 0x1000000
s_cbranch_scc1 L_end
s_cmp_lt_u32 s78, 1
s_cbranch_scc1 L_rw_27
ds_read_b128 v[96:99], v2 offset:0
ds_read_b128 v[100:103], v2 offset:1024
ds_read_b128 v[104:107], v2 offset:2048
ds_read_b128 v[108:111], v2 offset:3072
ds_read_b128 v[112:115], v2 offset:4096
v_pk_add_f32 v[188:189], v[188:189], v[184:185]
v_pk_add_f32 v[190:191], v[190:191], v[186:187]
v_pk_add_f32 v[204:205], v[204:205], v[200:201]
v_pk_add_f32 v[206:207], v[206:207], v[202:203]
v_pk_add_f32 v[220:221], v[220:221], v[216:217]
v_pk_add_f32 v[222:223], v[222:223], v[218:219]
v_pk_add_f32 v[236:237], v[236:237], v[232:233]
v_pk_add_f32 v[238:239], v[238:239], v[234:235]
v_pk_add_f32 v[252:253], v[252:253], v[248:249]
v_pk_add_f32 v[254:255], v[254:255], v[250:251]
s_waitcnt lgkmcnt(4)
v_pk_add_f32 v[188:189], v[188:189], v[96:97]
v_pk_add_f32 v[190:191], v[190:191], v[98:99]
s_waitcnt lgkmcnt(3)
v_pk_add_f32 v[204:205], v[204:205], v[100:101]
v_pk_add_f32 v[206:207], v[206:207], v[102:103]
s_waitcnt lgkmcnt(2)
v_pk_add_f32 v[220:221], v[220:221], v[104:105]
v_pk_add_f32 v[222:223], v[222:223], v[106:107]
s_waitcnt lgkmcnt(1)
v_pk_add_f32 v[236:237], v[236:237], v[108:109]
v_pk_add_f32 v[238:239], v[238:239], v[110:111]
s_waitcnt lgkmcnt(0)
v_pk_add_f32 v[252:253], v[252:253], v[112:113]
v_pk_add_f32 v[254:255], v[254:255], v[114:115]
L_rj_24:
s_nop 7
v_pk_add_f32 v[176:177], v[176:177], v[188:189]
v_pk_add_f32 v[178:179], v[178:179], v[190:191]
v_pk_add_f32 v[192:193], v[192:193], v[204:205]
v_pk_add_f32 v[194:195], v[194:195], v[206:207]
v_pk_add_f32 v[208:209], v[208:209], v[220:221]
v_pk_add_f32 v[210:211], v[210:211], v[222:223]
v_pk_add_f32 v[224:225], v[224:225], v[236:237]
v_pk_add_f32 v[226:227], v[226:227], v[238:239]
v_pk_add_f32 v[240:241], v[240:241], v[252:253]
v_pk_add_f32 v[242:243], v[242:243], v[254:255]
v_cvt_pk_bf16_f32 v100, v176, v177
v_cvt_pk_bf16_f32 v101, v178, v179
v_cvt_pk_bf16_f32 v102, v192, v193
v_cvt_pk_bf16_f32 v103, v194, v195
v_cvt_pk_bf16_f32 v104, v208, v209
v_cvt_pk_bf16_f32 v105, v210, v211
v_cvt_pk_bf16_f32 v106, v224, v225
v_cvt_pk_bf16_f32 v107, v226, v227
v_cvt_pk_bf16_f32 v108, v240, v241
v_cvt_pk_bf16_f32 v109, v242, v243
buffer_store_dwordx4 v[100:103], v169, s[52:55], s42 offen
buffer_store_dwordx4 v[104:107], v169, s[52:55], s42 offen offset:16
buffer_store_dwordx2 v[108:109], v169, s[52:55], s42 offen offset:32
s_endpgm
L_C:
v_lshrrev_b32 v1, 4, v0
v_bfe_u32 v2, v0, 2, 2
v_and_b32 v3, 3, v0
v_and_b32 v5, 1, v1
v_lshl_add_u32 v4, v5, 2, v2
v_lshrrev_b32 v6, 1, v1
v_lshlrev_b32 v6, 13, v6
s_lshl_b32 s76, s65, 5
v_and_b32 v7, 15, v0
v_add_u32 v7, s76, v7
v_lshrrev_b32 v128, 1, v7
v_xor_b32 v128, v128, v1
v_and_b32 v128, 7, v128
v_lshlrev_b32 v128, 4, v128
v_lshl_add_u32 v128, v7, 7, v128
v_add_u32 v246, 81920, v128
v_xor_b32 v247, 64, v246
v_mul_u32_u24 v128, 160, v4
v_mul_u32_u24 v129, 40, v3
v_add3_u32 v240, v128, v129, v6
v_add_u32 v241, 49152, v240
v_mov_b32 v242, 0
v_lshlrev_b32 v243, 4, v0
v_mov_b32 v128, 0
v_mov_b32 v129, 0
v_mov_b32 v130, 0
v_mov_b32 v131, 0
s_lshl_b32 s76, s65, 9
s_add_u32 s76, s76, 131072
v_lshl_add_u32 v132, v0, 3, s76
ds_write_b64 v132, v[128:129]
v_lshlrev_b32 v132, 2, v0
v_add_u32 v132, 133120, v132
ds_write_b32 v132, v128
v_mul_u32_u24 v132, 800, v3
v_mul_u32_u24 v133, 40, v2
v_add3_u32 v132, v132, v133, s76
v_cmp_eq_u32 vcc, v1, v3
s_add_u32 s77, s76, 4294833920
v_subrev_u32 v132, s77, v132
v_mov_b32 v133, 131072
v_cndmask_b32 v244, v133, v132, vcc
s_mov_b32 s8, 3184710632
s_mov_b32 s9, 3184710632
s_mov_b32 s10, 1069066811
s_mov_b32 s11, 1069066811
s_waitcnt lgkmcnt(0)
s_mov_b32 s48, s40
s_mov_b32 s49, s41
s_mov_b32 s50, 20971520
s_mov_b32 s51, 0x20000
s_lshl_b32 s76, s60, 1
s_lshr_b32 s77, s65, 1
s_add_u32 s15, s76, s77
s_lshl_b32 s76, s60, 13
s_lshr_b32 s77, s61, 1
s_lshl_b32 s77, s77, 7
s_add_u32 s76, s76, s77
s_add_u32 s76, s76, 14811136
s_add_u32 s72, s40, s76
s_addc_u32 s73, s41, 0
s_lshl_b32 s76, s61, 11
s_add_u32 s76, s76, 14942208
s_add_u32 s74, s40, s76
s_addc_u32 s75, s41, 0
s_lshl_b32 s76, s61, 13
s_lshl_b32 s77, s60, 9
s_add_u32 s76, s76, s77
s_lshl_b32 s77, s65, 7
s_add_u32 s76, s76, s77
s_add_u32 s3, s76, 13631488
s_cmp_eq_u32 s62, 1
s_cbranch_scc1 L_CQ
v_lshrrev_b32 v128, 1, v4
v_lshlrev_b32 v129, 7, v4
v_lshl_add_u32 v129, v3, 3, v129
v_add_u32 v129, v129, v6
v_xor_b32 v130, 0, v128
v_lshl_add_u32 v248, v130, 5, v129
v_add_u32 v249, 49152, v248
v_xor_b32 v130, 1, v128
v_lshl_add_u32 v250, v130, 5, v129
v_add_u32 v251, 49152, v250
v_xor_b32 v130, 2, v128
v_lshl_add_u32 v252, v130, 5, v129
v_add_u32 v253, 49152, v252
v_xor_b32 v130, 3, v128
v_lshl_add_u32 v254, v130, 5, v129
v_add_u32 v255, 49152, v254
v_lshlrev_b32 v190, 4, v1
v_add_u32 v191, 49152, v190
s_mul_i32 s76, s15, 54
s_lshl_b32 s77, s61, 1
s_add_u32 s76, s76, s77
s_lshl_b32 s76, s76, 12
s_and_b32 s77, s65, 1
s_lshl_b32 s77, s77, 11
s_add_u32 s12, s76, s77
v_lshl_add_u32 v8, v1, 2, v2
v_and_b32 v9, 7, v8
v_lshlrev_b32 v8, 7, v8
s_lshl_b32 s76, s65, 14
s_cmp_eq_u32 s65, 3
s_cmov_b32 s76, 114688
v_and_b32 v10, 1, v3
v_lshl_add_u32 v8, v10, 3, v8
v_add_u32 v8, s76, v8
v_lshrrev_b32 v10, 1, v3
v_add_u32 v128, 0, v10
v_xor_b32 v128, v128, v9
v_lshl_add_u32 v128, v128, 4, v8
v_add_u32 v129, 2, v10
v_xor_b32 v129, v129, v9
v_lshl_add_u32 v129, v129, 4, v8
v_add_u32 v130, 4, v10
v_xor_b32 v130, v130, v9
v_lshl_add_u32 v130, v130, 4, v8
v_add_u32 v131, 5, v10
v_xor_b32 v131, v131, v9
v_lshl_add_u32 v131, v131, 4, v8
v_xor_b32 v132, 7, v9
v_lshl_add_u32 v132, v132, 4, v8
v_mov_b32 v10, 7
v_and_b32 v8, 15, v0
s_lshl_b32 s76, s65, 5
v_add_u32 v8, s76, v8
v_cmp_eq_u32 vcc, 3, v1
v_lshlrev_b32 v8, 7, v8
v_and_b32 v11, 7, v0
v_cndmask_b32 v9, v1, v10, vcc
v_lshl_add_u32 v8, v11, 4, v8
v_lshl_add_u32 v245, v9, 14, v8
v_mov_b32 v13, 1073741824
v_and_b32 v14, 15, v0
v_cmp_gt_u32 vcc, 32, v0
s_nop 1
v_cndmask_b32 v133, v13, v243, vcc
v_cmp_gt_u32 vcc, 5, v14
s_nop 1
v_cndmask_b32 v134, v13, v243, vcc
v_cndmask_b32 v135, v13, v133, vcc
s_lshl_b32 s76, s61, 6
s_add_u32 s76, s76, s65
s_mul_i32 s76, s76, 6144
s_add_u32 s4, s76, 16777216
s_mul_i32 s76, s60, 24576
s_add_u32 s5, s4, s76
s_add_u32 s6, s5, 4096
s_mul_i32 s76, s60, 14
v_add_u32 v8, s76, v14
v_mul_u32_u24 v9, 3121, v8
v_lshrrev_b32 v9, 16, v9
v_mul_u32_u24 v10, 21, v9
v_sub_u32 v10, v8, v10
v_lshrrev_b32 v11, 2, v9
v_lshrrev_b32 v12, 4, v10
v_lshl_add_u32 v11, v11, 1, v12
v_and_b32 v12, 3, v9
v_and_b32 v15, 15, v10
v_lshl_add_u32 v12, v12, 4, v15
v_lshlrev_b32 v12, 4, v12
v_lshl_add_u32 v11, v11, 10, v12
v_mul_u32_u24 v12, 24576, v1
v_add_u32 v11, v11, v12
v_cmp_gt_u32 s[76:77], 14, v14
v_cmp_gt_u32 vcc, 210, v8
s_nop 1
s_and_b64 vcc, vcc, s[76:77]
v_cndmask_b32 v6, v13, v11, vcc
v_mul_u32_u24 v12, 24, v9
v_add_lshl_u32 v12, v12, v10, 3
s_and_b64 vcc, vcc, 0xffff
v_cndmask_b32 v7, v13, v12, vcc
s_lshl_b32 s76, s61, 2
s_add_u32 s76, s76, s65
s_lshl_b32 s76, s76, 11
s_add_u32 s7, s76, 14680064
s_add_u32 s68, s74, 16384
s_addc_u32 s69, s75, 0
v_mov_b32 v8, 0
v_mov_b32 v9, 0
v_mov_b32 v10, 0
v_mov_b32 v11, 0
v_mov_b32 v12, 0
v_mov_b32 v13, 0
v_mov_b32 v14, 0
v_mov_b32 v15, 0
v_mov_b32 v16, 0
v_mov_b32 v17, 0
v_mov_b32 v18, 0
v_mov_b32 v19, 0
v_mov_b32 v20, 0
v_mov_b32 v21, 0
v_mov_b32 v22, 0
v_mov_b32 v23, 0
v_mov_b32 v24, 0
v_mov_b32 v25, 0
v_mov_b32 v26, 0
v_mov_b32 v27, 0
v_mov_b32 v28, 0
v_mov_b32 v29, 0
v_mov_b32 v30, 0
v_mov_b32 v31, 0
v_mov_b32 v32, 0
v_mov_b32 v33, 0
v_mov_b32 v34, 0
v_mov_b32 v35, 0
v_mov_b32 v36, 0
v_mov_b32 v37, 0
v_mov_b32 v38, 0
v_mov_b32 v39, 0
v_mov_b32 v40, 0
v_mov_b32 v41, 0
v_mov_b32 v42, 0
v_mov_b32 v43, 0
v_mov_b32 v44, 0
v_mov_b32 v45, 0
v_mov_b32 v46, 0
v_mov_b32 v47, 0
v_mov_b32 v48, 0
v_mov_b32 v49, 0
v_mov_b32 v50, 0
v_mov_b32 v51, 0
v_mov_b32 v52, 0
v_mov_b32 v53, 0
v_mov_b32 v54, 0
v_mov_b32 v55, 0
v_mov_b32 v56, 0
v_mov_b32 v57, 0
v_mov_b32 v58, 0
v_mov_b32 v59, 0
v_mov_b32 v60, 0
v_mov_b32 v61, 0
v_mov_b32 v62, 0
v_mov_b32 v63, 0
v_mov_b32 v64, 0
v_mov_b32 v65, 0
v_mov_b32 v66, 0
v_mov_b32 v67, 0
v_mov_b32 v68, 0
v_mov_b32 v69, 0
v_mov_b32 v70, 0
v_mov_b32 v71, 0
v_mov_b32 v72, 0
v_mov_b32 v73, 0
v_mov_b32 v74, 0
v_mov_b32 v75, 0
v_mov_b32 v76, 0
v_mov_b32 v77, 0
v_mov_b32 v78, 0
v_mov_b32 v79, 0
v_mov_b32 v80, 0
v_mov_b32 v81, 0
v_mov_b32 v82, 0
v_mov_b32 v83, 0
v_mov_b32 v84, 0
v_mov_b32 v85, 0
v_mov_b32 v86, 0
v_mov_b32 v87, 0
v_mov_b32 v120, 0
v_mov_b32 v121, 0
v_mov_b32 v122, 0
v_mov_b32 v123, 0
v_mov_b32 v124, 0
v_mov_b32 v125, 0
v_mov_b32 v126, 0
v_mov_b32 v127, 0
v_lshlrev_b32 v156, 3, v1
v_add_u32 v156, 163328, v156
s_waitcnt vmcnt(4)
ds_read_b64 v[136:137], v156 offset:0
ds_read_b64 v[138:139], v156 offset:32
ds_read_b64 v[140:141], v156 offset:64
ds_read_b64 v[142:143], v156 offset:96
s_waitcnt lgkmcnt(0)
v_lshlrev_b32 v88, 16, v136
v_and_b32 v89, 0xffff0000, v136
v_lshlrev_b32 v90, 16, v137
v_and_b32 v91, 0xffff0000, v137
v_lshlrev_b32 v92, 16, v136
v_and_b32 v93, 0xffff0000, v136
v_lshlrev_b32 v94, 16, v137
v_and_b32 v95, 0xffff0000, v137
v_lshlrev_b32 v96, 16, v138
v_and_b32 v97, 0xffff0000, v138
v_lshlrev_b32 v98, 16, v139
v_and_b32 v99, 0xffff0000, v139
v_lshlrev_b32 v100, 16, v138
v_and_b32 v101, 0xffff0000, v138
v_lshlrev_b32 v102, 16, v139
v_and_b32 v103, 0xffff0000, v139
v_lshlrev_b32 v104, 16, v140
v_and_b32 v105, 0xffff0000, v140
v_lshlrev_b32 v106, 16, v141
v_and_b32 v107, 0xffff0000, v141
v_lshlrev_b32 v108, 16, v140
v_and_b32 v109, 0xffff0000, v140
v_lshlrev_b32 v110, 16, v141
v_and_b32 v111, 0xffff0000, v141
v_lshlrev_b32 v112, 16, v142
v_and_b32 v113, 0xffff0000, v142
v_lshlrev_b32 v114, 16, v143
v_and_b32 v115, 0xffff0000, v143
v_lshlrev_b32 v116, 16, v142
v_and_b32 v117, 0xffff0000, v142
v_lshlrev_b32 v118, 16, v143
v_and_b32 v119, 0xffff0000, v143
s_waitcnt vmcnt(0)
s_barrier
ds_read_b128 v[224:227], v246 offset:0
ds_read_b128 v[228:231], v246 offset:2048
ds_read_b64_tr_b16 v[192:193], v240 offset:0
ds_read_b64_tr_b16 v[194:195], v240 offset:4096
ds_read_b64_tr_b16 v[196:197], v240 offset:8
ds_read_b64_tr_b16 v[198:199], v240 offset:4104
ds_read_b64_tr_b16 v[200:201], v240 offset:16
ds_read_b64_tr_b16 v[202:203], v240 offset:4112
ds_read_b64_tr_b16 v[204:205], v240 offset:24
ds_read_b64_tr_b16 v[206:207], v240 offset:4120
ds_read_b64_tr_b16 v[208:209], v240 offset:32
ds_read_b64_tr_b16 v[210:211], v240 offset:4128
s_waitcnt lgkmcnt(6)
v_mfma_f32_16x16x32_bf16 v[8:11], v[192:195], v[224:227], v[8:11]
ds_read_b64_tr_b16 v[212:213], v240 offset:1280
v_mfma_f32_16x16x32_bf16 v[12:15], v[192:195], v[228:231], v[12:15]
ds_read_b64_tr_b16 v[214:215], v240 offset:5376
v_mfma_f32_16x16x32_bf16 v[16:19], v[196:199], v[224:227], v[16:19]
ds_read_b64_tr_b16 v[216:217], v240 offset:1288
v_mfma_f32_16x16x32_bf16 v[20:23], v[196:199], v[228:231], v[20:23]
ds_read_b64_tr_b16 v[218:219], v240 offset:5384
s_waitcnt lgkmcnt(6)
v_mfma_f32_16x16x32_bf16 v[24:27], v[200:203], v[224:227], v[24:27]
ds_read_b64_tr_b16 v[192:193], v240 offset:1296
v_mfma_f32_16x16x32_bf16 v[28:31], v[200:203], v[228:231], v[28:31]
ds_read_b64_tr_b16 v[194:195], v240 offset:5392
v_mfma_f32_16x16x32_bf16 v[32:35], v[204:207], v[224:227], v[32:35]
ds_read_b64_tr_b16 v[196:197], v240 offset:1304
v_mfma_f32_16x16x32_bf16 v[36:39], v[204:207], v[228:231], v[36:39]
ds_read_b64_tr_b16 v[198:199], v240 offset:5400
s_waitcnt lgkmcnt(6)
v_mfma_f32_16x16x32_bf16 v[40:43], v[208:211], v[224:227], v[40:43]
ds_read_b64_tr_b16 v[200:201], v240 offset:1312
v_mfma_f32_16x16x32_bf16 v[44:47], v[208:211], v[228:231], v[44:47]
ds_read_b64_tr_b16 v[202:203], v240 offset:5408
v_mfma_f32_16x16x32_bf16 v[48:51], v[212:215], v[224:227], v[48:51]
ds_read_b64_tr_b16 v[204:205], v248 offset:3072
v_mfma_f32_16x16x32_bf16 v[52:55], v[212:215], v[228:231], v[52:55]
ds_read_b64_tr_b16 v[206:207], v248 offset:7168
s_waitcnt lgkmcnt(6)
v_mfma_f32_16x16x32_bf16 v[56:59], v[216:219], v[224:227], v[56:59]
ds_read_b64_tr_b16 v[208:209], v250 offset:3072
v_mfma_f32_16x16x32_bf16 v[60:63], v[216:219], v[228:231], v[60:63]
ds_read_b64_tr_b16 v[210:211], v250 offset:7168
v_mfma_f32_16x16x32_bf16 v[64:67], v[192:195], v[224:227], v[64:67]
ds_read_b64_tr_b16 v[212:213], v252 offset:3072
v_mfma_f32_16x16x32_bf16 v[68:71], v[192:195], v[228:231], v[68:71]
ds_read_b64_tr_b16 v[214:215], v252 offset:7168
s_waitcnt lgkmcnt(6)
v_mfma_f32_16x16x32_bf16 v[72:75], v[196:199], v[224:227], v[72:75]
ds_read_b64_tr_b16 v[216:217], v254 offset:3072
v_mfma_f32_16x16x32_bf16 v[76:79], v[196:199], v[228:231], v[76:79]
ds_read_b64_tr_b16 v[218:219], v254 offset:7168
v_mfma_f32_16x16x32_bf16 v[80:83], v[200:203], v[224:227], v[80:83]
ds_read_b128 v[192:195], v190 offset:2560
v_mfma_f32_16x16x32_bf16 v[84:87], v[200:203], v[228:231], v[84:87]
s_waitcnt lgkmcnt(5)
v_mfma_f32_16x16x32_bf16 v[88:91], v[204:207], v[224:227], v[88:91]
s_barrier
ds_read_b128 v[232:235], v247 offset:0
ds_read_b128 v[236:239], v247 offset:2048
v_mfma_f32_16x16x32_bf16 v[92:95], v[204:207], v[228:231], v[92:95]
ds_read_b64_tr_b16 v[196:197], v240 offset:16384
ds_read_b64_tr_b16 v[198:199], v240 offset:20480
v_mfma_f32_16x16x32_bf16 v[96:99], v[208:211], v[224:227], v[96:99]
ds_read_b64_tr_b16 v[200:201], v240 offset:16392
v_mfma_f32_16x16x32_bf16 v[100:103], v[208:211], v[228:231], v[100:103]
ds_read_b64_tr_b16 v[202:203], v240 offset:20488
s_waitcnt lgkmcnt(7)
v_mfma_f32_16x16x32_bf16 v[104:107], v[212:215], v[224:227], v[104:107]
ds_read_b64_tr_b16 v[204:205], v240 offset:16400
v_mfma_f32_16x16x32_bf16 v[108:111], v[212:215], v[228:231], v[108:111]
ds_read_b64_tr_b16 v[206:207], v240 offset:20496
v_mfma_f32_16x16x32_bf16 v[112:115], v[216:219], v[224:227], v[112:115]
ds_read_b64_tr_b16 v[208:209], v240 offset:16408
v_mfma_f32_16x16x32_bf16 v[116:119], v[216:219], v[228:231], v[116:119]
ds_read_b64_tr_b16 v[210:211], v240 offset:20504
s_waitcnt lgkmcnt(6)
v_mfma_f32_16x16x32_bf16 v[120:123], v[192:195], v[224:227], v[120:123]
ds_read_b64_tr_b16 v[212:213], v240 offset:16416
v_mfma_f32_16x16x32_bf16 v[124:127], v[192:195], v[228:231], v[124:127]
ds_read_b64_tr_b16 v[214:215], v240 offset:20512
v_mfma_f32_16x16x32_bf16 v[8:11], v[196:199], v[232:235], v[8:11]
ds_read_b64_tr_b16 v[216:217], v240 offset:17664
v_mfma_f32_16x16x32_bf16 v[12:15], v[196:199], v[236:239], v[12:15]
ds_read_b64_tr_b16 v[218:219], v240 offset:21760
s_waitcnt lgkmcnt(6)
v_mfma_f32_16x16x32_bf16 v[16:19], v[200:203], v[232:235], v[16:19]
ds_read_b64_tr_b16 v[192:193], v240 offset:17672
v_mfma_f32_16x16x32_bf16 v[20:23], v[200:203], v[236:239], v[20:23]
ds_read_b64_tr_b16 v[194:195], v240 offset:21768
v_mfma_f32_16x16x32_bf16 v[24:27], v[204:207], v[232:235], v[24:27]
ds_read_b64_tr_b16 v[196:197], v240 offset:17680
v_mfma_f32_16x16x32_bf16 v[28:31], v[204:207], v[236:239], v[28:31]
ds_read_b64_tr_b16 v[198:199], v240 offset:21776
s_waitcnt lgkmcnt(6)
v_mfma_f32_16x16x32_bf16 v[32:35], v[208:211], v[232:235], v[32:35]
ds_read_b64_tr_b16 v[200:201], v240 offset:17688
v_mfma_f32_16x16x32_bf16 v[36:39], v[208:211], v[236:239], v[36:39]
ds_read_b64_tr_b16 v[202:203], v240 offset:21784
v_mfma_f32_16x16x32_bf16 v[40:43], v[212:215], v[232:235], v[40:43]
ds_read_b64_tr_b16 v[204:205], v240 offset:17696
v_mfma_f32_16x16x32_bf16 v[44:47], v[212:215], v[236:239], v[44:47]
ds_read_b64_tr_b16 v[206:207], v240 offset:21792
s_waitcnt lgkmcnt(6)
v_mfma_f32_16x16x32_bf16 v[48:51], v[216:219], v[232:235], v[48:51]
ds_read_b64_tr_b16 v[208:209], v248 offset:19456
v_mfma_f32_16x16x32_bf16 v[52:55], v[216:219], v[236:239], v[52:55]
ds_read_b64_tr_b16 v[210:211], v248 offset:23552
v_mfma_f32_16x16x32_bf16 v[56:59], v[192:195], v[232:235], v[56:59]
ds_read_b64_tr_b16 v[212:213], v250 offset:19456
v_mfma_f32_16x16x32_bf16 v[60:63], v[192:195], v[236:239], v[60:63]
ds_read_b64_tr_b16 v[214:215], v250 offset:23552
s_waitcnt lgkmcnt(6)
v_mfma_f32_16x16x32_bf16 v[64:67], v[196:199], v[232:235], v[64:67]
ds_read_b64_tr_b16 v[216:217], v252 offset:19456
v_mfma_f32_16x16x32_bf16 v[68:71], v[196:199], v[236:239], v[68:71]
ds_read_b64_tr_b16 v[218:219], v252 offset:23552
v_mfma_f32_16x16x32_bf16 v[72:75], v[200:203], v[232:235], v[72:75]
ds_read_b64_tr_b16 v[192:193], v254 offset:19456
v_mfma_f32_16x16x32_bf16 v[76:79], v[200:203], v[236:239], v[76:79]
ds_read_b64_tr_b16 v[194:195], v254 offset:23552
s_waitcnt lgkmcnt(6)
v_mfma_f32_16x16x32_bf16 v[80:83], v[204:207], v[232:235], v[80:83]
ds_read_b128 v[196:199], v190 offset:18944
v_mfma_f32_16x16x32_bf16 v[84:87], v[204:207], v[236:239], v[84:87]
v_mfma_f32_16x16x32_bf16 v[88:91], v[208:211], v[232:235], v[88:91]
s_barrier
ds_read_b128 v[224:227], v246 offset:16384
ds_read_b128 v[228:231], v246 offset:18432
v_mfma_f32_16x16x32_bf16 v[92:95], v[208:211], v[236:239], v[92:95]
ds_read_b64_tr_b16 v[200:201], v240 offset:32768
ds_read_b64_tr_b16 v[202:203], v240 offset:36864
s_waitcnt lgkmcnt(7)
v_mfma_f32_16x16x32_bf16 v[96:99], v[212:215], v[232:235], v[96:99]
ds_read_b64_tr_b16 v[204:205], v240 offset:32776
v_mfma_f32_16x16x32_bf16 v[100:103], v[212:215], v[236:239], v[100:103]
ds_read_b64_tr_b16 v[206:207], v240 offset:36872
v_mfma_f32_16x16x32_bf16 v[104:107], v[216:219], v[232:235], v[104:107]
ds_read_b64_tr_b16 v[208:209], v240 offset:32784
v_mfma_f32_16x16x32_bf16 v[108:111], v[216:219], v[236:239], v[108:111]
ds_read_b64_tr_b16 v[210:211], v240 offset:36880
s_waitcnt lgkmcnt(8)
v_mfma_f32_16x16x32_bf16 v[112:115], v[192:195], v[232:235], v[112:115]
ds_read_b64_tr_b16 v[212:213], v240 offset:32792
v_mfma_f32_16x16x32_bf16 v[116:119], v[192:195], v[236:239], v[116:119]
ds_read_b64_tr_b16 v[214:215], v240 offset:36888
v_mfma_f32_16x16x32_bf16 v[120:123], v[196:199], v[232:235], v[120:123]
ds_read_b64_tr_b16 v[216:217], v240 offset:32800
v_mfma_f32_16x16x32_bf16 v[124:127], v[196:199], v[236:239], v[124:127]
ds_read_b64_tr_b16 v[218:219], v240 offset:36896
s_waitcnt lgkmcnt(6)
v_mfma_f32_16x16x32_bf16 v[8:11], v[200:203], v[224:227], v[8:11]
ds_read_b64_tr_b16 v[192:193], v240 offset:34048
v_mfma_f32_16x16x32_bf16 v[12:15], v[200:203], v[228:231], v[12:15]
ds_read_b64_tr_b16 v[194:195], v240 offset:38144
v_mfma_f32_16x16x32_bf16 v[16:19], v[204:207], v[224:227], v[16:19]
ds_read_b64_tr_b16 v[196:197], v240 offset:34056
v_mfma_f32_16x16x32_bf16 v[20:23], v[204:207], v[228:231], v[20:23]
ds_read_b64_tr_b16 v[198:199], v240 offset:38152
s_waitcnt lgkmcnt(6)
v_mfma_f32_16x16x32_bf16 v[24:27], v[208:211], v[224:227], v[24:27]
ds_read_b64_tr_b16 v[200:201], v240 offset:34064
v_mfma_f32_16x16x32_bf16 v[28:31], v[208:211], v[228:231], v[28:31]
ds_read_b64_tr_b16 v[202:203], v240 offset:38160
v_mfma_f32_16x16x32_bf16 v[32:35], v[212:215], v[224:227], v[32:35]
ds_read_b64_tr_b16 v[204:205], v240 offset:34072
v_mfma_f32_16x16x32_bf16 v[36:39], v[212:215], v[228:231], v[36:39]
ds_read_b64_tr_b16 v[206:207], v240 offset:38168
s_waitcnt lgkmcnt(6)
v_mfma_f32_16x16x32_bf16 v[40:43], v[216:219], v[224:227], v[40:43]
ds_read_b64_tr_b16 v[208:209], v240 offset:34080
v_mfma_f32_16x16x32_bf16 v[44:47], v[216:219], v[228:231], v[44:47]
ds_read_b64_tr_b16 v[210:211], v240 offset:38176
v_mfma_f32_16x16x32_bf16 v[48:51], v[192:195], v[224:227], v[48:51]
ds_read_b64_tr_b16 v[212:213], v248 offset:35840
v_mfma_f32_16x16x32_bf16 v[52:55], v[192:195], v[228:231], v[52:55]
ds_read_b64_tr_b16 v[214:215], v248 offset:39936
s_waitcnt lgkmcnt(6)
v_mfma_f32_16x16x32_bf16 v[56:59], v[196:199], v[224:227], v[56:59]
ds_read_b64_tr_b16 v[216:217], v250 offset:35840
v_mfma_f32_16x16x32_bf16 v[60:63], v[196:199], v[228:231], v[60:63]
ds_read_b64_tr_b16 v[218:219], v250 offset:39936
v_mfma_f32_16x16x32_bf16 v[64:67], v[200:203], v[224:227], v[64:67]
ds_read_b64_tr_b16 v[192:193], v252 offset:35840
v_mfma_f32_16x16x32_bf16 v[68:71], v[200:203], v[228:231], v[68:71]
ds_read_b64_tr_b16 v[194:195], v252 offset:39936
s_waitcnt lgkmcnt(6)
v_mfma_f32_16x16x32_bf16 v[72:75], v[204:207], v[224:227], v[72:75]
ds_read_b64_tr_b16 v[196:197], v254 offset:35840
v_mfma_f32_16x16x32_bf16 v[76:79], v[204:207], v[228:231], v[76:79]
ds_read_b64_tr_b16 v[198:199], v254 offset:39936
v_mfma_f32_16x16x32_bf16 v[80:83], v[208:211], v[224:227], v[80:83]
ds_read_b128 v[200:203], v190 offset:35328
v_mfma_f32_16x16x32_bf16 v[84:87], v[208:211], v[228:231], v[84:87]
s_waitcnt lgkmcnt(5)
v_mfma_f32_16x16x32_bf16 v[88:91], v[212:215], v[224:227], v[88:91]
s_barrier
ds_read_b128 v[232:235], v247 offset:16384
ds_read_b128 v[236:239], v247 offset:18432
v_mfma_f32_16x16x32_bf16 v[92:95], v[212:215], v[228:231], v[92:95]
ds_read_b64_tr_b16 v[204:205], v241 offset:0
ds_read_b64_tr_b16 v[206:207], v241 offset:4096
v_mfma_f32_16x16x32_bf16 v[96:99], v[216:219], v[224:227], v[96:99]
ds_read_b64_tr_b16 v[208:209], v241 offset:8
v_mfma_f32_16x16x32_bf16 v[100:103], v[216:219], v[228:231], v[100:103]
ds_read_b64_tr_b16 v[210:211], v241 offset:4104
s_waitcnt lgkmcnt(7)
v_mfma_f32_16x16x32_bf16 v[104:107], v[192:195], v[224:227], v[104:107]
ds_read_b64_tr_b16 v[212:213], v241 offset:16
v_mfma_f32_16x16x32_bf16 v[108:111], v[192:195], v[228:231], v[108:111]
ds_read_b64_tr_b16 v[214:215], v241 offset:4112
v_mfma_f32_16x16x32_bf16 v[112:115], v[196:199], v[224:227], v[112:115]
ds_read_b64_tr_b16 v[216:217], v241 offset:24
v_mfma_f32_16x16x32_bf16 v[116:119], v[196:199], v[228:231], v[116:119]
ds_read_b64_tr_b16 v[218:219], v241 offset:4120
s_waitcnt lgkmcnt(6)
v_mfma_f32_16x16x32_bf16 v[120:123], v[200:203], v[224:227], v[120:123]
ds_read_b64_tr_b16 v[192:193], v241 offset:32
v_mfma_f32_16x16x32_bf16 v[124:127], v[200:203], v[228:231], v[124:127]
ds_read_b64_tr_b16 v[194:195], v241 offset:4128
v_mfma_f32_16x16x32_bf16 v[8:11], v[204:207], v[232:235], v[8:11]
ds_read_b64_tr_b16 v[196:197], v241 offset:1280
v_mfma_f32_16x16x32_bf16 v[12:15], v[204:207], v[236:239], v[12:15]
ds_read_b64_tr_b16 v[198:199], v241 offset:5376
s_waitcnt lgkmcnt(6)
v_mfma_f32_16x16x32_bf16 v[16:19], v[208:211], v[232:235], v[16:19]
ds_read_b64_tr_b16 v[200:201], v241 offset:1288
v_mfma_f32_16x16x32_bf16 v[20:23], v[208:211], v[236:239], v[20:23]
ds_read_b64_tr_b16 v[202:203], v241 offset:5384
v_mfma_f32_16x16x32_bf16 v[24:27], v[212:215], v[232:235], v[24:27]
ds_read_b64_tr_b16 v[204:205], v241 offset:1296
v_mfma_f32_16x16x32_bf16 v[28:31], v[212:215], v[236:239], v[28:31]
ds_read_b64_tr_b16 v[206:207], v241 offset:5392
s_waitcnt lgkmcnt(6)
v_mfma_f32_16x16x32_bf16 v[32:35], v[216:219], v[232:235], v[32:35]
ds_read_b64_tr_b16 v[208:209], v241 offset:1304
v_mfma_f32_16x16x32_bf16 v[36:39], v[216:219], v[236:239], v[36:39]
ds_read_b64_tr_b16 v[210:211], v241 offset:5400
v_mfma_f32_16x16x32_bf16 v[40:43], v[192:195], v[232:235], v[40:43]
ds_read_b64_tr_b16 v[212:213], v241 offset:1312
v_mfma_f32_16x16x32_bf16 v[44:47], v[192:195], v[236:239], v[44:47]
ds_read_b64_tr_b16 v[214:215], v241 offset:5408
s_waitcnt lgkmcnt(6)
v_mfma_f32_16x16x32_bf16 v[48:51], v[196:199], v[232:235], v[48:51]
ds_read_b64_tr_b16 v[216:217], v249 offset:3072
v_mfma_f32_16x16x32_bf16 v[52:55], v[196:199], v[236:239], v[52:55]
ds_read_b64_tr_b16 v[218:219], v249 offset:7168
v_mfma_f32_16x16x32_bf16 v[56:59], v[200:203], v[232:235], v[56:59]
ds_read_b64_tr_b16 v[192:193], v251 offset:3072
v_mfma_f32_16x16x32_bf16 v[60:63], v[200:203], v[236:239], v[60:63]
ds_read_b64_tr_b16 v[194:195], v251 offset:7168
s_waitcnt lgkmcnt(6)
v_mfma_f32_16x16x32_bf16 v[64:67], v[204:207], v[232:235], v[64:67]
ds_read_b64_tr_b16 v[196:197], v253 offset:3072
v_mfma_f32_16x16x32_bf16 v[68:71], v[204:207], v[236:239], v[68:71]
ds_read_b64_tr_b16 v[198:199], v253 offset:7168
v_mfma_f32_16x16x32_bf16 v[72:75], v[208:211], v[232:235], v[72:75]
ds_read_b64_tr_b16 v[200:201], v255 offset:3072
v_mfma_f32_16x16x32_bf16 v[76:79], v[208:211], v[236:239], v[76:79]
ds_read_b64_tr_b16 v[202:203], v255 offset:7168
s_waitcnt lgkmcnt(6)
v_mfma_f32_16x16x32_bf16 v[80:83], v[212:215], v[232:235], v[80:83]
ds_read_b128 v[204:207], v191 offset:2560
v_mfma_f32_16x16x32_bf16 v[84:87], v[212:215], v[236:239], v[84:87]
v_mfma_f32_16x16x32_bf16 v[88:91], v[216:219], v[232:235], v[88:91]
s_barrier
ds_read_b128 v[224:227], v246 offset:32768
ds_read_b128 v[228:231], v246 offset:34816
v_mfma_f32_16x16x32_bf16 v[92:95], v[216:219], v[236:239], v[92:95]
ds_read_b64_tr_b16 v[208:209], v241 offset:16384
ds_read_b64_tr_b16 v[210:211], v241 offset:20480
s_waitcnt lgkmcnt(7)
v_mfma_f32_16x16x32_bf16 v[96:99], v[192:195], v[232:235], v[96:99]
ds_read_b64_tr_b16 v[212:213], v241 offset:16392
v_mfma_f32_16x16x32_bf16 v[100:103], v[192:195], v[236:239], v[100:103]
ds_read_b64_tr_b16 v[214:215], v241 offset:20488
v_mfma_f32_16x16x32_bf16 v[104:107], v[196:199], v[232:235], v[104:107]
ds_read_b64_tr_b16 v[216:217], v241 offset:16400
v_mfma_f32_16x16x32_bf16 v[108:111], v[196:199], v[236:239], v[108:111]
ds_read_b64_tr_b16 v[218:219], v241 offset:20496
s_waitcnt lgkmcnt(8)
v_mfma_f32_16x16x32_bf16 v[112:115], v[200:203], v[232:235], v[112:115]
ds_read_b64_tr_b16 v[192:193], v241 offset:16408
v_mfma_f32_16x16x32_bf16 v[116:119], v[200:203], v[236:239], v[116:119]
ds_read_b64_tr_b16 v[194:195], v241 offset:20504
v_mfma_f32_16x16x32_bf16 v[120:123], v[204:207], v[232:235], v[120:123]
ds_read_b64_tr_b16 v[196:197], v241 offset:16416
v_mfma_f32_16x16x32_bf16 v[124:127], v[204:207], v[236:239], v[124:127]
ds_read_b64_tr_b16 v[198:199], v241 offset:20512
s_waitcnt lgkmcnt(6)
v_mfma_f32_16x16x32_bf16 v[8:11], v[208:211], v[224:227], v[8:11]
ds_read_b64_tr_b16 v[200:201], v241 offset:17664
v_mfma_f32_16x16x32_bf16 v[12:15], v[208:211], v[228:231], v[12:15]
ds_read_b64_tr_b16 v[202:203], v241 offset:21760
v_mfma_f32_16x16x32_bf16 v[16:19], v[212:215], v[224:227], v[16:19]
ds_read_b64_tr_b16 v[204:205], v241 offset:17672
v_mfma_f32_16x16x32_bf16 v[20:23], v[212:215], v[228:231], v[20:23]
ds_read_b64_tr_b16 v[206:207], v241 offset:21768
s_waitcnt lgkmcnt(6)
v_mfma_f32_16x16x32_bf16 v[24:27], v[216:219], v[224:227], v[24:27]
ds_read_b64_tr_b16 v[208:209], v241 offset:17680
v_mfma_f32_16x16x32_bf16 v[28:31], v[216:219], v[228:231], v[28:31]
ds_read_b64_tr_b16 v[210:211], v241 offset:21776
v_mfma_f32_16x16x32_bf16 v[32:35], v[192:195], v[224:227], v[32:35]
ds_read_b64_tr_b16 v[212:213], v241 offset:17688
v_mfma_f32_16x16x32_bf16 v[36:39], v[192:195], v[228:231], v[36:39]
ds_read_b64_tr_b16 v[214:215], v241 offset:21784
s_waitcnt lgkmcnt(6)
v_mfma_f32_16x16x32_bf16 v[40:43], v[196:199], v[224:227], v[40:43]
ds_read_b64_tr_b16 v[216:217], v241 offset:17696
v_mfma_f32_16x16x32_bf16 v[44:47], v[196:199], v[228:231], v[44:47]
ds_read_b64_tr_b16 v[218:219], v241 offset:21792
v_mfma_f32_16x16x32_bf16 v[48:51], v[200:203], v[224:227], v[48:51]
ds_read_b64_tr_b16 v[192:193], v249 offset:19456
v_mfma_f32_16x16x32_bf16 v[52:55], v[200:203], v[228:231], v[52:55]
ds_read_b64_tr_b16 v[194:195], v249 offset:23552
s_waitcnt lgkmcnt(6)
v_mfma_f32_16x16x32_bf16 v[56:59], v[204:207], v[224:227], v[56:59]
ds_read_b64_tr_b16 v[196:197], v251 offset:19456
v_mfma_f32_16x16x32_bf16 v[60:63], v[204:207], v[228:231], v[60:63]
ds_read_b64_tr_b16 v[198:199], v251 offset:23552
v_mfma_f32_16x16x32_bf16 v[64:67], v[208:211], v[224:227], v[64:67]
ds_read_b64_tr_b16 v[200:201], v253 offset:19456
v_mfma_f32_16x16x32_bf16 v[68:71], v[208:211], v[228:231], v[68:71]
ds_read_b64_tr_b16 v[202:203], v253 offset:23552
s_waitcnt lgkmcnt(6)
v_mfma_f32_16x16x32_bf16 v[72:75], v[212:215], v[224:227], v[72:75]
ds_read_b64_tr_b16 v[204:205], v255 offset:19456
v_mfma_f32_16x16x32_bf16 v[76:79], v[212:215], v[228:231], v[76:79]
ds_read_b64_tr_b16 v[206:207], v255 offset:23552
v_mfma_f32_16x16x32_bf16 v[80:83], v[216:219], v[224:227], v[80:83]
ds_read_b128 v[208:211], v191 offset:18944
v_mfma_f32_16x16x32_bf16 v[84:87], v[216:219], v[228:231], v[84:87]
s_waitcnt lgkmcnt(5)
v_mfma_f32_16x16x32_bf16 v[88:91], v[192:195], v[224:227], v[88:91]
s_barrier
ds_read_b128 v[232:235], v247 offset:32768
ds_read_b128 v[236:239], v247 offset:34816
v_mfma_f32_16x16x32_bf16 v[92:95], v[192:195], v[228:231], v[92:95]
ds_read_b64_tr_b16 v[212:213], v240 offset:0
ds_read_b64_tr_b16 v[214:215], v240 offset:4096
v_mfma_f32_16x16x32_bf16 v[96:99], v[196:199], v[224:227], v[96:99]
ds_read_b64_tr_b16 v[216:217], v240 offset:8
v_mfma_f32_16x16x32_bf16 v[100:103], v[196:199], v[228:231], v[100:103]
ds_read_b64_tr_b16 v[218:219], v240 offset:4104
s_waitcnt lgkmcnt(7)
v_mfma_f32_16x16x32_bf16 v[104:107], v[200:203], v[224:227], v[104:107]
ds_read_b64_tr_b16 v[192:193], v240 offset:16
v_mfma_f32_16x16x32_bf16 v[108:111], v[200:203], v[228:231], v[108:111]
ds_read_b64_tr_b16 v[194:195], v240 offset:4112
v_mfma_f32_16x16x32_bf16 v[112:115], v[204:207], v[224:227], v[112:115]
ds_read_b64_tr_b16 v[196:197], v240 offset:24
v_mfma_f32_16x16x32_bf16 v[116:119], v[204:207], v[228:231], v[116:119]
ds_read_b64_tr_b16 v[198:199], v240 offset:4120
s_waitcnt lgkmcnt(6)
v_mfma_f32_16x16x32_bf16 v[120:123], v[208:211], v[224:227], v[120:123]
ds_read_b64_tr_b16 v[200:201], v240 offset:32
v_mfma_f32_16x16x32_bf16 v[124:127], v[208:211], v[228:231], v[124:127]
ds_read_b64_tr_b16 v[202:203], v240 offset:4128
v_mfma_f32_16x16x32_bf16 v[8:11], v[212:215], v[232:235], v[8:11]
ds_read_b64_tr_b16 v[204:205], v240 offset:1280
v_mfma_f32_16x16x32_bf16 v[12:15], v[212:215], v[236:239], v[12:15]
ds_read_b64_tr_b16 v[206:207], v240 offset:5376
s_waitcnt lgkmcnt(6)
v_mfma_f32_16x16x32_bf16 v[16:19], v[216:219], v[232:235], v[16:19]
ds_read_b64_tr_b16 v[208:209], v240 offset:1288
v_mfma_f32_16x16x32_bf16 v[20:23], v[216:219], v[236:239], v[20:23]
ds_read_b64_tr_b16 v[210:211], v240 offset:5384
v_mfma_f32_16x16x32_bf16 v[24:27], v[192:195], v[232:235], v[24:27]
ds_read_b64_tr_b16 v[212:213], v240 offset:1296
v_mfma_f32_16x16x32_bf16 v[28:31], v[192:195], v[236:239], v[28:31]
ds_read_b64_tr_b16 v[214:215], v240 offset:5392
s_waitcnt lgkmcnt(6)
v_mfma_f32_16x16x32_bf16 v[32:35], v[196:199], v[232:235], v[32:35]
ds_read_b64_tr_b16 v[216:217], v240 offset:1304
v_mfma_f32_16x16x32_bf16 v[36:39], v[196:199], v[236:239], v[36:39]
ds_read_b64_tr_b16 v[218:219], v240 offset:5400
v_mfma_f32_16x16x32_bf16 v[40:43], v[200:203], v[232:235], v[40:43]
ds_read_b64_tr_b16 v[192:193], v240 offset:1312
v_mfma_f32_16x16x32_bf16 v[44:47], v[200:203], v[236:239], v[44:47]
ds_read_b64_tr_b16 v[194:195], v240 offset:5408
s_waitcnt lgkmcnt(6)
v_mfma_f32_16x16x32_bf16 v[48:51], v[204:207], v[232:235], v[48:51]
ds_read_b64_tr_b16 v[196:197], v248 offset:3072
v_mfma_f32_16x16x32_bf16 v[52:55], v[204:207], v[236:239], v[52:55]
ds_read_b64_tr_b16 v[198:199], v248 offset:7168
v_mfma_f32_16x16x32_bf16 v[56:59], v[208:211], v[232:235], v[56:59]
ds_read_b64_tr_b16 v[200:201], v250 offset:3072
v_mfma_f32_16x16x32_bf16 v[60:63], v[208:211], v[236:239], v[60:63]
ds_read_b64_tr_b16 v[202:203], v250 offset:7168
s_waitcnt lgkmcnt(6)
v_mfma_f32_16x16x32_bf16 v[64:67], v[212:215], v[232:235], v[64:67]
ds_read_b64_tr_b16 v[204:205], v252 offset:3072
v_mfma_f32_16x16x32_bf16 v[68:71], v[212:215], v[236:239], v[68:71]
ds_read_b64_tr_b16 v[206:207], v252 offset:7168
v_mfma_f32_16x16x32_bf16 v[72:75], v[216:219], v[232:235], v[72:75]
ds_read_b64_tr_b16 v[208:209], v254 offset:3072
v_mfma_f32_16x16x32_bf16 v[76:79], v[216:219], v[236:239], v[76:79]
ds_read_b64_tr_b16 v[210:211], v254 offset:7168
s_waitcnt lgkmcnt(6)
v_mfma_f32_16x16x32_bf16 v[80:83], v[192:195], v[232:235], v[80:83]
ds_read_b128 v[212:215], v190 offset:2560
v_mfma_f32_16x16x32_bf16 v[84:87], v[192:195], v[236:239], v[84:87]
v_mfma_f32_16x16x32_bf16 v[88:91], v[196:199], v[232:235], v[88:91]
s_barrier
ds_read_b128 v[224:227], v246 offset:0
ds_read_b128 v[228:231], v246 offset:2048
v_mfma_f32_16x16x32_bf16 v[92:95], v[196:199], v[236:239], v[92:95]
ds_read_b64_tr_b16 v[216:217], v240 offset:16384
ds_read_b64_tr_b16 v[218:219], v240 offset:20480
s_waitcnt lgkmcnt(7)
v_mfma_f32_16x16x32_bf16 v[96:99], v[200:203], v[232:235], v[96:99]
ds_read_b64_tr_b16 v[192:193], v240 offset:16392
v_mfma_f32_16x16x32_bf16 v[100:103], v[200:203], v[236:239], v[100:103]
ds_read_b64_tr_b16 v[194:195], v240 offset:20488
v_mfma_f32_16x16x32_bf16 v[104:107], v[204:207], v[232:235], v[104:107]
ds_read_b64_tr_b16 v[196:197], v240 offset:16400
v_mfma_f32_16x16x32_bf16 v[108:111], v[204:207], v[236:239], v[108:111]
ds_read_b64_tr_b16 v[198:199], v240 offset:20496
s_waitcnt lgkmcnt(8)
v_mfma_f32_16x16x32_bf16 v[112:115], v[208:211], v[232:235], v[112:115]
ds_read_b64_tr_b16 v[200:201], v240 offset:16408
v_mfma_f32_16x16x32_bf16 v[116:119], v[208:211], v[236:239], v[116:119]
ds_read_b64_tr_b16 v[202:203], v240 offset:20504
v_mfma_f32_16x16x32_bf16 v[120:123], v[212:215], v[232:235], v[120:123]
ds_read_b64_tr_b16 v[204:205], v240 offset:16416
v_mfma_f32_16x16x32_bf16 v[124:127], v[212:215], v[236:239], v[124:127]
ds_read_b64_tr_b16 v[206:207], v240 offset:20512
s_waitcnt lgkmcnt(6)
v_mfma_f32_16x16x32_bf16 v[8:11], v[216:219], v[224:227], v[8:11]
ds_read_b64_tr_b16 v[208:209], v240 offset:17664
v_mfma_f32_16x16x32_bf16 v[12:15], v[216:219], v[228:231], v[12:15]
ds_read_b64_tr_b16 v[210:211], v240 offset:21760
v_mfma_f32_16x16x32_bf16 v[16:19], v[192:195], v[224:227], v[16:19]
ds_read_b64_tr_b16 v[212:213], v240 offset:17672
v_mfma_f32_16x16x32_bf16 v[20:23], v[192:195], v[228:231], v[20:23]
ds_read_b64_tr_b16 v[214:215], v240 offset:21768
s_waitcnt lgkmcnt(6)
v_mfma_f32_16x16x32_bf16 v[24:27], v[196:199], v[224:227], v[24:27]
ds_read_b64_tr_b16 v[216:217], v240 offset:17680
v_mfma_f32_16x16x32_bf16 v[28:31], v[196:199], v[228:231], v[28:31]
ds_read_b64_tr_b16 v[218:219], v240 offset:21776
v_mfma_f32_16x16x32_bf16 v[32:35], v[200:203], v[224:227], v[32:35]
ds_read_b64_tr_b16 v[192:193], v240 offset:17688
v_mfma_f32_16x16x32_bf16 v[36:39], v[200:203], v[228:231], v[36:39]
ds_read_b64_tr_b16 v[194:195], v240 offset:21784
s_waitcnt lgkmcnt(6)
v_mfma_f32_16x16x32_bf16 v[40:43], v[204:207], v[224:227], v[40:43]
ds_read_b64_tr_b16 v[196:197], v240 offset:17696
v_mfma_f32_16x16x32_bf16 v[44:47], v[204:207], v[228:231], v[44:47]
ds_read_b64_tr_b16 v[198:199], v240 offset:21792
v_mfma_f32_16x16x32_bf16 v[48:51], v[208:211], v[224:227], v[48:51]
ds_read_b64_tr_b16 v[200:201], v248 offset:19456
v_mfma_f32_16x16x32_bf16 v[52:55], v[208:211], v[228:231], v[52:55]
ds_read_b64_tr_b16 v[202:203], v248 offset:23552
s_waitcnt lgkmcnt(6)
v_mfma_f32_16x16x32_bf16 v[56:59], v[212:215], v[224:227], v[56:59]
ds_read_b64_tr_b16 v[204:205], v250 offset:19456
v_mfma_f32_16x16x32_bf16 v[60:63], v[212:215], v[228:231], v[60:63]
ds_read_b64_tr_b16 v[206:207], v250 offset:23552
v_mfma_f32_16x16x32_bf16 v[64:67], v[216:219], v[224:227], v[64:67]
ds_read_b64_tr_b16 v[208:209], v252 offset:19456
v_mfma_f32_16x16x32_bf16 v[68:71], v[216:219], v[228:231], v[68:71]
ds_read_b64_tr_b16 v[210:211], v252 offset:23552
s_waitcnt lgkmcnt(6)
v_mfma_f32_16x16x32_bf16 v[72:75], v[192:195], v[224:227], v[72:75]
ds_read_b64_tr_b16 v[212:213], v254 offset:19456
v_mfma_f32_16x16x32_bf16 v[76:79], v[192:195], v[228:231], v[76:79]
ds_read_b64_tr_b16 v[214:215], v254 offset:23552
v_mfma_f32_16x16x32_bf16 v[80:83], v[196:199], v[224:227], v[80:83]
ds_read_b128 v[216:219], v190 offset:18944
v_mfma_f32_16x16x32_bf16 v[84:87], v[196:199], v[228:231], v[84:87]
s_waitcnt lgkmcnt(5)
v_mfma_f32_16x16x32_bf16 v[88:91], v[200:203], v[224:227], v[88:91]
s_barrier
ds_read_b128 v[232:235], v247 offset:0
ds_read_b128 v[236:239], v247 offset:2048
v_mfma_f32_16x16x32_bf16 v[92:95], v[200:203], v[228:231], v[92:95]
ds_read_b64_tr_b16 v[192:193], v240 offset:32768
ds_read_b64_tr_b16 v[194:195], v240 offset:36864
v_mfma_f32_16x16x32_bf16 v[96:99], v[204:207], v[224:227], v[96:99]
ds_read_b64_tr_b16 v[196:197], v240 offset:32776
v_mfma_f32_16x16x32_bf16 v[100:103], v[204:207], v[228:231], v[100:103]
ds_read_b64_tr_b16 v[198:199], v240 offset:36872
s_waitcnt lgkmcnt(7)
v_mfma_f32_16x16x32_bf16 v[104:107], v[208:211], v[224:227], v[104:107]
ds_read_b64_tr_b16 v[200:201], v240 offset:32784
v_mfma_f32_16x16x32_bf16 v[108:111], v[208:211], v[228:231], v[108:111]
ds_read_b64_tr_b16 v[202:203], v240 offset:36880
v_mfma_f32_16x16x32_bf16 v[112:115], v[212:215], v[224:227], v[112:115]
ds_read_b64_tr_b16 v[204:205], v240 offset:32792
v_mfma_f32_16x16x32_bf16 v[116:119], v[212:215], v[228:231], v[116:119]
ds_read_b64_tr_b16 v[206:207], v240 offset:36888
s_waitcnt lgkmcnt(6)
v_mfma_f32_16x16x32_bf16 v[120:123], v[216:219], v[224:227], v[120:123]
ds_read_b64_tr_b16 v[208:209], v240 offset:32800
v_mfma_f32_16x16x32_bf16 v[124:127], v[216:219], v[228:231], v[124:127]
ds_read_b64_tr_b16 v[210:211], v240 offset:36896
v_mfma_f32_16x16x32_bf16 v[8:11], v[192:195], v[232:235], v[8:11]
ds_read_b64_tr_b16 v[212:213], v240 offset:34048
v_mfma_f32_16x16x32_bf16 v[12:15], v[192:195], v[236:239], v[12:15]
ds_read_b64_tr_b16 v[214:215], v240 offset:38144
s_waitcnt lgkmcnt(6)
v_mfma_f32_16x16x32_bf16 v[16:19], v[196:199], v[232:235], v[16:19]
ds_read_b64_tr_b16 v[216:217], v240 offset:34056
v_mfma_f32_16x16x32_bf16 v[20:23], v[196:199], v[236:239], v[20:23]
ds_read_b64_tr_b16 v[218:219], v240 offset:38152
v_mfma_f32_16x16x32_bf16 v[24:27], v[200:203], v[232:235], v[24:27]
ds_read_b64_tr_b16 v[192:193], v240 offset:34064
v_mfma_f32_16x16x32_bf16 v[28:31], v[200:203], v[236:239], v[28:31]
ds_read_b64_tr_b16 v[194:195], v240 offset:38160
s_waitcnt lgkmcnt(6)
v_mfma_f32_16x16x32_bf16 v[32:35], v[204:207], v[232:235], v[32:35]
ds_read_b64_tr_b16 v[196:197], v240 offset:34072
v_mfma_f32_16x16x32_bf16 v[36:39], v[204:207], v[236:239], v[36:39]
ds_read_b64_tr_b16 v[198:199], v240 offset:38168
v_mfma_f32_16x16x32_bf16 v[40:43], v[208:211], v[232:235], v[40:43]
ds_read_b64_tr_b16 v[200:201], v240 offset:34080
v_mfma_f32_16x16x32_bf16 v[44:47], v[208:211], v[236:239], v[44:47]
ds_read_b64_tr_b16 v[202:203], v240 offset:38176
s_waitcnt lgkmcnt(6)
v_mfma_f32_16x16x32_bf16 v[48:51], v[212:215], v[232:235], v[48:51]
ds_read_b64_tr_b16 v[204:205], v248 offset:35840
v_mfma_f32_16x16x32_bf16 v[52:55], v[212:215], v[236:239], v[52:55]
ds_read_b64_tr_b16 v[206:207], v248 offset:39936
v_mfma_f32_16x16x32_bf16 v[56:59], v[216:219], v[232:235], v[56:59]
ds_read_b64_tr_b16 v[208:209], v250 offset:35840
v_mfma_f32_16x16x32_bf16 v[60:63], v[216:219], v[236:239], v[60:63]
ds_read_b64_tr_b16 v[210:211], v250 offset:39936
s_waitcnt lgkmcnt(6)
v_mfma_f32_16x16x32_bf16 v[64:67], v[192:195], v[232:235], v[64:67]
ds_read_b64_tr_b16 v[212:213], v252 offset:35840
v_mfma_f32_16x16x32_bf16 v[68:71], v[192:195], v[236:239], v[68:71]
ds_read_b64_tr_b16 v[214:215], v252 offset:39936
v_mfma_f32_16x16x32_bf16 v[72:75], v[196:199], v[232:235], v[72:75]
ds_read_b64_tr_b16 v[216:217], v254 offset:35840
v_mfma_f32_16x16x32_bf16 v[76:79], v[196:199], v[236:239], v[76:79]
ds_read_b64_tr_b16 v[218:219], v254 offset:39936
s_waitcnt lgkmcnt(6)
v_mfma_f32_16x16x32_bf16 v[80:83], v[200:203], v[232:235], v[80:83]
ds_read_b128 v[192:195], v190 offset:35328
v_mfma_f32_16x16x32_bf16 v[84:87], v[200:203], v[236:239], v[84:87]
v_mfma_f32_16x16x32_bf16 v[88:91], v[204:207], v[232:235], v[88:91]
s_barrier
ds_read_b128 v[224:227], v246 offset:16384
ds_read_b128 v[228:231], v246 offset:18432
v_mfma_f32_16x16x32_bf16 v[92:95], v[204:207], v[236:239], v[92:95]
ds_read_b64_tr_b16 v[196:197], v241 offset:0
ds_read_b64_tr_b16 v[198:199], v241 offset:4096
s_waitcnt lgkmcnt(7)
v_mfma_f32_16x16x32_bf16 v[96:99], v[208:211], v[232:235], v[96:99]
ds_read_b64_tr_b16 v[200:201], v241 offset:8
v_mfma_f32_16x16x32_bf16 v[100:103], v[208:211], v[236:239], v[100:103]
ds_read_b64_tr_b16 v[202:203], v241 offset:4104
v_mfma_f32_16x16x32_bf16 v[104:107], v[212:215], v[232:235], v[104:107]
ds_read_b64_tr_b16 v[204:205], v241 offset:16
v_mfma_f32_16x16x32_bf16 v[108:111], v[212:215], v[236:239], v[108:111]
ds_read_b64_tr_b16 v[206:207], v241 offset:4112
s_waitcnt lgkmcnt(8)
v_mfma_f32_16x16x32_bf16 v[112:115], v[216:219], v[232:235], v[112:115]
ds_read_b64_tr_b16 v[208:209], v241 offset:24
v_mfma_f32_16x16x32_bf16 v[116:119], v[216:219], v[236:239], v[116:119]
ds_read_b64_tr_b16 v[210:211], v241 offset:4120
v_mfma_f32_16x16x32_bf16 v[120:123], v[192:195], v[232:235], v[120:123]
ds_read_b64_tr_b16 v[212:213], v241 offset:32
v_mfma_f32_16x16x32_bf16 v[124:127], v[192:195], v[236:239], v[124:127]
ds_read_b64_tr_b16 v[214:215], v241 offset:4128
s_waitcnt lgkmcnt(6)
v_mfma_f32_16x16x32_bf16 v[8:11], v[196:199], v[224:227], v[8:11]
ds_read_b64_tr_b16 v[216:217], v241 offset:1280
v_mfma_f32_16x16x32_bf16 v[12:15], v[196:199], v[228:231], v[12:15]
ds_read_b64_tr_b16 v[218:219], v241 offset:5376
v_mfma_f32_16x16x32_bf16 v[16:19], v[200:203], v[224:227], v[16:19]
ds_read_b64_tr_b16 v[192:193], v241 offset:1288
v_mfma_f32_16x16x32_bf16 v[20:23], v[200:203], v[228:231], v[20:23]
ds_read_b64_tr_b16 v[194:195], v241 offset:5384
s_waitcnt lgkmcnt(6)
v_mfma_f32_16x16x32_bf16 v[24:27], v[204:207], v[224:227], v[24:27]
ds_read_b64_tr_b16 v[196:197], v241 offset:1296
v_mfma_f32_16x16x32_bf16 v[28:31], v[204:207], v[228:231], v[28:31]
ds_read_b64_tr_b16 v[198:199], v241 offset:5392
v_mfma_f32_16x16x32_bf16 v[32:35], v[208:211], v[224:227], v[32:35]
ds_read_b64_tr_b16 v[200:201], v241 offset:1304
v_mfma_f32_16x16x32_bf16 v[36:39], v[208:211], v[228:231], v[36:39]
ds_read_b64_tr_b16 v[202:203], v241 offset:5400
s_waitcnt lgkmcnt(6)
v_mfma_f32_16x16x32_bf16 v[40:43], v[212:215], v[224:227], v[40:43]
ds_read_b64_tr_b16 v[204:205], v241 offset:1312
v_mfma_f32_16x16x32_bf16 v[44:47], v[212:215], v[228:231], v[44:47]
ds_read_b64_tr_b16 v[206:207], v241 offset:5408
v_mfma_f32_16x16x32_bf16 v[48:51], v[216:219], v[224:227], v[48:51]
ds_read_b64_tr_b16 v[208:209], v249 offset:3072
v_mfma_f32_16x16x32_bf16 v[52:55], v[216:219], v[228:231], v[52:55]
ds_read_b64_tr_b16 v[210:211], v249 offset:7168
s_waitcnt lgkmcnt(6)
v_mfma_f32_16x16x32_bf16 v[56:59], v[192:195], v[224:227], v[56:59]
ds_read_b64_tr_b16 v[212:213], v251 offset:3072
v_mfma_f32_16x16x32_bf16 v[60:63], v[192:195], v[228:231], v[60:63]
ds_read_b64_tr_b16 v[214:215], v251 offset:7168
v_mfma_f32_16x16x32_bf16 v[64:67], v[196:199], v[224:227], v[64:67]
ds_read_b64_tr_b16 v[216:217], v253 offset:3072
v_mfma_f32_16x16x32_bf16 v[68:71], v[196:199], v[228:231], v[68:71]
ds_read_b64_tr_b16 v[218:219], v253 offset:7168
s_waitcnt lgkmcnt(6)
v_mfma_f32_16x16x32_bf16 v[72:75], v[200:203], v[224:227], v[72:75]
ds_read_b64_tr_b16 v[192:193], v255 offset:3072
v_mfma_f32_16x16x32_bf16 v[76:79], v[200:203], v[228:231], v[76:79]
ds_read_b64_tr_b16 v[194:195], v255 offset:7168
v_mfma_f32_16x16x32_bf16 v[80:83], v[204:207], v[224:227], v[80:83]
ds_read_b128 v[196:199], v191 offset:2560
v_mfma_f32_16x16x32_bf16 v[84:87], v[204:207], v[228:231], v[84:87]
s_waitcnt lgkmcnt(5)
v_mfma_f32_16x16x32_bf16 v[88:91], v[208:211], v[224:227], v[88:91]
s_barrier
ds_read_b128 v[232:235], v247 offset:16384
ds_read_b128 v[236:239], v247 offset:18432
v_mfma_f32_16x16x32_bf16 v[92:95], v[208:211], v[228:231], v[92:95]
ds_read_b64_tr_b16 v[200:201], v241 offset:16384
ds_read_b64_tr_b16 v[202:203], v241 offset:20480
v_mfma_f32_16x16x32_bf16 v[96:99], v[212:215], v[224:227], v[96:99]
ds_read_b64_tr_b16 v[204:205], v241 offset:16392
v_mfma_f32_16x16x32_bf16 v[100:103], v[212:215], v[228:231], v[100:103]
ds_read_b64_tr_b16 v[206:207], v241 offset:20488
s_waitcnt lgkmcnt(7)
v_mfma_f32_16x16x32_bf16 v[104:107], v[216:219], v[224:227], v[104:107]
ds_read_b64_tr_b16 v[208:209], v241 offset:16400
v_mfma_f32_16x16x32_bf16 v[108:111], v[216:219], v[228:231], v[108:111]
ds_read_b64_tr_b16 v[210:211], v241 offset:20496
v_mfma_f32_16x16x32_bf16 v[112:115], v[192:195], v[224:227], v[112:115]
ds_read_b64_tr_b16 v[212:213], v241 offset:16408
v_mfma_f32_16x16x32_bf16 v[116:119], v[192:195], v[228:231], v[116:119]
ds_read_b64_tr_b16 v[214:215], v241 offset:20504
s_waitcnt lgkmcnt(6)
v_mfma_f32_16x16x32_bf16 v[120:123], v[196:199], v[224:227], v[120:123]
ds_read_b64_tr_b16 v[216:217], v241 offset:16416
v_mfma_f32_16x16x32_bf16 v[124:127], v[196:199], v[228:231], v[124:127]
ds_read_b64_tr_b16 v[218:219], v241 offset:20512
v_mfma_f32_16x16x32_bf16 v[8:11], v[200:203], v[232:235], v[8:11]
ds_read_b64_tr_b16 v[192:193], v241 offset:17664
v_mfma_f32_16x16x32_bf16 v[12:15], v[200:203], v[236:239], v[12:15]
ds_read_b64_tr_b16 v[194:195], v241 offset:21760
s_waitcnt lgkmcnt(6)
v_mfma_f32_16x16x32_bf16 v[16:19], v[204:207], v[232:235], v[16:19]
ds_read_b64_tr_b16 v[196:197], v241 offset:17672
v_mfma_f32_16x16x32_bf16 v[20:23], v[204:207], v[236:239], v[20:23]
ds_read_b64_tr_b16 v[198:199], v241 offset:21768
v_mfma_f32_16x16x32_bf16 v[24:27], v[208:211], v[232:235], v[24:27]
ds_read_b64_tr_b16 v[200:201], v241 offset:17680
v_mfma_f32_16x16x32_bf16 v[28:31], v[208:211], v[236:239], v[28:31]
ds_read_b64_tr_b16 v[202:203], v241 offset:21776
s_waitcnt lgkmcnt(6)
v_mfma_f32_16x16x32_bf16 v[32:35], v[212:215], v[232:235], v[32:35]
ds_read_b64_tr_b16 v[204:205], v241 offset:17688
v_mfma_f32_16x16x32_bf16 v[36:39], v[212:215], v[236:239], v[36:39]
ds_read_b64_tr_b16 v[206:207], v241 offset:21784
v_mfma_f32_16x16x32_bf16 v[40:43], v[216:219], v[232:235], v[40:43]
ds_read_b64_tr_b16 v[208:209], v241 offset:17696
v_mfma_f32_16x16x32_bf16 v[44:47], v[216:219], v[236:239], v[44:47]
ds_read_b64_tr_b16 v[210:211], v241 offset:21792
s_waitcnt lgkmcnt(6)
v_mfma_f32_16x16x32_bf16 v[48:51], v[192:195], v[232:235], v[48:51]
ds_read_b64_tr_b16 v[212:213], v249 offset:19456
v_mfma_f32_16x16x32_bf16 v[52:55], v[192:195], v[236:239], v[52:55]
ds_read_b64_tr_b16 v[214:215], v249 offset:23552
v_mfma_f32_16x16x32_bf16 v[56:59], v[196:199], v[232:235], v[56:59]
ds_read_b64_tr_b16 v[216:217], v251 offset:19456
v_mfma_f32_16x16x32_bf16 v[60:63], v[196:199], v[236:239], v[60:63]
ds_read_b64_tr_b16 v[218:219], v251 offset:23552
s_waitcnt lgkmcnt(6)
v_mfma_f32_16x16x32_bf16 v[64:67], v[200:203], v[232:235], v[64:67]
ds_read_b64_tr_b16 v[192:193], v253 offset:19456
v_mfma_f32_16x16x32_bf16 v[68:71], v[200:203], v[236:239], v[68:71]
ds_read_b64_tr_b16 v[194:195], v253 offset:23552
v_mfma_f32_16x16x32_bf16 v[72:75], v[204:207], v[232:235], v[72:75]
ds_read_b64_tr_b16 v[196:197], v255 offset:19456
v_mfma_f32_16x16x32_bf16 v[76:79], v[204:207], v[236:239], v[76:79]
ds_read_b64_tr_b16 v[198:199], v255 offset:23552
s_waitcnt lgkmcnt(6)
v_mfma_f32_16x16x32_bf16 v[80:83], v[208:211], v[232:235], v[80:83]
ds_read_b128 v[200:203], v191 offset:18944
v_mfma_f32_16x16x32_bf16 v[84:87], v[208:211], v[236:239], v[84:87]
v_mfma_f32_16x16x32_bf16 v[88:91], v[212:215], v[232:235], v[88:91]
s_barrier
ds_read_b128 v[224:227], v246 offset:32768
ds_read_b128 v[228:231], v246 offset:34816
v_mfma_f32_16x16x32_bf16 v[92:95], v[212:215], v[236:239], v[92:95]
ds_read_b64_tr_b16 v[204:205], v240 offset:0
ds_read_b64_tr_b16 v[206:207], v240 offset:4096
s_waitcnt lgkmcnt(7)
v_mfma_f32_16x16x32_bf16 v[96:99], v[216:219], v[232:235], v[96:99]
ds_read_b64_tr_b16 v[208:209], v240 offset:8
v_mfma_f32_16x16x32_bf16 v[100:103], v[216:219], v[236:239], v[100:103]
ds_read_b64_tr_b16 v[210:211], v240 offset:4104
v_mfma_f32_16x16x32_bf16 v[104:107], v[192:195], v[232:235], v[104:107]
ds_read_b64_tr_b16 v[212:213], v240 offset:16
v_mfma_f32_16x16x32_bf16 v[108:111], v[192:195], v[236:239], v[108:111]
ds_read_b64_tr_b16 v[214:215], v240 offset:4112
s_waitcnt lgkmcnt(8)
v_mfma_f32_16x16x32_bf16 v[112:115], v[196:199], v[232:235], v[112:115]
ds_read_b64_tr_b16 v[216:217], v240 offset:24
v_mfma_f32_16x16x32_bf16 v[116:119], v[196:199], v[236:239], v[116:119]
ds_read_b64_tr_b16 v[218:219], v240 offset:4120
v_mfma_f32_16x16x32_bf16 v[120:123], v[200:203], v[232:235], v[120:123]
ds_read_b64_tr_b16 v[192:193], v240 offset:32
v_mfma_f32_16x16x32_bf16 v[124:127], v[200:203], v[236:239], v[124:127]
ds_read_b64_tr_b16 v[194:195], v240 offset:4128
s_waitcnt lgkmcnt(6)
v_mfma_f32_16x16x32_bf16 v[8:11], v[204:207], v[224:227], v[8:11]
ds_read_b64_tr_b16 v[196:197], v240 offset:1280
v_mfma_f32_16x16x32_bf16 v[12:15], v[204:207], v[228:231], v[12:15]
ds_read_b64_tr_b16 v[198:199], v240 offset:5376
v_mfma_f32_16x16x32_bf16 v[16:19], v[208:211], v[224:227], v[16:19]
ds_read_b64_tr_b16 v[200:201], v240 offset:1288
v_mfma_f32_16x16x32_bf16 v[20:23], v[208:211], v[228:231], v[20:23]
ds_read_b64_tr_b16 v[202:203], v240 offset:5384
s_waitcnt lgkmcnt(6)
v_mfma_f32_16x16x32_bf16 v[24:27], v[212:215], v[224:227], v[24:27]
ds_read_b64_tr_b16 v[204:205], v240 offset:1296
v_mfma_f32_16x16x32_bf16 v[28:31], v[212:215], v[228:231], v[28:31]
ds_read_b64_tr_b16 v[206:207], v240 offset:5392
v_mfma_f32_16x16x32_bf16 v[32:35], v[216:219], v[224:227], v[32:35]
ds_read_b64_tr_b16 v[208:209], v240 offset:1304
v_mfma_f32_16x16x32_bf16 v[36:39], v[216:219], v[228:231], v[36:39]
ds_read_b64_tr_b16 v[210:211], v240 offset:5400
s_waitcnt lgkmcnt(6)
v_mfma_f32_16x16x32_bf16 v[40:43], v[192:195], v[224:227], v[40:43]
ds_read_b64_tr_b16 v[212:213], v240 offset:1312
v_mfma_f32_16x16x32_bf16 v[44:47], v[192:195], v[228:231], v[44:47]
ds_read_b64_tr_b16 v[214:215], v240 offset:5408
v_mfma_f32_16x16x32_bf16 v[48:51], v[196:199], v[224:227], v[48:51]
ds_read_b64_tr_b16 v[216:217], v248 offset:3072
v_mfma_f32_16x16x32_bf16 v[52:55], v[196:199], v[228:231], v[52:55]
ds_read_b64_tr_b16 v[218:219], v248 offset:7168
s_waitcnt lgkmcnt(6)
v_mfma_f32_16x16x32_bf16 v[56:59], v[200:203], v[224:227], v[56:59]
ds_read_b64_tr_b16 v[192:193], v250 offset:3072
v_mfma_f32_16x16x32_bf16 v[60:63], v[200:203], v[228:231], v[60:63]
ds_read_b64_tr_b16 v[194:195], v250 offset:7168
v_mfma_f32_16x16x32_bf16 v[64:67], v[204:207], v[224:227], v[64:67]
ds_read_b64_tr_b16 v[196:197], v252 offset:3072
v_mfma_f32_16x16x32_bf16 v[68:71], v[204:207], v[228:231], v[68:71]
ds_read_b64_tr_b16 v[198:199], v252 offset:7168
s_waitcnt lgkmcnt(6)
v_mfma_f32_16x16x32_bf16 v[72:75], v[208:211], v[224:227], v[72:75]
ds_read_b64_tr_b16 v[200:201], v254 offset:3072
v_mfma_f32_16x16x32_bf16 v[76:79], v[208:211], v[228:231], v[76:79]
ds_read_b64_tr_b16 v[202:203], v254 offset:7168
v_mfma_f32_16x16x32_bf16 v[80:83], v[212:215], v[224:227], v[80:83]
ds_read_b128 v[204:207], v190 offset:2560
v_mfma_f32_16x16x32_bf16 v[84:87], v[212:215], v[228:231], v[84:87]
s_waitcnt lgkmcnt(5)
v_mfma_f32_16x16x32_bf16 v[88:91], v[216:219], v[224:227], v[88:91]
s_barrier
ds_read_b128 v[232:235], v247 offset:32768
ds_read_b128 v[236:239], v247 offset:34816
v_mfma_f32_16x16x32_bf16 v[92:95], v[216:219], v[228:231], v[92:95]
ds_read_b64_tr_b16 v[208:209], v240 offset:16384
ds_read_b64_tr_b16 v[210:211], v240 offset:20480
v_mfma_f32_16x16x32_bf16 v[96:99], v[192:195], v[224:227], v[96:99]
ds_read_b64_tr_b16 v[212:213], v240 offset:16392
v_mfma_f32_16x16x32_bf16 v[100:103], v[192:195], v[228:231], v[100:103]
ds_read_b64_tr_b16 v[214:215], v240 offset:20488
s_waitcnt lgkmcnt(7)
v_mfma_f32_16x16x32_bf16 v[104:107], v[196:199], v[224:227], v[104:107]
ds_read_b64_tr_b16 v[216:217], v240 offset:16400
v_mfma_f32_16x16x32_bf16 v[108:111], v[196:199], v[228:231], v[108:111]
ds_read_b64_tr_b16 v[218:219], v240 offset:20496
v_mfma_f32_16x16x32_bf16 v[112:115], v[200:203], v[224:227], v[112:115]
ds_read_b64_tr_b16 v[192:193], v240 offset:16408
v_mfma_f32_16x16x32_bf16 v[116:119], v[200:203], v[228:231], v[116:119]
ds_read_b64_tr_b16 v[194:195], v240 offset:20504
s_waitcnt lgkmcnt(6)
v_mfma_f32_16x16x32_bf16 v[120:123], v[204:207], v[224:227], v[120:123]
ds_read_b64_tr_b16 v[196:197], v240 offset:16416
v_mfma_f32_16x16x32_bf16 v[124:127], v[204:207], v[228:231], v[124:127]
ds_read_b64_tr_b16 v[198:199], v240 offset:20512
v_mfma_f32_16x16x32_bf16 v[8:11], v[208:211], v[232:235], v[8:11]
ds_read_b64_tr_b16 v[200:201], v240 offset:17664
v_mfma_f32_16x16x32_bf16 v[12:15], v[208:211], v[236:239], v[12:15]
ds_read_b64_tr_b16 v[202:203], v240 offset:21760
s_waitcnt lgkmcnt(6)
v_mfma_f32_16x16x32_bf16 v[16:19], v[212:215], v[232:235], v[16:19]
ds_read_b64_tr_b16 v[204:205], v240 offset:17672
v_mfma_f32_16x16x32_bf16 v[20:23], v[212:215], v[236:239], v[20:23]
ds_read_b64_tr_b16 v[206:207], v240 offset:21768
v_mfma_f32_16x16x32_bf16 v[24:27], v[216:219], v[232:235], v[24:27]
ds_read_b64_tr_b16 v[208:209], v240 offset:17680
v_mfma_f32_16x16x32_bf16 v[28:31], v[216:219], v[236:239], v[28:31]
ds_read_b64_tr_b16 v[210:211], v240 offset:21776
s_waitcnt lgkmcnt(6)
v_mfma_f32_16x16x32_bf16 v[32:35], v[192:195], v[232:235], v[32:35]
ds_read_b64_tr_b16 v[212:213], v240 offset:17688
v_mfma_f32_16x16x32_bf16 v[36:39], v[192:195], v[236:239], v[36:39]
ds_read_b64_tr_b16 v[214:215], v240 offset:21784
v_mfma_f32_16x16x32_bf16 v[40:43], v[196:199], v[232:235], v[40:43]
ds_read_b64_tr_b16 v[216:217], v240 offset:17696
v_mfma_f32_16x16x32_bf16 v[44:47], v[196:199], v[236:239], v[44:47]
ds_read_b64_tr_b16 v[218:219], v240 offset:21792
s_waitcnt lgkmcnt(6)
v_mfma_f32_16x16x32_bf16 v[48:51], v[200:203], v[232:235], v[48:51]
ds_read_b64_tr_b16 v[192:193], v248 offset:19456
v_mfma_f32_16x16x32_bf16 v[52:55], v[200:203], v[236:239], v[52:55]
ds_read_b64_tr_b16 v[194:195], v248 offset:23552
v_mfma_f32_16x16x32_bf16 v[56:59], v[204:207], v[232:235], v[56:59]
ds_read_b64_tr_b16 v[196:197], v250 offset:19456
v_mfma_f32_16x16x32_bf16 v[60:63], v[204:207], v[236:239], v[60:63]
ds_read_b64_tr_b16 v[198:199], v250 offset:23552
s_waitcnt lgkmcnt(6)
v_mfma_f32_16x16x32_bf16 v[64:67], v[208:211], v[232:235], v[64:67]
ds_read_b64_tr_b16 v[200:201], v252 offset:19456
v_mfma_f32_16x16x32_bf16 v[68:71], v[208:211], v[236:239], v[68:71]
ds_read_b64_tr_b16 v[202:203], v252 offset:23552
v_mfma_f32_16x16x32_bf16 v[72:75], v[212:215], v[232:235], v[72:75]
ds_read_b64_tr_b16 v[204:205], v254 offset:19456
v_mfma_f32_16x16x32_bf16 v[76:79], v[212:215], v[236:239], v[76:79]
ds_read_b64_tr_b16 v[206:207], v254 offset:23552
s_waitcnt lgkmcnt(6)
v_mfma_f32_16x16x32_bf16 v[80:83], v[216:219], v[232:235], v[80:83]
ds_read_b128 v[208:211], v190 offset:18944
v_mfma_f32_16x16x32_bf16 v[84:87], v[216:219], v[236:239], v[84:87]
v_mfma_f32_16x16x32_bf16 v[88:91], v[192:195], v[232:235], v[88:91]
s_barrier
ds_read_b128 v[224:227], v246 offset:0
ds_read_b128 v[228:231], v246 offset:2048
v_mfma_f32_16x16x32_bf16 v[92:95], v[192:195], v[236:239], v[92:95]
ds_read_b64_tr_b16 v[212:213], v240 offset:32768
ds_read_b64_tr_b16 v[214:215], v240 offset:36864
s_waitcnt lgkmcnt(7)
v_mfma_f32_16x16x32_bf16 v[96:99], v[196:199], v[232:235], v[96:99]
ds_read_b64_tr_b16 v[216:217], v240 offset:32776
v_mfma_f32_16x16x32_bf16 v[100:103], v[196:199], v[236:239], v[100:103]
ds_read_b64_tr_b16 v[218:219], v240 offset:36872
v_mfma_f32_16x16x32_bf16 v[104:107], v[200:203], v[232:235], v[104:107]
ds_read_b64_tr_b16 v[192:193], v240 offset:32784
v_mfma_f32_16x16x32_bf16 v[108:111], v[200:203], v[236:239], v[108:111]
ds_read_b64_tr_b16 v[194:195], v240 offset:36880
s_waitcnt lgkmcnt(8)
v_mfma_f32_16x16x32_bf16 v[112:115], v[204:207], v[232:235], v[112:115]
ds_read_b64_tr_b16 v[196:197], v240 offset:32792
v_mfma_f32_16x16x32_bf16 v[116:119], v[204:207], v[236:239], v[116:119]
ds_read_b64_tr_b16 v[198:199], v240 offset:36888
v_mfma_f32_16x16x32_bf16 v[120:123], v[208:211], v[232:235], v[120:123]
ds_read_b64_tr_b16 v[200:201], v240 offset:32800
v_mfma_f32_16x16x32_bf16 v[124:127], v[208:211], v[236:239], v[124:127]
ds_read_b64_tr_b16 v[202:203], v240 offset:36896
s_waitcnt lgkmcnt(6)
v_mfma_f32_16x16x32_bf16 v[8:11], v[212:215], v[224:227], v[8:11]
ds_read_b64_tr_b16 v[204:205], v240 offset:34048
v_mfma_f32_16x16x32_bf16 v[12:15], v[212:215], v[228:231], v[12:15]
ds_read_b64_tr_b16 v[206:207], v240 offset:38144
v_mfma_f32_16x16x32_bf16 v[16:19], v[216:219], v[224:227], v[16:19]
ds_read_b64_tr_b16 v[208:209], v240 offset:34056
v_mfma_f32_16x16x32_bf16 v[20:23], v[216:219], v[228:231], v[20:23]
ds_read_b64_tr_b16 v[210:211], v240 offset:38152
s_waitcnt lgkmcnt(6)
v_mfma_f32_16x16x32_bf16 v[24:27], v[192:195], v[224:227], v[24:27]
ds_read_b64_tr_b16 v[212:213], v240 offset:34064
v_mfma_f32_16x16x32_bf16 v[28:31], v[192:195], v[228:231], v[28:31]
ds_read_b64_tr_b16 v[214:215], v240 offset:38160
v_mfma_f32_16x16x32_bf16 v[32:35], v[196:199], v[224:227], v[32:35]
ds_read_b64_tr_b16 v[216:217], v240 offset:34072
v_mfma_f32_16x16x32_bf16 v[36:39], v[196:199], v[228:231], v[36:39]
ds_read_b64_tr_b16 v[218:219], v240 offset:38168
s_waitcnt lgkmcnt(6)
v_mfma_f32_16x16x32_bf16 v[40:43], v[200:203], v[224:227], v[40:43]
ds_read_b64_tr_b16 v[192:193], v240 offset:34080
v_mfma_f32_16x16x32_bf16 v[44:47], v[200:203], v[228:231], v[44:47]
ds_read_b64_tr_b16 v[194:195], v240 offset:38176
v_mfma_f32_16x16x32_bf16 v[48:51], v[204:207], v[224:227], v[48:51]
ds_read_b64_tr_b16 v[196:197], v248 offset:35840
v_mfma_f32_16x16x32_bf16 v[52:55], v[204:207], v[228:231], v[52:55]
ds_read_b64_tr_b16 v[198:199], v248 offset:39936
s_waitcnt lgkmcnt(6)
v_mfma_f32_16x16x32_bf16 v[56:59], v[208:211], v[224:227], v[56:59]
ds_read_b64_tr_b16 v[200:201], v250 offset:35840
v_mfma_f32_16x16x32_bf16 v[60:63], v[208:211], v[228:231], v[60:63]
ds_read_b64_tr_b16 v[202:203], v250 offset:39936
v_mfma_f32_16x16x32_bf16 v[64:67], v[212:215], v[224:227], v[64:67]
ds_read_b64_tr_b16 v[204:205], v252 offset:35840
v_mfma_f32_16x16x32_bf16 v[68:71], v[212:215], v[228:231], v[68:71]
ds_read_b64_tr_b16 v[206:207], v252 offset:39936
s_waitcnt lgkmcnt(6)
v_mfma_f32_16x16x32_bf16 v[72:75], v[216:219], v[224:227], v[72:75]
ds_read_b64_tr_b16 v[208:209], v254 offset:35840
v_mfma_f32_16x16x32_bf16 v[76:79], v[216:219], v[228:231], v[76:79]
ds_read_b64_tr_b16 v[210:211], v254 offset:39936
v_mfma_f32_16x16x32_bf16 v[80:83], v[192:195], v[224:227], v[80:83]
ds_read_b128 v[212:215], v190 offset:35328
v_mfma_f32_16x16x32_bf16 v[84:87], v[192:195], v[228:231], v[84:87]
s_waitcnt lgkmcnt(5)
v_mfma_f32_16x16x32_bf16 v[88:91], v[196:199], v[224:227], v[88:91]
s_barrier
ds_read_b128 v[232:235], v247 offset:0
ds_read_b128 v[236:239], v247 offset:2048
v_mfma_f32_16x16x32_bf16 v[92:95], v[196:199], v[228:231], v[92:95]
ds_read_b64_tr_b16 v[216:217], v241 offset:0
ds_read_b64_tr_b16 v[218:219], v241 offset:4096
v_mfma_f32_16x16x32_bf16 v[96:99], v[200:203], v[224:227], v[96:99]
ds_read_b64_tr_b16 v[192:193], v241 offset:8
v_mfma_f32_16x16x32_bf16 v[100:103], v[200:203], v[228:231], v[100:103]
ds_read_b64_tr_b16 v[194:195], v241 offset:4104
s_waitcnt lgkmcnt(7)
v_mfma_f32_16x16x32_bf16 v[104:107], v[204:207], v[224:227], v[104:107]
ds_read_b64_tr_b16 v[196:197], v241 offset:16
v_mfma_f32_16x16x32_bf16 v[108:111], v[204:207], v[228:231], v[108:111]
ds_read_b64_tr_b16 v[198:199], v241 offset:4112
v_mfma_f32_16x16x32_bf16 v[112:115], v[208:211], v[224:227], v[112:115]
ds_read_b64_tr_b16 v[200:201], v241 offset:24
v_mfma_f32_16x16x32_bf16 v[116:119], v[208:211], v[228:231], v[116:119]
ds_read_b64_tr_b16 v[202:203], v241 offset:4120
s_waitcnt lgkmcnt(6)
v_mfma_f32_16x16x32_bf16 v[120:123], v[212:215], v[224:227], v[120:123]
ds_read_b64_tr_b16 v[204:205], v241 offset:32
v_mfma_f32_16x16x32_bf16 v[124:127], v[212:215], v[228:231], v[124:127]
ds_read_b64_tr_b16 v[206:207], v241 offset:4128
v_mfma_f32_16x16x32_bf16 v[8:11], v[216:219], v[232:235], v[8:11]
ds_read_b64_tr_b16 v[208:209], v241 offset:1280
v_mfma_f32_16x16x32_bf16 v[12:15], v[216:219], v[236:239], v[12:15]
ds_read_b64_tr_b16 v[210:211], v241 offset:5376
s_waitcnt lgkmcnt(6)
v_mfma_f32_16x16x32_bf16 v[16:19], v[192:195], v[232:235], v[16:19]
ds_read_b64_tr_b16 v[212:213], v241 offset:1288
v_mfma_f32_16x16x32_bf16 v[20:23], v[192:195], v[236:239], v[20:23]
ds_read_b64_tr_b16 v[214:215], v241 offset:5384
v_mfma_f32_16x16x32_bf16 v[24:27], v[196:199], v[232:235], v[24:27]
ds_read_b64_tr_b16 v[216:217], v241 offset:1296
v_mfma_f32_16x16x32_bf16 v[28:31], v[196:199], v[236:239], v[28:31]
ds_read_b64_tr_b16 v[218:219], v241 offset:5392
s_waitcnt lgkmcnt(6)
v_mfma_f32_16x16x32_bf16 v[32:35], v[200:203], v[232:235], v[32:35]
ds_read_b64_tr_b16 v[192:193], v241 offset:1304
v_mfma_f32_16x16x32_bf16 v[36:39], v[200:203], v[236:239], v[36:39]
ds_read_b64_tr_b16 v[194:195], v241 offset:5400
v_mfma_f32_16x16x32_bf16 v[40:43], v[204:207], v[232:235], v[40:43]
ds_read_b64_tr_b16 v[196:197], v241 offset:1312
v_mfma_f32_16x16x32_bf16 v[44:47], v[204:207], v[236:239], v[44:47]
ds_read_b64_tr_b16 v[198:199], v241 offset:5408
s_waitcnt lgkmcnt(6)
v_mfma_f32_16x16x32_bf16 v[48:51], v[208:211], v[232:235], v[48:51]
ds_read_b64_tr_b16 v[200:201], v249 offset:3072
v_mfma_f32_16x16x32_bf16 v[52:55], v[208:211], v[236:239], v[52:55]
ds_read_b64_tr_b16 v[202:203], v249 offset:7168
v_mfma_f32_16x16x32_bf16 v[56:59], v[212:215], v[232:235], v[56:59]
ds_read_b64_tr_b16 v[204:205], v251 offset:3072
v_mfma_f32_16x16x32_bf16 v[60:63], v[212:215], v[236:239], v[60:63]
ds_read_b64_tr_b16 v[206:207], v251 offset:7168
s_waitcnt lgkmcnt(6)
v_mfma_f32_16x16x32_bf16 v[64:67], v[216:219], v[232:235], v[64:67]
ds_read_b64_tr_b16 v[208:209], v253 offset:3072
v_mfma_f32_16x16x32_bf16 v[68:71], v[216:219], v[236:239], v[68:71]
ds_read_b64_tr_b16 v[210:211], v253 offset:7168
v_mfma_f32_16x16x32_bf16 v[72:75], v[192:195], v[232:235], v[72:75]
ds_read_b64_tr_b16 v[212:213], v255 offset:3072
v_mfma_f32_16x16x32_bf16 v[76:79], v[192:195], v[236:239], v[76:79]
ds_read_b64_tr_b16 v[214:215], v255 offset:7168
s_waitcnt lgkmcnt(6)
v_mfma_f32_16x16x32_bf16 v[80:83], v[196:199], v[232:235], v[80:83]
ds_read_b128 v[216:219], v191 offset:2560
v_mfma_f32_16x16x32_bf16 v[84:87], v[196:199], v[236:239], v[84:87]
v_mfma_f32_16x16x32_bf16 v[88:91], v[200:203], v[232:235], v[88:91]
s_barrier
ds_read_b128 v[224:227], v246 offset:16384
ds_read_b128 v[228:231], v246 offset:18432
v_mfma_f32_16x16x32_bf16 v[92:95], v[200:203], v[236:239], v[92:95]
ds_read_b64_tr_b16 v[192:193], v241 offset:16384
ds_read_b64_tr_b16 v[194:195], v241 offset:20480
s_waitcnt lgkmcnt(7)
v_mfma_f32_16x16x32_bf16 v[96:99], v[204:207], v[232:235], v[96:99]
ds_read_b64_tr_b16 v[196:197], v241 offset:16392
v_mfma_f32_16x16x32_bf16 v[100:103], v[204:207], v[236:239], v[100:103]
ds_read_b64_tr_b16 v[198:199], v241 offset:20488
v_mfma_f32_16x16x32_bf16 v[104:107], v[208:211], v[232:235], v[104:107]
ds_read_b64_tr_b16 v[200:201], v241 offset:16400
v_mfma_f32_16x16x32_bf16 v[108:111], v[208:211], v[236:239], v[108:111]
ds_read_b64_tr_b16 v[202:203], v241 offset:20496
s_waitcnt lgkmcnt(8)
v_mfma_f32_16x16x32_bf16 v[112:115], v[212:215], v[232:235], v[112:115]
ds_read_b64_tr_b16 v[204:205], v241 offset:16408
v_mfma_f32_16x16x32_bf16 v[116:119], v[212:215], v[236:239], v[116:119]
ds_read_b64_tr_b16 v[206:207], v241 offset:20504
v_mfma_f32_16x16x32_bf16 v[120:123], v[216:219], v[232:235], v[120:123]
ds_read_b64_tr_b16 v[208:209], v241 offset:16416
v_mfma_f32_16x16x32_bf16 v[124:127], v[216:219], v[236:239], v[124:127]
ds_read_b64_tr_b16 v[210:211], v241 offset:20512
s_waitcnt lgkmcnt(6)
v_mfma_f32_16x16x32_bf16 v[8:11], v[192:195], v[224:227], v[8:11]
ds_read_b64_tr_b16 v[212:213], v241 offset:17664
v_mfma_f32_16x16x32_bf16 v[12:15], v[192:195], v[228:231], v[12:15]
ds_read_b64_tr_b16 v[214:215], v241 offset:21760
v_mfma_f32_16x16x32_bf16 v[16:19], v[196:199], v[224:227], v[16:19]
ds_read_b64_tr_b16 v[216:217], v241 offset:17672
v_mfma_f32_16x16x32_bf16 v[20:23], v[196:199], v[228:231], v[20:23]
ds_read_b64_tr_b16 v[218:219], v241 offset:21768
s_waitcnt lgkmcnt(6)
v_mfma_f32_16x16x32_bf16 v[24:27], v[200:203], v[224:227], v[24:27]
ds_read_b64_tr_b16 v[192:193], v241 offset:17680
v_mfma_f32_16x16x32_bf16 v[28:31], v[200:203], v[228:231], v[28:31]
ds_read_b64_tr_b16 v[194:195], v241 offset:21776
v_mfma_f32_16x16x32_bf16 v[32:35], v[204:207], v[224:227], v[32:35]
ds_read_b64_tr_b16 v[196:197], v241 offset:17688
v_mfma_f32_16x16x32_bf16 v[36:39], v[204:207], v[228:231], v[36:39]
ds_read_b64_tr_b16 v[198:199], v241 offset:21784
s_waitcnt lgkmcnt(6)
v_mfma_f32_16x16x32_bf16 v[40:43], v[208:211], v[224:227], v[40:43]
ds_read_b64_tr_b16 v[200:201], v241 offset:17696
v_mfma_f32_16x16x32_bf16 v[44:47], v[208:211], v[228:231], v[44:47]
ds_read_b64_tr_b16 v[202:203], v241 offset:21792
v_mfma_f32_16x16x32_bf16 v[48:51], v[212:215], v[224:227], v[48:51]
ds_read_b64_tr_b16 v[204:205], v249 offset:19456
v_mfma_f32_16x16x32_bf16 v[52:55], v[212:215], v[228:231], v[52:55]
ds_read_b64_tr_b16 v[206:207], v249 offset:23552
s_waitcnt lgkmcnt(6)
v_mfma_f32_16x16x32_bf16 v[56:59], v[216:219], v[224:227], v[56:59]
ds_read_b64_tr_b16 v[208:209], v251 offset:19456
v_mfma_f32_16x16x32_bf16 v[60:63], v[216:219], v[228:231], v[60:63]
ds_read_b64_tr_b16 v[210:211], v251 offset:23552
v_mfma_f32_16x16x32_bf16 v[64:67], v[192:195], v[224:227], v[64:67]
ds_read_b64_tr_b16 v[212:213], v253 offset:19456
v_mfma_f32_16x16x32_bf16 v[68:71], v[192:195], v[228:231], v[68:71]
ds_read_b64_tr_b16 v[214:215], v253 offset:23552
s_waitcnt lgkmcnt(6)
v_mfma_f32_16x16x32_bf16 v[72:75], v[196:199], v[224:227], v[72:75]
ds_read_b64_tr_b16 v[216:217], v255 offset:19456
v_mfma_f32_16x16x32_bf16 v[76:79], v[196:199], v[228:231], v[76:79]
ds_read_b64_tr_b16 v[218:219], v255 offset:23552
v_mfma_f32_16x16x32_bf16 v[80:83], v[200:203], v[224:227], v[80:83]
ds_read_b128 v[192:195], v191 offset:18944
v_mfma_f32_16x16x32_bf16 v[84:87], v[200:203], v[228:231], v[84:87]
s_waitcnt lgkmcnt(5)
v_mfma_f32_16x16x32_bf16 v[88:91], v[204:207], v[224:227], v[88:91]
s_barrier
ds_read_b128 v[232:235], v247 offset:16384
ds_read_b128 v[236:239], v247 offset:18432
v_mfma_f32_16x16x32_bf16 v[92:95], v[204:207], v[228:231], v[92:95]
ds_read_b64_tr_b16 v[196:197], v240 offset:0
ds_read_b64_tr_b16 v[198:199], v240 offset:4096
v_mfma_f32_16x16x32_bf16 v[96:99], v[208:211], v[224:227], v[96:99]
ds_read_b64_tr_b16 v[200:201], v240 offset:8
v_mfma_f32_16x16x32_bf16 v[100:103], v[208:211], v[228:231], v[100:103]
ds_read_b64_tr_b16 v[202:203], v240 offset:4104
s_waitcnt lgkmcnt(7)
v_mfma_f32_16x16x32_bf16 v[104:107], v[212:215], v[224:227], v[104:107]
ds_read_b64_tr_b16 v[204:205], v240 offset:16
v_mfma_f32_16x16x32_bf16 v[108:111], v[212:215], v[228:231], v[108:111]
ds_read_b64_tr_b16 v[206:207], v240 offset:4112
v_mfma_f32_16x16x32_bf16 v[112:115], v[216:219], v[224:227], v[112:115]
ds_read_b64_tr_b16 v[208:209], v240 offset:24
v_mfma_f32_16x16x32_bf16 v[116:119], v[216:219], v[228:231], v[116:119]
ds_read_b64_tr_b16 v[210:211], v240 offset:4120
s_waitcnt lgkmcnt(6)
v_mfma_f32_16x16x32_bf16 v[120:123], v[192:195], v[224:227], v[120:123]
ds_read_b64_tr_b16 v[212:213], v240 offset:32
v_mfma_f32_16x16x32_bf16 v[124:127], v[192:195], v[228:231], v[124:127]
ds_read_b64_tr_b16 v[214:215], v240 offset:4128
v_mfma_f32_16x16x32_bf16 v[8:11], v[196:199], v[232:235], v[8:11]
ds_read_b64_tr_b16 v[216:217], v240 offset:1280
v_mfma_f32_16x16x32_bf16 v[12:15], v[196:199], v[236:239], v[12:15]
ds_read_b64_tr_b16 v[218:219], v240 offset:5376
s_waitcnt lgkmcnt(6)
v_mfma_f32_16x16x32_bf16 v[16:19], v[200:203], v[232:235], v[16:19]
ds_read_b64_tr_b16 v[192:193], v240 offset:1288
v_mfma_f32_16x16x32_bf16 v[20:23], v[200:203], v[236:239], v[20:23]
ds_read_b64_tr_b16 v[194:195], v240 offset:5384
v_mfma_f32_16x16x32_bf16 v[24:27], v[204:207], v[232:235], v[24:27]
ds_read_b64_tr_b16 v[196:197], v240 offset:1296
v_mfma_f32_16x16x32_bf16 v[28:31], v[204:207], v[236:239], v[28:31]
ds_read_b64_tr_b16 v[198:199], v240 offset:5392
s_waitcnt lgkmcnt(6)
v_mfma_f32_16x16x32_bf16 v[32:35], v[208:211], v[232:235], v[32:35]
ds_read_b64_tr_b16 v[200:201], v240 offset:1304
v_mfma_f32_16x16x32_bf16 v[36:39], v[208:211], v[236:239], v[36:39]
ds_read_b64_tr_b16 v[202:203], v240 offset:5400
v_mfma_f32_16x16x32_bf16 v[40:43], v[212:215], v[232:235], v[40:43]
ds_read_b64_tr_b16 v[204:205], v240 offset:1312
v_mfma_f32_16x16x32_bf16 v[44:47], v[212:215], v[236:239], v[44:47]
ds_read_b64_tr_b16 v[206:207], v240 offset:5408
s_waitcnt lgkmcnt(6)
v_mfma_f32_16x16x32_bf16 v[48:51], v[216:219], v[232:235], v[48:51]
ds_read_b64_tr_b16 v[208:209], v248 offset:3072
v_mfma_f32_16x16x32_bf16 v[52:55], v[216:219], v[236:239], v[52:55]
ds_read_b64_tr_b16 v[210:211], v248 offset:7168
v_mfma_f32_16x16x32_bf16 v[56:59], v[192:195], v[232:235], v[56:59]
ds_read_b64_tr_b16 v[212:213], v250 offset:3072
v_mfma_f32_16x16x32_bf16 v[60:63], v[192:195], v[236:239], v[60:63]
ds_read_b64_tr_b16 v[214:215], v250 offset:7168
s_waitcnt lgkmcnt(6)
v_mfma_f32_16x16x32_bf16 v[64:67], v[196:199], v[232:235], v[64:67]
ds_read_b64_tr_b16 v[216:217], v252 offset:3072
v_mfma_f32_16x16x32_bf16 v[68:71], v[196:199], v[236:239], v[68:71]
ds_read_b64_tr_b16 v[218:219], v252 offset:7168
v_mfma_f32_16x16x32_bf16 v[72:75], v[200:203], v[232:235], v[72:75]
ds_read_b64_tr_b16 v[192:193], v254 offset:3072
v_mfma_f32_16x16x32_bf16 v[76:79], v[200:203], v[236:239], v[76:79]
ds_read_b64_tr_b16 v[194:195], v254 offset:7168
s_waitcnt lgkmcnt(6)
v_mfma_f32_16x16x32_bf16 v[80:83], v[204:207], v[232:235], v[80:83]
ds_read_b128 v[196:199], v190 offset:2560
v_mfma_f32_16x16x32_bf16 v[84:87], v[204:207], v[236:239], v[84:87]
v_mfma_f32_16x16x32_bf16 v[88:91], v[208:211], v[232:235], v[88:91]
s_barrier
ds_read_b128 v[224:227], v246 offset:32768
ds_read_b128 v[228:231], v246 offset:34816
v_mfma_f32_16x16x32_bf16 v[92:95], v[208:211], v[236:239], v[92:95]
ds_read_b64_tr_b16 v[200:201], v240 offset:16384
ds_read_b64_tr_b16 v[202:203], v240 offset:20480
s_waitcnt lgkmcnt(7)
v_mfma_f32_16x16x32_bf16 v[96:99], v[212:215], v[232:235], v[96:99]
ds_read_b64_tr_b16 v[204:205], v240 offset:16392
v_mfma_f32_16x16x32_bf16 v[100:103], v[212:215], v[236:239], v[100:103]
ds_read_b64_tr_b16 v[206:207], v240 offset:20488
v_mfma_f32_16x16x32_bf16 v[104:107], v[216:219], v[232:235], v[104:107]
ds_read_b64_tr_b16 v[208:209], v240 offset:16400
v_mfma_f32_16x16x32_bf16 v[108:111], v[216:219], v[236:239], v[108:111]
ds_read_b64_tr_b16 v[210:211], v240 offset:20496
s_waitcnt lgkmcnt(8)
v_mfma_f32_16x16x32_bf16 v[112:115], v[192:195], v[232:235], v[112:115]
ds_read_b64_tr_b16 v[212:213], v240 offset:16408
v_mfma_f32_16x16x32_bf16 v[116:119], v[192:195], v[236:239], v[116:119]
ds_read_b64_tr_b16 v[214:215], v240 offset:20504
v_mfma_f32_16x16x32_bf16 v[120:123], v[196:199], v[232:235], v[120:123]
ds_read_b64_tr_b16 v[216:217], v240 offset:16416
v_mfma_f32_16x16x32_bf16 v[124:127], v[196:199], v[236:239], v[124:127]
ds_read_b64_tr_b16 v[218:219], v240 offset:20512
s_waitcnt lgkmcnt(6)
v_mfma_f32_16x16x32_bf16 v[8:11], v[200:203], v[224:227], v[8:11]
ds_read_b64_tr_b16 v[192:193], v240 offset:17664
v_mfma_f32_16x16x32_bf16 v[12:15], v[200:203], v[228:231], v[12:15]
ds_read_b64_tr_b16 v[194:195], v240 offset:21760
v_mfma_f32_16x16x32_bf16 v[16:19], v[204:207], v[224:227], v[16:19]
ds_read_b64_tr_b16 v[196:197], v240 offset:17672
v_mfma_f32_16x16x32_bf16 v[20:23], v[204:207], v[228:231], v[20:23]
ds_read_b64_tr_b16 v[198:199], v240 offset:21768
s_waitcnt lgkmcnt(6)
v_mfma_f32_16x16x32_bf16 v[24:27], v[208:211], v[224:227], v[24:27]
ds_read_b64_tr_b16 v[200:201], v240 offset:17680
v_mfma_f32_16x16x32_bf16 v[28:31], v[208:211], v[228:231], v[28:31]
ds_read_b64_tr_b16 v[202:203], v240 offset:21776
v_mfma_f32_16x16x32_bf16 v[32:35], v[212:215], v[224:227], v[32:35]
ds_read_b64_tr_b16 v[204:205], v240 offset:17688
v_mfma_f32_16x16x32_bf16 v[36:39], v[212:215], v[228:231], v[36:39]
ds_read_b64_tr_b16 v[206:207], v240 offset:21784
s_waitcnt lgkmcnt(6)
v_mfma_f32_16x16x32_bf16 v[40:43], v[216:219], v[224:227], v[40:43]
ds_read_b64_tr_b16 v[208:209], v240 offset:17696
v_mfma_f32_16x16x32_bf16 v[44:47], v[216:219], v[228:231], v[44:47]
ds_read_b64_tr_b16 v[210:211], v240 offset:21792
v_mfma_f32_16x16x32_bf16 v[48:51], v[192:195], v[224:227], v[48:51]
ds_read_b64_tr_b16 v[212:213], v248 offset:19456
v_mfma_f32_16x16x32_bf16 v[52:55], v[192:195], v[228:231], v[52:55]
ds_read_b64_tr_b16 v[214:215], v248 offset:23552
s_waitcnt lgkmcnt(6)
v_mfma_f32_16x16x32_bf16 v[56:59], v[196:199], v[224:227], v[56:59]
ds_read_b64_tr_b16 v[216:217], v250 offset:19456
v_mfma_f32_16x16x32_bf16 v[60:63], v[196:199], v[228:231], v[60:63]
ds_read_b64_tr_b16 v[218:219], v250 offset:23552
v_mfma_f32_16x16x32_bf16 v[64:67], v[200:203], v[224:227], v[64:67]
ds_read_b64_tr_b16 v[192:193], v252 offset:19456
v_mfma_f32_16x16x32_bf16 v[68:71], v[200:203], v[228:231], v[68:71]
ds_read_b64_tr_b16 v[194:195], v252 offset:23552
s_waitcnt lgkmcnt(6)
v_mfma_f32_16x16x32_bf16 v[72:75], v[204:207], v[224:227], v[72:75]
ds_read_b64_tr_b16 v[196:197], v254 offset:19456
v_mfma_f32_16x16x32_bf16 v[76:79], v[204:207], v[228:231], v[76:79]
ds_read_b64_tr_b16 v[198:199], v254 offset:23552
v_mfma_f32_16x16x32_bf16 v[80:83], v[208:211], v[224:227], v[80:83]
ds_read_b128 v[200:203], v190 offset:18944
v_mfma_f32_16x16x32_bf16 v[84:87], v[208:211], v[228:231], v[84:87]
s_waitcnt lgkmcnt(5)
v_mfma_f32_16x16x32_bf16 v[88:91], v[212:215], v[224:227], v[88:91]
s_barrier
ds_read_b128 v[232:235], v247 offset:32768
ds_read_b128 v[236:239], v247 offset:34816
v_mfma_f32_16x16x32_bf16 v[92:95], v[212:215], v[228:231], v[92:95]
ds_read_b64_tr_b16 v[204:205], v240 offset:32768
ds_read_b64_tr_b16 v[206:207], v240 offset:36864
v_mfma_f32_16x16x32_bf16 v[96:99], v[216:219], v[224:227], v[96:99]
ds_read_b64_tr_b16 v[208:209], v240 offset:32776
v_mfma_f32_16x16x32_bf16 v[100:103], v[216:219], v[228:231], v[100:103]
ds_read_b64_tr_b16 v[210:211], v240 offset:36872
s_waitcnt lgkmcnt(7)
v_mfma_f32_16x16x32_bf16 v[104:107], v[192:195], v[224:227], v[104:107]
ds_read_b64_tr_b16 v[212:213], v240 offset:32784
v_mfma_f32_16x16x32_bf16 v[108:111], v[192:195], v[228:231], v[108:111]
ds_read_b64_tr_b16 v[214:215], v240 offset:36880
v_mfma_f32_16x16x32_bf16 v[112:115], v[196:199], v[224:227], v[112:115]
ds_read_b64_tr_b16 v[216:217], v240 offset:32792
v_mfma_f32_16x16x32_bf16 v[116:119], v[196:199], v[228:231], v[116:119]
ds_read_b64_tr_b16 v[218:219], v240 offset:36888
s_waitcnt lgkmcnt(6)
v_mfma_f32_16x16x32_bf16 v[120:123], v[200:203], v[224:227], v[120:123]
ds_read_b64_tr_b16 v[192:193], v240 offset:32800
v_mfma_f32_16x16x32_bf16 v[124:127], v[200:203], v[228:231], v[124:127]
ds_read_b64_tr_b16 v[194:195], v240 offset:36896
v_mfma_f32_16x16x32_bf16 v[8:11], v[204:207], v[232:235], v[8:11]
ds_read_b64_tr_b16 v[196:197], v240 offset:34048
v_mfma_f32_16x16x32_bf16 v[12:15], v[204:207], v[236:239], v[12:15]
ds_read_b64_tr_b16 v[198:199], v240 offset:38144
s_waitcnt lgkmcnt(6)
v_mfma_f32_16x16x32_bf16 v[16:19], v[208:211], v[232:235], v[16:19]
ds_read_b64_tr_b16 v[200:201], v240 offset:34056
v_mfma_f32_16x16x32_bf16 v[20:23], v[208:211], v[236:239], v[20:23]
ds_read_b64_tr_b16 v[202:203], v240 offset:38152
v_mfma_f32_16x16x32_bf16 v[24:27], v[212:215], v[232:235], v[24:27]
ds_read_b64_tr_b16 v[204:205], v240 offset:34064
v_mfma_f32_16x16x32_bf16 v[28:31], v[212:215], v[236:239], v[28:31]
ds_read_b64_tr_b16 v[206:207], v240 offset:38160
s_waitcnt lgkmcnt(6)
v_mfma_f32_16x16x32_bf16 v[32:35], v[216:219], v[232:235], v[32:35]
ds_read_b64_tr_b16 v[208:209], v240 offset:34072
v_mfma_f32_16x16x32_bf16 v[36:39], v[216:219], v[236:239], v[36:39]
ds_read_b64_tr_b16 v[210:211], v240 offset:38168
v_mfma_f32_16x16x32_bf16 v[40:43], v[192:195], v[232:235], v[40:43]
ds_read_b64_tr_b16 v[212:213], v240 offset:34080
v_mfma_f32_16x16x32_bf16 v[44:47], v[192:195], v[236:239], v[44:47]
ds_read_b64_tr_b16 v[214:215], v240 offset:38176
s_waitcnt lgkmcnt(6)
v_mfma_f32_16x16x32_bf16 v[48:51], v[196:199], v[232:235], v[48:51]
ds_read_b64_tr_b16 v[216:217], v248 offset:35840
v_mfma_f32_16x16x32_bf16 v[52:55], v[196:199], v[236:239], v[52:55]
ds_read_b64_tr_b16 v[218:219], v248 offset:39936
v_mfma_f32_16x16x32_bf16 v[56:59], v[200:203], v[232:235], v[56:59]
ds_read_b64_tr_b16 v[192:193], v250 offset:35840
v_mfma_f32_16x16x32_bf16 v[60:63], v[200:203], v[236:239], v[60:63]
ds_read_b64_tr_b16 v[194:195], v250 offset:39936
s_waitcnt lgkmcnt(6)
v_mfma_f32_16x16x32_bf16 v[64:67], v[204:207], v[232:235], v[64:67]
ds_read_b64_tr_b16 v[196:197], v252 offset:35840
v_mfma_f32_16x16x32_bf16 v[68:71], v[204:207], v[236:239], v[68:71]
ds_read_b64_tr_b16 v[198:199], v252 offset:39936
v_mfma_f32_16x16x32_bf16 v[72:75], v[208:211], v[232:235], v[72:75]
ds_read_b64_tr_b16 v[200:201], v254 offset:35840
v_mfma_f32_16x16x32_bf16 v[76:79], v[208:211], v[236:239], v[76:79]
ds_read_b64_tr_b16 v[202:203], v254 offset:39936
s_waitcnt lgkmcnt(6)
v_mfma_f32_16x16x32_bf16 v[80:83], v[212:215], v[232:235], v[80:83]
ds_read_b128 v[204:207], v190 offset:35328
v_mfma_f32_16x16x32_bf16 v[84:87], v[212:215], v[236:239], v[84:87]
v_mfma_f32_16x16x32_bf16 v[88:91], v[216:219], v[232:235], v[88:91]
s_barrier
ds_read_b128 v[224:227], v246 offset:0
ds_read_b128 v[228:231], v246 offset:2048
v_mfma_f32_16x16x32_bf16 v[92:95], v[216:219], v[236:239], v[92:95]
ds_read_b64_tr_b16 v[208:209], v241 offset:0
ds_read_b64_tr_b16 v[210:211], v241 offset:4096
s_waitcnt lgkmcnt(7)
v_mfma_f32_16x16x32_bf16 v[96:99], v[192:195], v[232:235], v[96:99]
ds_read_b64_tr_b16 v[212:213], v241 offset:8
v_mfma_f32_16x16x32_bf16 v[100:103], v[192:195], v[236:239], v[100:103]
ds_read_b64_tr_b16 v[214:215], v241 offset:4104
v_mfma_f32_16x16x32_bf16 v[104:107], v[196:199], v[232:235], v[104:107]
ds_read_b64_tr_b16 v[216:217], v241 offset:16
v_mfma_f32_16x16x32_bf16 v[108:111], v[196:199], v[236:239], v[108:111]
ds_read_b64_tr_b16 v[218:219], v241 offset:4112
s_waitcnt lgkmcnt(8)
v_mfma_f32_16x16x32_bf16 v[112:115], v[200:203], v[232:235], v[112:115]
ds_read_b64_tr_b16 v[192:193], v241 offset:24
v_mfma_f32_16x16x32_bf16 v[116:119], v[200:203], v[236:239], v[116:119]
ds_read_b64_tr_b16 v[194:195], v241 offset:4120
v_mfma_f32_16x16x32_bf16 v[120:123], v[204:207], v[232:235], v[120:123]
ds_read_b64_tr_b16 v[196:197], v241 offset:32
v_mfma_f32_16x16x32_bf16 v[124:127], v[204:207], v[236:239], v[124:127]
ds_read_b64_tr_b16 v[198:199], v241 offset:4128
s_waitcnt lgkmcnt(6)
v_mfma_f32_16x16x32_bf16 v[8:11], v[208:211], v[224:227], v[8:11]
ds_read_b64_tr_b16 v[200:201], v241 offset:1280
v_mfma_f32_16x16x32_bf16 v[12:15], v[208:211], v[228:231], v[12:15]
ds_read_b64_tr_b16 v[202:203], v241 offset:5376
v_mfma_f32_16x16x32_bf16 v[16:19], v[212:215], v[224:227], v[16:19]
ds_read_b64_tr_b16 v[204:205], v241 offset:1288
v_mfma_f32_16x16x32_bf16 v[20:23], v[212:215], v[228:231], v[20:23]
ds_read_b64_tr_b16 v[206:207], v241 offset:5384
s_waitcnt lgkmcnt(6)
v_mfma_f32_16x16x32_bf16 v[24:27], v[216:219], v[224:227], v[24:27]
ds_read_b64_tr_b16 v[208:209], v241 offset:1296
v_mfma_f32_16x16x32_bf16 v[28:31], v[216:219], v[228:231], v[28:31]
ds_read_b64_tr_b16 v[210:211], v241 offset:5392
v_mfma_f32_16x16x32_bf16 v[32:35], v[192:195], v[224:227], v[32:35]
ds_read_b64_tr_b16 v[212:213], v241 offset:1304
v_mfma_f32_16x16x32_bf16 v[36:39], v[192:195], v[228:231], v[36:39]
ds_read_b64_tr_b16 v[214:215], v241 offset:5400
s_waitcnt lgkmcnt(6)
v_mfma_f32_16x16x32_bf16 v[40:43], v[196:199], v[224:227], v[40:43]
ds_read_b64_tr_b16 v[216:217], v241 offset:1312
v_mfma_f32_16x16x32_bf16 v[44:47], v[196:199], v[228:231], v[44:47]
ds_read_b64_tr_b16 v[218:219], v241 offset:5408
v_mfma_f32_16x16x32_bf16 v[48:51], v[200:203], v[224:227], v[48:51]
ds_read_b64_tr_b16 v[192:193], v249 offset:3072
v_mfma_f32_16x16x32_bf16 v[52:55], v[200:203], v[228:231], v[52:55]
ds_read_b64_tr_b16 v[194:195], v249 offset:7168
s_waitcnt lgkmcnt(6)
v_mfma_f32_16x16x32_bf16 v[56:59], v[204:207], v[224:227], v[56:59]
ds_read_b64_tr_b16 v[196:197], v251 offset:3072
v_mfma_f32_16x16x32_bf16 v[60:63], v[204:207], v[228:231], v[60:63]
ds_read_b64_tr_b16 v[198:199], v251 offset:7168
v_mfma_f32_16x16x32_bf16 v[64:67], v[208:211], v[224:227], v[64:67]
ds_read_b64_tr_b16 v[200:201], v253 offset:3072
v_mfma_f32_16x16x32_bf16 v[68:71], v[208:211], v[228:231], v[68:71]
ds_read_b64_tr_b16 v[202:203], v253 offset:7168
s_waitcnt lgkmcnt(6)
v_mfma_f32_16x16x32_bf16 v[72:75], v[212:215], v[224:227], v[72:75]
ds_read_b64_tr_b16 v[204:205], v255 offset:3072
v_mfma_f32_16x16x32_bf16 v[76:79], v[212:215], v[228:231], v[76:79]
ds_read_b64_tr_b16 v[206:207], v255 offset:7168
v_mfma_f32_16x16x32_bf16 v[80:83], v[216:219], v[224:227], v[80:83]
ds_read_b128 v[208:211], v191 offset:2560
v_mfma_f32_16x16x32_bf16 v[84:87], v[216:219], v[228:231], v[84:87]
s_waitcnt lgkmcnt(5)
v_mfma_f32_16x16x32_bf16 v[88:91], v[192:195], v[224:227], v[88:91]
s_barrier
ds_read_b128 v[232:235], v247 offset:0
ds_read_b128 v[236:239], v247 offset:2048
v_mfma_f32_16x16x32_bf16 v[92:95], v[192:195], v[228:231], v[92:95]
ds_read_b64_tr_b16 v[212:213], v241 offset:16384
ds_read_b64_tr_b16 v[214:215], v241 offset:20480
v_mfma_f32_16x16x32_bf16 v[96:99], v[196:199], v[224:227], v[96:99]
ds_read_b64_tr_b16 v[216:217], v241 offset:16392
v_mfma_f32_16x16x32_bf16 v[100:103], v[196:199], v[228:231], v[100:103]
ds_read_b64_tr_b16 v[218:219], v241 offset:20488
s_waitcnt lgkmcnt(7)
v_mfma_f32_16x16x32_bf16 v[104:107], v[200:203], v[224:227], v[104:107]
ds_read_b64_tr_b16 v[192:193], v241 offset:16400
v_mfma_f32_16x16x32_bf16 v[108:111], v[200:203], v[228:231], v[108:111]
ds_read_b64_tr_b16 v[194:195], v241 offset:20496
v_mfma_f32_16x16x32_bf16 v[112:115], v[204:207], v[224:227], v[112:115]
ds_read_b64_tr_b16 v[196:197], v241 offset:16408
v_mfma_f32_16x16x32_bf16 v[116:119], v[204:207], v[228:231], v[116:119]
ds_read_b64_tr_b16 v[198:199], v241 offset:20504
s_waitcnt lgkmcnt(6)
v_mfma_f32_16x16x32_bf16 v[120:123], v[208:211], v[224:227], v[120:123]
ds_read_b64_tr_b16 v[200:201], v241 offset:16416
v_mfma_f32_16x16x32_bf16 v[124:127], v[208:211], v[228:231], v[124:127]
ds_read_b64_tr_b16 v[202:203], v241 offset:20512
v_mfma_f32_16x16x32_bf16 v[8:11], v[212:215], v[232:235], v[8:11]
ds_read_b64_tr_b16 v[204:205], v241 offset:17664
v_mfma_f32_16x16x32_bf16 v[12:15], v[212:215], v[236:239], v[12:15]
ds_read_b64_tr_b16 v[206:207], v241 offset:21760
s_waitcnt lgkmcnt(6)
v_mfma_f32_16x16x32_bf16 v[16:19], v[216:219], v[232:235], v[16:19]
ds_read_b64_tr_b16 v[208:209], v241 offset:17672
v_mfma_f32_16x16x32_bf16 v[20:23], v[216:219], v[236:239], v[20:23]
ds_read_b64_tr_b16 v[210:211], v241 offset:21768
v_mfma_f32_16x16x32_bf16 v[24:27], v[192:195], v[232:235], v[24:27]
ds_read_b64_tr_b16 v[212:213], v241 offset:17680
v_mfma_f32_16x16x32_bf16 v[28:31], v[192:195], v[236:239], v[28:31]
ds_read_b64_tr_b16 v[214:215], v241 offset:21776
s_waitcnt lgkmcnt(6)
v_mfma_f32_16x16x32_bf16 v[32:35], v[196:199], v[232:235], v[32:35]
ds_read_b64_tr_b16 v[216:217], v241 offset:17688
v_mfma_f32_16x16x32_bf16 v[36:39], v[196:199], v[236:239], v[36:39]
ds_read_b64_tr_b16 v[218:219], v241 offset:21784
v_mfma_f32_16x16x32_bf16 v[40:43], v[200:203], v[232:235], v[40:43]
ds_read_b64_tr_b16 v[192:193], v241 offset:17696
v_mfma_f32_16x16x32_bf16 v[44:47], v[200:203], v[236:239], v[44:47]
ds_read_b64_tr_b16 v[194:195], v241 offset:21792
s_waitcnt lgkmcnt(6)
v_mfma_f32_16x16x32_bf16 v[48:51], v[204:207], v[232:235], v[48:51]
ds_read_b64_tr_b16 v[196:197], v249 offset:19456
v_mfma_f32_16x16x32_bf16 v[52:55], v[204:207], v[236:239], v[52:55]
ds_read_b64_tr_b16 v[198:199], v249 offset:23552
v_mfma_f32_16x16x32_bf16 v[56:59], v[208:211], v[232:235], v[56:59]
ds_read_b64_tr_b16 v[200:201], v251 offset:19456
v_mfma_f32_16x16x32_bf16 v[60:63], v[208:211], v[236:239], v[60:63]
ds_read_b64_tr_b16 v[202:203], v251 offset:23552
s_waitcnt lgkmcnt(6)
v_mfma_f32_16x16x32_bf16 v[64:67], v[212:215], v[232:235], v[64:67]
ds_read_b64_tr_b16 v[204:205], v253 offset:19456
v_mfma_f32_16x16x32_bf16 v[68:71], v[212:215], v[236:239], v[68:71]
ds_read_b64_tr_b16 v[206:207], v253 offset:23552
v_mfma_f32_16x16x32_bf16 v[72:75], v[216:219], v[232:235], v[72:75]
ds_read_b64_tr_b16 v[208:209], v255 offset:19456
v_mfma_f32_16x16x32_bf16 v[76:79], v[216:219], v[236:239], v[76:79]
ds_read_b64_tr_b16 v[210:211], v255 offset:23552
s_waitcnt lgkmcnt(6)
v_mfma_f32_16x16x32_bf16 v[80:83], v[192:195], v[232:235], v[80:83]
ds_read_b128 v[212:215], v191 offset:18944
v_mfma_f32_16x16x32_bf16 v[84:87], v[192:195], v[236:239], v[84:87]
v_mfma_f32_16x16x32_bf16 v[88:91], v[196:199], v[232:235], v[88:91]
ds_read_b64_tr_b16 v[140:141], v244 offset:0
ds_read_b64_tr_b16 v[142:143], v244 offset:160
ds_read_b64_tr_b16 v[144:145], v244 offset:320
v_mfma_f32_16x16x32_bf16 v[92:95], v[196:199], v[236:239], v[92:95]
ds_read_b64_tr_b16 v[146:147], v244 offset:480
ds_read_b64_tr_b16 v[148:149], v244 offset:640
s_waitcnt lgkmcnt(8)
v_mfma_f32_16x16x32_bf16 v[96:99], v[200:203], v[232:235], v[96:99]
ds_read_b64_tr_b16 v[150:151], v244 offset:8
ds_read_b64_tr_b16 v[152:153], v244 offset:168
ds_read_b64_tr_b16 v[154:155], v244 offset:328
v_mfma_f32_16x16x32_bf16 v[100:103], v[200:203], v[236:239], v[100:103]
ds_read_b64_tr_b16 v[156:157], v244 offset:488
ds_read_b64_tr_b16 v[158:159], v244 offset:648
v_mfma_f32_16x16x32_bf16 v[104:107], v[204:207], v[232:235], v[104:107]
ds_read_b64_tr_b16 v[160:161], v244 offset:16
ds_read_b64_tr_b16 v[162:163], v244 offset:176
s_waitcnt lgkmcnt(10)
v_mfma_f32_16x16x32_bf16 v[108:111], v[204:207], v[236:239], v[108:111]
ds_read_b64_tr_b16 v[164:165], v244 offset:336
ds_read_b64_tr_b16 v[166:167], v244 offset:496
ds_read_b64_tr_b16 v[168:169], v244 offset:656
v_mfma_f32_16x16x32_bf16 v[112:115], v[208:211], v[232:235], v[112:115]
ds_read_b64_tr_b16 v[170:171], v244 offset:24
ds_read_b64_tr_b16 v[172:173], v244 offset:184
s_waitcnt lgkmcnt(10)
v_mfma_f32_16x16x32_bf16 v[116:119], v[208:211], v[236:239], v[116:119]
ds_read_b64_tr_b16 v[174:175], v244 offset:344
ds_read_b64_tr_b16 v[176:177], v244 offset:504
ds_read_b64_tr_b16 v[178:179], v244 offset:664
v_mfma_f32_16x16x32_bf16 v[120:123], v[212:215], v[232:235], v[120:123]
ds_read_b64_tr_b16 v[180:181], v244 offset:32
ds_read_b64_tr_b16 v[182:183], v244 offset:192
s_waitcnt lgkmcnt(10)
v_mfma_f32_16x16x32_bf16 v[124:127], v[212:215], v[236:239], v[124:127]
ds_read_b64_tr_b16 v[184:185], v244 offset:352
ds_read_b64_tr_b16 v[186:187], v244 offset:512
ds_read_b64_tr_b16 v[188:189], v244 offset:672
s_setprio 2
v_mov_b32 v4, 0
v_mov_b32 v5, v243
s_mov_b64 exec, 1
v_mov_b32 v136, 133152
v_mov_b32 v137, 1
ds_add_u32 v136, v137
s_mov_b64 exec, -1
v_cvt_pk_bf16_f32 v192, v8, v9
v_cvt_pk_bf16_f32 v193, v10, v11
v_cvt_pk_bf16_f32 v194, v16, v17
v_cvt_pk_bf16_f32 v195, v18, v19
v_cvt_pk_bf16_f32 v196, v24, v25
v_cvt_pk_bf16_f32 v197, v26, v27
v_cvt_pk_bf16_f32 v198, v32, v33
v_cvt_pk_bf16_f32 v199, v34, v35
v_cvt_pk_bf16_f32 v200, v40, v41
v_cvt_pk_bf16_f32 v201, v42, v43
v_cvt_pk_bf16_f32 v202, v12, v13
v_cvt_pk_bf16_f32 v203, v14, v15
v_cvt_pk_bf16_f32 v204, v20, v21
v_cvt_pk_bf16_f32 v205, v22, v23
v_cvt_pk_bf16_f32 v206, v28, v29
v_cvt_pk_bf16_f32 v207, v30, v31
v_cvt_pk_bf16_f32 v208, v36, v37
v_cvt_pk_bf16_f32 v209, v38, v39
v_cvt_pk_bf16_f32 v210, v44, v45
v_cvt_pk_bf16_f32 v211, v46, v47
s_waitcnt lgkmcnt(0)
v_mfma_f32_16x16x32_bf16 v[212:215], v[140:143], v[192:195], 0
v_xor_b32 v32, 0, v245
v_xor_b32 v33, 16, v245
v_mfma_f32_16x16x32_bf16 v[216:219], v[150:153], v[192:195], 0
v_xor_b32 v34, 32, v245
v_xor_b32 v35, 48, v245
v_mfma_f32_16x16x32_bf16 v[220:223], v[160:163], v[192:195], 0
v_xor_b32 v36, 64, v245
v_xor_b32 v37, 80, v245
v_mfma_f32_16x16x32_bf16 v[224:227], v[170:173], v[192:195], 0
v_xor_b32 v38, 96, v245
v_xor_b32 v39, 112, v245
v_mfma_f32_16x16x32_bf16 v[228:231], v[180:183], v[192:195], 0
v_cvt_pk_bf16_f32 v8, v48, v49
v_cvt_pk_bf16_f32 v9, v50, v51
v_mfma_f32_16x16x32_bf16 v[212:215], v[144:147], v[196:199], v[212:215]
v_cvt_pk_bf16_f32 v10, v56, v57
v_cvt_pk_bf16_f32 v11, v58, v59
v_mfma_f32_16x16x32_bf16 v[216:219], v[154:157], v[196:199], v[216:219]
v_cvt_pk_bf16_f32 v12, v64, v65
v_cvt_pk_bf16_f32 v13, v66, v67
v_mfma_f32_16x16x32_bf16 v[220:223], v[164:167], v[196:199], v[220:223]
v_cvt_pk_bf16_f32 v14, v72, v73
v_cvt_pk_bf16_f32 v15, v74, v75
v_mfma_f32_16x16x32_bf16 v[224:227], v[174:177], v[196:199], v[224:227]
v_cvt_pk_bf16_f32 v16, v80, v81
v_cvt_pk_bf16_f32 v17, v82, v83
v_mfma_f32_16x16x32_bf16 v[228:231], v[184:187], v[196:199], v[228:231]
v_mov_b32 v18, 0x3f80
v_mov_b32 v19, 0
v_mfma_f32_16x16x16_bf16 v[212:215], v[148:149], v[200:201], v[212:215]
v_cvt_pk_bf16_f32 v20, v52, v53
v_cvt_pk_bf16_f32 v21, v54, v55
v_mfma_f32_16x16x16_bf16 v[216:219], v[158:159], v[200:201], v[216:219]
v_cvt_pk_bf16_f32 v22, v60, v61
v_cvt_pk_bf16_f32 v23, v62, v63
v_mfma_f32_16x16x16_bf16 v[220:223], v[168:169], v[200:201], v[220:223]
v_cvt_pk_bf16_f32 v24, v68, v69
v_cvt_pk_bf16_f32 v25, v70, v71
v_mfma_f32_16x16x16_bf16 v[224:227], v[178:179], v[200:201], v[224:227]
v_cvt_pk_bf16_f32 v26, v76, v77
v_cvt_pk_bf16_f32 v27, v78, v79
v_mfma_f32_16x16x16_bf16 v[228:231], v[188:189], v[200:201], v[228:231]
v_cvt_pk_bf16_f32 v28, v84, v85
v_cvt_pk_bf16_f32 v29, v86, v87
v_mov_b32 v30, 0x3f80
v_mov_b32 v31, 0
v_max3_f32 v40, v212, v213, v214
v_min3_f32 v42, v212, v213, v214
v_max3_f32 v40, v40, v215, v216
v_min3_f32 v42, v42, v215, v216
v_max3_f32 v40, v40, v217, v218
v_min3_f32 v42, v42, v217, v218
v_max3_f32 v40, v40, v219, v220
v_min3_f32 v42, v42, v219, v220
v_max3_f32 v40, v40, v221, v222
v_min3_f32 v42, v42, v221, v222
v_max3_f32 v40, v40, v223, v224
v_min3_f32 v42, v42, v223, v224
v_max3_f32 v40, v40, v225, v226
v_min3_f32 v42, v42, v225, v226
v_max3_f32 v40, v40, v227, v228
v_min3_f32 v42, v42, v227, v228
v_max3_f32 v40, v40, v229, v230
v_min3_f32 v42, v42, v229, v230
v_max_f32 v40, v40, v231
v_min_f32 v42, v42, v231
v_mul_f32 v40, s10, v40
v_mul_f32 v42, s10, v42
v_pk_fma_f32 v[48:49], v[212:213], s[10:11], v[40:41] op_sel_hi:[1,1,0] neg_lo:[0,0,1] neg_hi:[0,0,1]
v_pk_fma_f32 v[212:213], v[212:213], s[10:11], v[42:43] op_sel_hi:[1,1,0] neg_lo:[1,0,0] neg_hi:[1,0,0]
v_pk_fma_f32 v[50:51], v[214:215], s[10:11], v[40:41] op_sel_hi:[1,1,0] neg_lo:[0,0,1] neg_hi:[0,0,1]
v_pk_fma_f32 v[214:215], v[214:215], s[10:11], v[42:43] op_sel_hi:[1,1,0] neg_lo:[1,0,0] neg_hi:[1,0,0]
v_pk_fma_f32 v[52:53], v[216:217], s[10:11], v[40:41] op_sel_hi:[1,1,0] neg_lo:[0,0,1] neg_hi:[0,0,1]
v_pk_fma_f32 v[216:217], v[216:217], s[10:11], v[42:43] op_sel_hi:[1,1,0] neg_lo:[1,0,0] neg_hi:[1,0,0]
v_pk_fma_f32 v[54:55], v[218:219], s[10:11], v[40:41] op_sel_hi:[1,1,0] neg_lo:[0,0,1] neg_hi:[0,0,1]
v_pk_fma_f32 v[218:219], v[218:219], s[10:11], v[42:43] op_sel_hi:[1,1,0] neg_lo:[1,0,0] neg_hi:[1,0,0]
v_pk_fma_f32 v[56:57], v[220:221], s[10:11], v[40:41] op_sel_hi:[1,1,0] neg_lo:[0,0,1] neg_hi:[0,0,1]
v_pk_fma_f32 v[220:221], v[220:221], s[10:11], v[42:43] op_sel_hi:[1,1,0] neg_lo:[1,0,0] neg_hi:[1,0,0]
v_pk_fma_f32 v[58:59], v[222:223], s[10:11], v[40:41] op_sel_hi:[1,1,0] neg_lo:[0,0,1] neg_hi:[0,0,1]
v_pk_fma_f32 v[222:223], v[222:223], s[10:11], v[42:43] op_sel_hi:[1,1,0] neg_lo:[1,0,0] neg_hi:[1,0,0]
v_pk_fma_f32 v[60:61], v[224:225], s[10:11], v[40:41] op_sel_hi:[1,1,0] neg_lo:[0,0,1] neg_hi:[0,0,1]
v_pk_fma_f32 v[224:225], v[224:225], s[10:11], v[42:43] op_sel_hi:[1,1,0] neg_lo:[1,0,0] neg_hi:[1,0,0]
v_pk_fma_f32 v[62:63], v[226:227], s[10:11], v[40:41] op_sel_hi:[1,1,0] neg_lo:[0,0,1] neg_hi:[0,0,1]
v_pk_fma_f32 v[226:227], v[226:227], s[10:11], v[42:43] op_sel_hi:[1,1,0] neg_lo:[1,0,0] neg_hi:[1,0,0]
v_pk_fma_f32 v[64:65], v[228:229], s[10:11], v[40:41] op_sel_hi:[1,1,0] neg_lo:[0,0,1] neg_hi:[0,0,1]
v_pk_fma_f32 v[228:229], v[228:229], s[10:11], v[42:43] op_sel_hi:[1,1,0] neg_lo:[1,0,0] neg_hi:[1,0,0]
v_pk_fma_f32 v[66:67], v[230:231], s[10:11], v[40:41] op_sel_hi:[1,1,0] neg_lo:[0,0,1] neg_hi:[0,0,1]
v_pk_fma_f32 v[230:231], v[230:231], s[10:11], v[42:43] op_sel_hi:[1,1,0] neg_lo:[1,0,0] neg_hi:[1,0,0]
v_exp_f32 v48, v48
v_exp_f32 v212, v212
v_exp_f32 v49, v49
v_exp_f32 v213, v213
v_exp_f32 v50, v50
v_exp_f32 v214, v214
v_exp_f32 v51, v51
v_exp_f32 v215, v215
v_exp_f32 v52, v52
v_exp_f32 v216, v216
v_exp_f32 v53, v53
v_exp_f32 v217, v217
v_exp_f32 v54, v54
v_exp_f32 v218, v218
v_exp_f32 v55, v55
v_exp_f32 v219, v219
v_exp_f32 v56, v56
v_exp_f32 v220, v220
v_exp_f32 v57, v57
v_exp_f32 v221, v221
v_exp_f32 v58, v58
v_exp_f32 v222, v222
v_exp_f32 v59, v59
v_exp_f32 v223, v223
v_exp_f32 v60, v60
v_exp_f32 v224, v224
v_exp_f32 v61, v61
v_exp_f32 v225, v225
v_exp_f32 v62, v62
v_exp_f32 v226, v226
v_exp_f32 v63, v63
v_exp_f32 v227, v227
v_exp_f32 v64, v64
v_exp_f32 v228, v228
v_exp_f32 v65, v65
v_exp_f32 v229, v229
v_exp_f32 v66, v66
v_exp_f32 v230, v230
v_exp_f32 v67, v67
v_exp_f32 v231, v231
v_pk_add_f32 v[44:45], v[48:49], v[50:51]
v_pk_add_f32 v[46:47], v[212:213], v[214:215]
v_pk_add_f32 v[44:45], v[44:45], v[52:53]
v_pk_add_f32 v[46:47], v[46:47], v[216:217]
v_pk_add_f32 v[44:45], v[44:45], v[54:55]
v_pk_add_f32 v[46:47], v[46:47], v[218:219]
v_pk_add_f32 v[44:45], v[44:45], v[56:57]
v_pk_add_f32 v[46:47], v[46:47], v[220:221]
v_pk_add_f32 v[44:45], v[44:45], v[58:59]
v_pk_add_f32 v[46:47], v[46:47], v[222:223]
v_pk_add_f32 v[44:45], v[44:45], v[60:61]
v_pk_add_f32 v[46:47], v[46:47], v[224:225]
v_pk_add_f32 v[44:45], v[44:45], v[62:63]
v_pk_add_f32 v[46:47], v[46:47], v[226:227]
v_pk_add_f32 v[44:45], v[44:45], v[64:65]
v_pk_add_f32 v[46:47], v[46:47], v[228:229]
v_pk_add_f32 v[44:45], v[44:45], v[66:67]
v_pk_add_f32 v[46:47], v[46:47], v[230:231]
v_add_f32 v44, v44, v45
v_add_f32 v46, v46, v47
v_rcp_f32 v44, v44
v_rcp_f32 v46, v46
v_pk_mul_f32 v[48:49], v[48:49], v[44:45] op_sel_hi:[1,0]
v_pk_mul_f32 v[50:51], v[50:51], v[44:45] op_sel_hi:[1,0]
v_cvt_pk_bf16_f32 v68, v48, v49
v_pk_mul_f32 v[52:53], v[52:53], v[44:45] op_sel_hi:[1,0]
v_cvt_pk_bf16_f32 v69, v50, v51
v_pk_mul_f32 v[54:55], v[54:55], v[44:45] op_sel_hi:[1,0]
v_cvt_pk_bf16_f32 v70, v52, v53
v_pk_mul_f32 v[56:57], v[56:57], v[44:45] op_sel_hi:[1,0]
v_cvt_pk_bf16_f32 v71, v54, v55
v_pk_mul_f32 v[58:59], v[58:59], v[44:45] op_sel_hi:[1,0]
v_cvt_pk_bf16_f32 v72, v56, v57
v_pk_mul_f32 v[60:61], v[60:61], v[44:45] op_sel_hi:[1,0]
v_cvt_pk_bf16_f32 v73, v58, v59
v_pk_mul_f32 v[62:63], v[62:63], v[44:45] op_sel_hi:[1,0]
v_cvt_pk_bf16_f32 v74, v60, v61
v_pk_mul_f32 v[64:65], v[64:65], v[44:45] op_sel_hi:[1,0]
v_cvt_pk_bf16_f32 v75, v62, v63
v_pk_mul_f32 v[66:67], v[66:67], v[44:45] op_sel_hi:[1,0]
v_cvt_pk_bf16_f32 v76, v64, v65
v_cvt_pk_bf16_f32 v77, v66, v67
v_pk_mul_f32 v[212:213], v[212:213], v[46:47] op_sel_hi:[1,0]
v_pk_mul_f32 v[214:215], v[214:215], v[46:47] op_sel_hi:[1,0]
v_cvt_pk_bf16_f32 v78, v212, v213
v_pk_mul_f32 v[216:217], v[216:217], v[46:47] op_sel_hi:[1,0]
v_cvt_pk_bf16_f32 v79, v214, v215
v_pk_mul_f32 v[218:219], v[218:219], v[46:47] op_sel_hi:[1,0]
v_cvt_pk_bf16_f32 v80, v216, v217
v_pk_mul_f32 v[220:221], v[220:221], v[46:47] op_sel_hi:[1,0]
v_cvt_pk_bf16_f32 v81, v218, v219
v_pk_mul_f32 v[222:223], v[222:223], v[46:47] op_sel_hi:[1,0]
v_cvt_pk_bf16_f32 v82, v220, v221
v_pk_mul_f32 v[224:225], v[224:225], v[46:47] op_sel_hi:[1,0]
v_cvt_pk_bf16_f32 v83, v222, v223
v_pk_mul_f32 v[226:227], v[226:227], v[46:47] op_sel_hi:[1,0]
v_cvt_pk_bf16_f32 v84, v224, v225
v_pk_mul_f32 v[228:229], v[228:229], v[46:47] op_sel_hi:[1,0]
v_cvt_pk_bf16_f32 v85, v226, v227
v_pk_mul_f32 v[230:231], v[230:231], v[46:47] op_sel_hi:[1,0]
v_cvt_pk_bf16_f32 v86, v228, v229
v_cvt_pk_bf16_f32 v87, v230, v231
v_mfma_f32_16x16x32_bf16 v[232:235], v[140:143], v[202:205], 0
ds_write_b128 v32, v[68:71]
v_mul_f32 v40, 3216550459, v120
v_mfma_f32_16x16x32_bf16 v[236:239], v[150:153], v[202:205], 0
ds_write_b128 v33, v[72:75]
v_mul_f32 v41, 3216550459, v124
v_mfma_f32_16x16x32_bf16 v[240:243], v[160:163], v[202:205], 0
ds_write_b128 v34, v[76:79]
v_exp_f32 v40, v40
v_mfma_f32_16x16x32_bf16 v[244:247], v[170:173], v[202:205], 0
ds_write_b128 v35, v[80:83]
v_exp_f32 v41, v41
v_mfma_f32_16x16x32_bf16 v[248:251], v[180:183], v[202:205], 0
ds_write_b128 v36, v[84:87]
v_add_f32 v40, 1.0, v40
v_mfma_f32_16x16x32_bf16 v[232:235], v[144:147], v[206:209], v[232:235]
ds_write_b128 v37, v[8:11] offset:0
v_add_f32 v41, 1.0, v41
v_mfma_f32_16x16x32_bf16 v[236:239], v[154:157], v[206:209], v[236:239]
ds_write_b128 v38, v[12:15] offset:0
v_rcp_f32 v40, v40
v_mfma_f32_16x16x32_bf16 v[240:243], v[164:167], v[206:209], v[240:243]
ds_write_b128 v39, v[16:19] offset:0
v_rcp_f32 v41, v41
v_mfma_f32_16x16x32_bf16 v[244:247], v[174:177], v[206:209], v[244:247]
ds_write_b128 v37, v[20:23] offset:2048
v_lshlrev_b32 v42, 2, v0
v_mfma_f32_16x16x32_bf16 v[248:251], v[184:187], v[206:209], v[248:251]
ds_write_b128 v38, v[24:27] offset:2048
v_mfma_f32_16x16x16_bf16 v[232:235], v[148:149], v[210:211], v[232:235]
ds_write_b128 v39, v[28:31] offset:2048
v_mfma_f32_16x16x16_bf16 v[236:239], v[158:159], v[210:211], v[236:239]
v_mfma_f32_16x16x16_bf16 v[240:243], v[168:169], v[210:211], v[240:243]
v_mfma_f32_16x16x16_bf16 v[244:247], v[178:179], v[210:211], v[244:247]
v_mfma_f32_16x16x16_bf16 v[248:251], v[188:189], v[210:211], v[248:251]
s_mov_b64 exec, 0xffff
buffer_store_dword v40, v42, s[48:51], s3 offen offset:0 sc1
buffer_store_dword v41, v42, s[48:51], s3 offen offset:64 sc1
s_mov_b64 exec, -1
v_max3_f32 v40, v232, v233, v234
v_min3_f32 v42, v232, v233, v234
v_max3_f32 v40, v40, v235, v236
v_min3_f32 v42, v42, v235, v236
v_max3_f32 v40, v40, v237, v238
v_min3_f32 v42, v42, v237, v238
v_max3_f32 v40, v40, v239, v240
v_min3_f32 v42, v42, v239, v240
v_max3_f32 v40, v40, v241, v242
v_min3_f32 v42, v42, v241, v242
v_max3_f32 v40, v40, v243, v244
v_min3_f32 v42, v42, v243, v244
v_max3_f32 v40, v40, v245, v246
v_min3_f32 v42, v42, v245, v246
v_max3_f32 v40, v40, v247, v248
v_min3_f32 v42, v42, v247, v248
v_max3_f32 v40, v40, v249, v250
v_min3_f32 v42, v42, v249, v250
v_max_f32 v40, v40, v251
v_min_f32 v42, v42, v251
v_mul_f32 v40, s10, v40
v_mul_f32 v42, s10, v42
v_pk_fma_f32 v[192:193], v[232:233], s[10:11], v[40:41] op_sel_hi:[1,1,0] neg_lo:[0,0,1] neg_hi:[0,0,1]
v_pk_fma_f32 v[232:233], v[232:233], s[10:11], v[42:43] op_sel_hi:[1,1,0] neg_lo:[1,0,0] neg_hi:[1,0,0]
v_pk_fma_f32 v[194:195], v[234:235], s[10:11], v[40:41] op_sel_hi:[1,1,0] neg_lo:[0,0,1] neg_hi:[0,0,1]
v_pk_fma_f32 v[234:235], v[234:235], s[10:11], v[42:43] op_sel_hi:[1,1,0] neg_lo:[1,0,0] neg_hi:[1,0,0]
v_pk_fma_f32 v[196:197], v[236:237], s[10:11], v[40:41] op_sel_hi:[1,1,0] neg_lo:[0,0,1] neg_hi:[0,0,1]
v_pk_fma_f32 v[236:237], v[236:237], s[10:11], v[42:43] op_sel_hi:[1,1,0] neg_lo:[1,0,0] neg_hi:[1,0,0]
v_pk_fma_f32 v[198:199], v[238:239], s[10:11], v[40:41] op_sel_hi:[1,1,0] neg_lo:[0,0,1] neg_hi:[0,0,1]
v_pk_fma_f32 v[238:239], v[238:239], s[10:11], v[42:43] op_sel_hi:[1,1,0] neg_lo:[1,0,0] neg_hi:[1,0,0]
v_pk_fma_f32 v[200:201], v[240:241], s[10:11], v[40:41] op_sel_hi:[1,1,0] neg_lo:[0,0,1] neg_hi:[0,0,1]
v_pk_fma_f32 v[240:241], v[240:241], s[10:11], v[42:43] op_sel_hi:[1,1,0] neg_lo:[1,0,0] neg_hi:[1,0,0]
v_pk_fma_f32 v[202:203], v[242:243], s[10:11], v[40:41] op_sel_hi:[1,1,0] neg_lo:[0,0,1] neg_hi:[0,0,1]
v_pk_fma_f32 v[242:243], v[242:243], s[10:11], v[42:43] op_sel_hi:[1,1,0] neg_lo:[1,0,0] neg_hi:[1,0,0]
v_pk_fma_f32 v[204:205], v[244:245], s[10:11], v[40:41] op_sel_hi:[1,1,0] neg_lo:[0,0,1] neg_hi:[0,0,1]
v_pk_fma_f32 v[244:245], v[244:245], s[10:11], v[42:43] op_sel_hi:[1,1,0] neg_lo:[1,0,0] neg_hi:[1,0,0]
v_pk_fma_f32 v[206:207], v[246:247], s[10:11], v[40:41] op_sel_hi:[1,1,0] neg_lo:[0,0,1] neg_hi:[0,0,1]
v_pk_fma_f32 v[246:247], v[246:247], s[10:11], v[42:43] op_sel_hi:[1,1,0] neg_lo:[1,0,0] neg_hi:[1,0,0]
v_pk_fma_f32 v[208:209], v[248:249], s[10:11], v[40:41] op_sel_hi:[1,1,0] neg_lo:[0,0,1] neg_hi:[0,0,1]
v_pk_fma_f32 v[248:249], v[248:249], s[10:11], v[42:43] op_sel_hi:[1,1,0] neg_lo:[1,0,0] neg_hi:[1,0,0]
v_pk_fma_f32 v[210:211], v[250:251], s[10:11], v[40:41] op_sel_hi:[1,1,0] neg_lo:[0,0,1] neg_hi:[0,0,1]
v_pk_fma_f32 v[250:251], v[250:251], s[10:11], v[42:43] op_sel_hi:[1,1,0] neg_lo:[1,0,0] neg_hi:[1,0,0]
v_exp_f32 v192, v192
v_exp_f32 v232, v232
v_exp_f32 v193, v193
v_exp_f32 v233, v233
v_exp_f32 v194, v194
v_exp_f32 v234, v234
v_exp_f32 v195, v195
v_exp_f32 v235, v235
v_exp_f32 v196, v196
v_exp_f32 v236, v236
v_exp_f32 v197, v197
v_exp_f32 v237, v237
v_exp_f32 v198, v198
v_exp_f32 v238, v238
v_exp_f32 v199, v199
v_exp_f32 v239, v239
v_exp_f32 v200, v200
v_exp_f32 v240, v240
v_exp_f32 v201, v201
v_exp_f32 v241, v241
v_exp_f32 v202, v202
v_exp_f32 v242, v242
v_exp_f32 v203, v203
v_exp_f32 v243, v243
v_exp_f32 v204, v204
v_exp_f32 v244, v244
v_exp_f32 v205, v205
v_exp_f32 v245, v245
v_exp_f32 v206, v206
v_exp_f32 v246, v246
v_exp_f32 v207, v207
v_exp_f32 v247, v247
v_exp_f32 v208, v208
v_exp_f32 v248, v248
v_exp_f32 v209, v209
v_exp_f32 v249, v249
v_exp_f32 v210, v210
v_exp_f32 v250, v250
v_exp_f32 v211, v211
v_exp_f32 v251, v251
v_pk_add_f32 v[44:45], v[192:193], v[194:195]
v_pk_add_f32 v[46:47], v[232:233], v[234:235]
v_pk_add_f32 v[44:45], v[44:45], v[196:197]
v_pk_add_f32 v[46:47], v[46:47], v[236:237]
v_pk_add_f32 v[44:45], v[44:45], v[198:199]
v_pk_add_f32 v[46:47], v[46:47], v[238:239]
v_pk_add_f32 v[44:45], v[44:45], v[200:201]
v_pk_add_f32 v[46:47], v[46:47], v[240:241]
v_pk_add_f32 v[44:45], v[44:45], v[202:203]
v_pk_add_f32 v[46:47], v[46:47], v[242:243]
v_pk_add_f32 v[44:45], v[44:45], v[204:205]
v_pk_add_f32 v[46:47], v[46:47], v[244:245]
v_pk_add_f32 v[44:45], v[44:45], v[206:207]
v_pk_add_f32 v[46:47], v[46:47], v[246:247]
v_pk_add_f32 v[44:45], v[44:45], v[208:209]
v_pk_add_f32 v[46:47], v[46:47], v[248:249]
v_pk_add_f32 v[44:45], v[44:45], v[210:211]
v_pk_add_f32 v[46:47], v[46:47], v[250:251]
v_add_f32 v44, v44, v45
v_add_f32 v46, v46, v47
v_rcp_f32 v44, v44
v_rcp_f32 v46, v46
v_pk_mul_f32 v[192:193], v[192:193], v[44:45] op_sel_hi:[1,0]
v_pk_mul_f32 v[194:195], v[194:195], v[44:45] op_sel_hi:[1,0]
v_cvt_pk_bf16_f32 v160, v192, v193
v_pk_mul_f32 v[196:197], v[196:197], v[44:45] op_sel_hi:[1,0]
v_cvt_pk_bf16_f32 v161, v194, v195
v_pk_mul_f32 v[198:199], v[198:199], v[44:45] op_sel_hi:[1,0]
v_cvt_pk_bf16_f32 v162, v196, v197
v_pk_mul_f32 v[200:201], v[200:201], v[44:45] op_sel_hi:[1,0]
v_cvt_pk_bf16_f32 v163, v198, v199
ds_write_b128 v32, v[160:163] offset:2048
v_pk_mul_f32 v[202:203], v[202:203], v[44:45] op_sel_hi:[1,0]
v_cvt_pk_bf16_f32 v164, v200, v201
v_pk_mul_f32 v[204:205], v[204:205], v[44:45] op_sel_hi:[1,0]
v_cvt_pk_bf16_f32 v165, v202, v203
v_pk_mul_f32 v[206:207], v[206:207], v[44:45] op_sel_hi:[1,0]
v_cvt_pk_bf16_f32 v166, v204, v205
v_pk_mul_f32 v[208:209], v[208:209], v[44:45] op_sel_hi:[1,0]
v_cvt_pk_bf16_f32 v167, v206, v207
ds_write_b128 v33, v[164:167] offset:2048
v_pk_mul_f32 v[210:211], v[210:211], v[44:45] op_sel_hi:[1,0]
v_cvt_pk_bf16_f32 v168, v208, v209
v_cvt_pk_bf16_f32 v169, v210, v211
v_pk_mul_f32 v[232:233], v[232:233], v[46:47] op_sel_hi:[1,0]
v_pk_mul_f32 v[234:235], v[234:235], v[46:47] op_sel_hi:[1,0]
v_cvt_pk_bf16_f32 v170, v232, v233
v_pk_mul_f32 v[236:237], v[236:237], v[46:47] op_sel_hi:[1,0]
v_cvt_pk_bf16_f32 v171, v234, v235
ds_write_b128 v34, v[168:171] offset:2048
v_pk_mul_f32 v[238:239], v[238:239], v[46:47] op_sel_hi:[1,0]
v_cvt_pk_bf16_f32 v172, v236, v237
v_pk_mul_f32 v[240:241], v[240:241], v[46:47] op_sel_hi:[1,0]
v_cvt_pk_bf16_f32 v173, v238, v239
v_pk_mul_f32 v[242:243], v[242:243], v[46:47] op_sel_hi:[1,0]
v_cvt_pk_bf16_f32 v174, v240, v241
v_pk_mul_f32 v[244:245], v[244:245], v[46:47] op_sel_hi:[1,0]
v_cvt_pk_bf16_f32 v175, v242, v243
ds_write_b128 v35, v[172:175] offset:2048
v_pk_mul_f32 v[246:247], v[246:247], v[46:47] op_sel_hi:[1,0]
v_cvt_pk_bf16_f32 v176, v244, v245
v_pk_mul_f32 v[248:249], v[248:249], v[46:47] op_sel_hi:[1,0]
v_cvt_pk_bf16_f32 v177, v246, v247
v_pk_mul_f32 v[250:251], v[250:251], v[46:47] op_sel_hi:[1,0]
v_cvt_pk_bf16_f32 v178, v248, v249
v_cvt_pk_bf16_f32 v179, v250, v251
ds_write_b128 v36, v[176:179] offset:2048
s_waitcnt lgkmcnt(0)
s_mov_b64 exec, 1
v_mov_b32 v136, 133124
v_mov_b32 v137, 1
ds_add_u32 v136, v137
s_mov_b32 s79, 0
L_ls_28:
ds_read_b32 v137, v136
s_waitcnt lgkmcnt(0)
v_readfirstlane_b32 s78, v137
s_add_u32 s79, s79, 1
s_cmp_ge_u32 s79, 0x1000000
s_cbranch_scc1 L_end
s_cmp_lt_u32 s78, 4
s_cbranch_scc1 L_ls_28
s_mov_b64 exec, -1
ds_read_b64_tr_b16 v[48:49], v128 offset:0
ds_read_b64_tr_b16 v[50:51], v128 offset:2048
ds_read_b64_tr_b16 v[52:53], v129 offset:0
ds_read_b64_tr_b16 v[54:55], v129 offset:2048
ds_read_b64_tr_b16 v[56:57], v130 offset:0
ds_read_b64_tr_b16 v[58:59], v130 offset:2048
ds_read_b64_tr_b16 v[60:61], v131 offset:0
ds_read_b64_tr_b16 v[62:63], v131 offset:2048
ds_read_b64_tr_b16 v[64:65], v132 offset:0
ds_read_b64_tr_b16 v[66:67], v132 offset:2048
ds_read_b64_tr_b16 v[68:69], v128 offset:4096
ds_read_b64_tr_b16 v[70:71], v128 offset:6144
ds_read_b64_tr_b16 v[72:73], v129 offset:4096
ds_read_b64_tr_b16 v[74:75], v129 offset:6144
s_waitcnt lgkmcnt(4)
v_mfma_f32_16x16x32_bf16 v[212:215], v[48:51], v[60:63], 0
ds_read_b64_tr_b16 v[76:77], v130 offset:4096
ds_read_b64_tr_b16 v[78:79], v130 offset:6144
v_mfma_f32_16x16x32_bf16 v[216:219], v[52:55], v[60:63], 0
ds_read_b64_tr_b16 v[80:81], v131 offset:4096
ds_read_b64_tr_b16 v[82:83], v131 offset:6144
v_mfma_f32_16x16x32_bf16 v[220:223], v[56:59], v[60:63], 0
ds_read_b64_tr_b16 v[84:85], v132 offset:4096
ds_read_b64_tr_b16 v[86:87], v132 offset:6144
v_mfma_f32_16x16x32_bf16 v[224:227], v[48:51], v[64:67], 0
ds_read_b64_tr_b16 v[140:141], v128 offset:8192
ds_read_b64_tr_b16 v[142:143], v128 offset:10240
v_mfma_f32_16x16x32_bf16 v[228:231], v[52:55], v[64:67], 0
ds_read_b64_tr_b16 v[144:145], v129 offset:8192
ds_read_b64_tr_b16 v[146:147], v129 offset:10240
v_mfma_f32_16x16x32_bf16 v[232:235], v[56:59], v[64:67], 0
s_waitcnt lgkmcnt(4)
v_mfma_f32_16x16x32_bf16 v[212:215], v[68:71], v[80:83], v[212:215]
ds_read_b64_tr_b16 v[148:149], v130 offset:8192
ds_read_b64_tr_b16 v[150:151], v130 offset:10240
v_mfma_f32_16x16x32_bf16 v[216:219], v[72:75], v[80:83], v[216:219]
ds_read_b64_tr_b16 v[152:153], v131 offset:8192
ds_read_b64_tr_b16 v[154:155], v131 offset:10240
v_mfma_f32_16x16x32_bf16 v[220:223], v[76:79], v[80:83], v[220:223]
ds_read_b64_tr_b16 v[156:157], v132 offset:8192
ds_read_b64_tr_b16 v[158:159], v132 offset:10240
v_mfma_f32_16x16x32_bf16 v[224:227], v[68:71], v[84:87], v[224:227]
ds_read_b64_tr_b16 v[160:161], v128 offset:12288
ds_read_b64_tr_b16 v[162:163], v128 offset:14336
v_mfma_f32_16x16x32_bf16 v[228:231], v[72:75], v[84:87], v[228:231]
ds_read_b64_tr_b16 v[164:165], v129 offset:12288
ds_read_b64_tr_b16 v[166:167], v129 offset:14336
v_mfma_f32_16x16x32_bf16 v[232:235], v[76:79], v[84:87], v[232:235]
s_waitcnt lgkmcnt(4)
v_mfma_f32_16x16x32_bf16 v[212:215], v[140:143], v[152:155], v[212:215]
ds_read_b64_tr_b16 v[168:169], v130 offset:12288
ds_read_b64_tr_b16 v[170:171], v130 offset:14336
v_mfma_f32_16x16x32_bf16 v[216:219], v[144:147], v[152:155], v[216:219]
ds_read_b64_tr_b16 v[172:173], v131 offset:12288
ds_read_b64_tr_b16 v[174:175], v131 offset:14336
v_mfma_f32_16x16x32_bf16 v[220:223], v[148:151], v[152:155], v[220:223]
ds_read_b64_tr_b16 v[176:177], v132 offset:12288
ds_read_b64_tr_b16 v[178:179], v132 offset:14336
v_mfma_f32_16x16x32_bf16 v[224:227], v[140:143], v[156:159], v[224:227]
v_mfma_f32_16x16x32_bf16 v[228:231], v[144:147], v[156:159], v[228:231]
v_mfma_f32_16x16x32_bf16 v[232:235], v[148:151], v[156:159], v[232:235]
s_waitcnt lgkmcnt(0)
v_mfma_f32_16x16x32_bf16 v[212:215], v[160:163], v[172:175], v[212:215]
v_mfma_f32_16x16x32_bf16 v[216:219], v[164:167], v[172:175], v[216:219]
v_mfma_f32_16x16x32_bf16 v[220:223], v[168:171], v[172:175], v[220:223]
v_mfma_f32_16x16x32_bf16 v[224:227], v[160:163], v[176:179], v[224:227]
v_mfma_f32_16x16x32_bf16 v[228:231], v[164:167], v[176:179], v[228:231]
v_mfma_f32_16x16x32_bf16 v[232:235], v[168:171], v[176:179], v[232:235]
s_mov_b64 exec, 1
v_mov_b32 v136, 133168
v_mov_b32 v137, 1
ds_add_u32 v136, v137
s_mov_b64 exec, -1
buffer_store_dwordx4 v[212:215], v5, s[48:51], s5 offen offset:0 sc1
buffer_store_dwordx4 v[224:227], v134, s[48:51], s5 offen offset:1024 sc1
buffer_store_dwordx4 v[216:219], v5, s[48:51], s5 offen offset:2048 sc1
buffer_store_dwordx4 v[228:231], v134, s[48:51], s5 offen offset:3072 sc1
buffer_store_dwordx4 v[220:223], v133, s[48:51], s6 offen offset:0 sc1
buffer_store_dwordx4 v[232:235], v135, s[48:51], s6 offen offset:1024 sc1
v_mov_b32 v128, 3222493025
v_mov_b32 v129, 3222493025
v_pk_mul_f32 v[130:131], v[88:89], v[88:89]
v_pk_mul_f32 v[132:133], v[90:91], v[90:91]
v_pk_mul_f32 v[134:135], v[96:97], v[96:97]
v_pk_mul_f32 v[136:137], v[98:99], v[98:99]
v_pk_fma_f32 v[130:131], v[130:131], s[8:9], v[128:129]
v_pk_fma_f32 v[132:133], v[132:133], s[8:9], v[128:129]
v_pk_fma_f32 v[134:135], v[134:135], s[8:9], v[128:129]
v_pk_fma_f32 v[136:137], v[136:137], s[8:9], v[128:129]
v_pk_mul_f32 v[130:131], v[130:131], v[88:89]
v_pk_mul_f32 v[132:133], v[132:133], v[90:91]
v_pk_mul_f32 v[134:135], v[134:135], v[96:97]
v_pk_mul_f32 v[136:137], v[136:137], v[98:99]
v_exp_f32 v130, v130
v_exp_f32 v131, v131
v_exp_f32 v132, v132
v_exp_f32 v133, v133
v_exp_f32 v134, v134
v_exp_f32 v135, v135
v_exp_f32 v136, v136
v_exp_f32 v137, v137
v_pk_add_f32 v[130:131], v[130:131], 1.0 op_sel_hi:[1,0]
v_pk_add_f32 v[132:133], v[132:133], 1.0 op_sel_hi:[1,0]
v_pk_add_f32 v[134:135], v[134:135], 1.0 op_sel_hi:[1,0]
v_pk_add_f32 v[136:137], v[136:137], 1.0 op_sel_hi:[1,0]
v_rcp_f32 v130, v130
v_rcp_f32 v131, v131
v_rcp_f32 v132, v132
v_rcp_f32 v133, v133
v_rcp_f32 v134, v134
v_rcp_f32 v135, v135
v_rcp_f32 v136, v136
v_rcp_f32 v137, v137
v_pk_mul_f32 v[130:131], v[130:131], v[88:89]
v_pk_mul_f32 v[132:133], v[132:133], v[90:91]
v_pk_mul_f32 v[134:135], v[134:135], v[96:97]
v_pk_mul_f32 v[136:137], v[136:137], v[98:99]
v_cvt_pk_bf16_f32 v192, v130, v131
v_cvt_pk_bf16_f32 v193, v132, v133
v_cvt_pk_bf16_f32 v194, v134, v135
v_cvt_pk_bf16_f32 v195, v136, v137
buffer_store_dwordx4 v[192:195], v5, s[48:51], s12 offen offset:0 sc1
v_pk_mul_f32 v[130:131], v[92:93], v[92:93]
v_pk_mul_f32 v[132:133], v[94:95], v[94:95]
v_pk_mul_f32 v[134:135], v[100:101], v[100:101]
v_pk_mul_f32 v[136:137], v[102:103], v[102:103]
v_pk_fma_f32 v[130:131], v[130:131], s[8:9], v[128:129]
v_pk_fma_f32 v[132:133], v[132:133], s[8:9], v[128:129]
v_pk_fma_f32 v[134:135], v[134:135], s[8:9], v[128:129]
v_pk_fma_f32 v[136:137], v[136:137], s[8:9], v[128:129]
v_pk_mul_f32 v[130:131], v[130:131], v[92:93]
v_pk_mul_f32 v[132:133], v[132:133], v[94:95]
v_pk_mul_f32 v[134:135], v[134:135], v[100:101]
v_pk_mul_f32 v[136:137], v[136:137], v[102:103]
v_exp_f32 v130, v130
v_exp_f32 v131, v131
v_exp_f32 v132, v132
v_exp_f32 v133, v133
v_exp_f32 v134, v134
v_exp_f32 v135, v135
v_exp_f32 v136, v136
v_exp_f32 v137, v137
v_pk_add_f32 v[130:131], v[130:131], 1.0 op_sel_hi:[1,0]
v_pk_add_f32 v[132:133], v[132:133], 1.0 op_sel_hi:[1,0]
v_pk_add_f32 v[134:135], v[134:135], 1.0 op_sel_hi:[1,0]
v_pk_add_f32 v[136:137], v[136:137], 1.0 op_sel_hi:[1,0]
v_rcp_f32 v130, v130
v_rcp_f32 v131, v131
v_rcp_f32 v132, v132
v_rcp_f32 v133, v133
v_rcp_f32 v134, v134
v_rcp_f32 v135, v135
v_rcp_f32 v136, v136
v_rcp_f32 v137, v137
v_pk_mul_f32 v[130:131], v[130:131], v[92:93]
v_pk_mul_f32 v[132:133], v[132:133], v[94:95]
v_pk_mul_f32 v[134:135], v[134:135], v[100:101]
v_pk_mul_f32 v[136:137], v[136:137], v[102:103]
v_cvt_pk_bf16_f32 v196, v130, v131
v_cvt_pk_bf16_f32 v197, v132, v133
v_cvt_pk_bf16_f32 v198, v134, v135
v_cvt_pk_bf16_f32 v199, v136, v137
buffer_store_dwordx4 v[196:199], v5, s[48:51], s12 offen offset:1024 sc1
s_add_u32 s12, s12, 4096
s_waitcnt lgkmcnt(0)
s_mul_i32 s20, s65, 512
s_add_u32 s20, s20, s68
s_addc_u32 s21, s69, 0
s_mov_b32 s16, 1
s_mov_b32 s17, 1
s_mov_b32 s18, 1
s_mov_b32 s19, 1
s_waitcnt vmcnt(2)
s_waitcnt lgkmcnt(0)
s_mov_b64 exec, 1
v_mov_b32 v136, 133128
v_mov_b32 v137, 1
ds_add_u32 v136, v137
s_mov_b32 s79, 0
L_ls_30:
ds_read_b32 v137, v136
s_waitcnt lgkmcnt(0)
v_readfirstlane_b32 s78, v137
s_add_u32 s79, s79, 1
s_cmp_ge_u32 s79, 0x1000000
s_cbranch_scc1 L_end
s_cmp_lt_u32 s78, 4
s_cbranch_scc1 L_ls_30
s_mov_b64 exec, -1
s_atomic_add s16, s[20:21], 0 glc
s_atomic_add s17, s[20:21], 128 glc
s_atomic_add s18, s[20:21], 256 glc
s_atomic_add s19, s[20:21], 384 glc
v_pk_mul_f32 v[130:131], v[104:105], v[104:105]
v_pk_mul_f32 v[132:133], v[106:107], v[106:107]
v_pk_mul_f32 v[134:135], v[112:113], v[112:113]
v_pk_mul_f32 v[136:137], v[114:115], v[114:115]
v_pk_fma_f32 v[130:131], v[130:131], s[8:9], v[128:129]
v_pk_fma_f32 v[132:133], v[132:133], s[8:9], v[128:129]
v_pk_fma_f32 v[134:135], v[134:135], s[8:9], v[128:129]
v_pk_fma_f32 v[136:137], v[136:137], s[8:9], v[128:129]
v_pk_mul_f32 v[130:131], v[130:131], v[104:105]
v_pk_mul_f32 v[132:133], v[132:133], v[106:107]
v_pk_mul_f32 v[134:135], v[134:135], v[112:113]
v_pk_mul_f32 v[136:137], v[136:137], v[114:115]
v_exp_f32 v130, v130
v_exp_f32 v131, v131
v_exp_f32 v132, v132
v_exp_f32 v133, v133
v_exp_f32 v134, v134
v_exp_f32 v135, v135
v_exp_f32 v136, v136
v_exp_f32 v137, v137
v_pk_add_f32 v[130:131], v[130:131], 1.0 op_sel_hi:[1,0]
v_pk_add_f32 v[132:133], v[132:133], 1.0 op_sel_hi:[1,0]
v_pk_add_f32 v[134:135], v[134:135], 1.0 op_sel_hi:[1,0]
v_pk_add_f32 v[136:137], v[136:137], 1.0 op_sel_hi:[1,0]
v_rcp_f32 v130, v130
v_rcp_f32 v131, v131
v_rcp_f32 v132, v132
v_rcp_f32 v133, v133
v_rcp_f32 v134, v134
v_rcp_f32 v135, v135
v_rcp_f32 v136, v136
v_rcp_f32 v137, v137
v_pk_mul_f32 v[130:131], v[130:131], v[104:105]
v_pk_mul_f32 v[132:133], v[132:133], v[106:107]
v_pk_mul_f32 v[134:135], v[134:135], v[112:113]
v_pk_mul_f32 v[136:137], v[136:137], v[114:115]
v_cvt_pk_bf16_f32 v200, v130, v131
v_cvt_pk_bf16_f32 v201, v132, v133
v_cvt_pk_bf16_f32 v202, v134, v135
v_cvt_pk_bf16_f32 v203, v136, v137
buffer_store_dwordx4 v[200:203], v5, s[48:51], s12 offen offset:0 sc1
v_pk_mul_f32 v[130:131], v[108:109], v[108:109]
v_pk_mul_f32 v[132:133], v[110:111], v[110:111]
v_pk_mul_f32 v[134:135], v[116:117], v[116:117]
v_pk_mul_f32 v[136:137], v[118:119], v[118:119]
v_pk_fma_f32 v[130:131], v[130:131], s[8:9], v[128:129]
v_pk_fma_f32 v[132:133], v[132:133], s[8:9], v[128:129]
v_pk_fma_f32 v[134:135], v[134:135], s[8:9], v[128:129]
v_pk_fma_f32 v[136:137], v[136:137], s[8:9], v[128:129]
v_pk_mul_f32 v[130:131], v[130:131], v[108:109]
v_pk_mul_f32 v[132:133], v[132:133], v[110:111]
v_pk_mul_f32 v[134:135], v[134:135], v[116:117]
v_pk_mul_f32 v[136:137], v[136:137], v[118:119]
v_exp_f32 v130, v130
v_exp_f32 v131, v131
v_exp_f32 v132, v132
v_exp_f32 v133, v133
v_exp_f32 v134, v134
v_exp_f32 v135, v135
v_exp_f32 v136, v136
v_exp_f32 v137, v137
v_pk_add_f32 v[130:131], v[130:131], 1.0 op_sel_hi:[1,0]
v_pk_add_f32 v[132:133], v[132:133], 1.0 op_sel_hi:[1,0]
v_pk_add_f32 v[134:135], v[134:135], 1.0 op_sel_hi:[1,0]
v_pk_add_f32 v[136:137], v[136:137], 1.0 op_sel_hi:[1,0]
v_rcp_f32 v130, v130
v_rcp_f32 v131, v131
v_rcp_f32 v132, v132
v_rcp_f32 v133, v133
v_rcp_f32 v134, v134
v_rcp_f32 v135, v135
v_rcp_f32 v136, v136
v_rcp_f32 v137, v137
v_pk_mul_f32 v[130:131], v[130:131], v[108:109]
v_pk_mul_f32 v[132:133], v[132:133], v[110:111]
v_pk_mul_f32 v[134:135], v[134:135], v[116:117]
v_pk_mul_f32 v[136:137], v[136:137], v[118:119]
v_cvt_pk_bf16_f32 v204, v130, v131
v_cvt_pk_bf16_f32 v205, v132, v133
v_cvt_pk_bf16_f32 v206, v134, v135
v_cvt_pk_bf16_f32 v207, v136, v137
buffer_store_dwordx4 v[204:207], v5, s[48:51], s12 offen offset:1024 sc1
s_add_u32 s12, s12, 4096
L_hskip_29:
s_lshl_b32 s76, s60, 7
s_add_u32 s68, s68, s76
s_addc_u32 s69, s69, 0
s_mov_b32 s79, 0
L_sp_31:
s_load_dword s34, s[68:69], 0 glc
s_waitcnt lgkmcnt(0)
s_cmp_ge_u32 s34, 16
s_cbranch_scc1 L_spd_33
s_add_u32 s79, s79, 1
s_cmp_ge_u32 s79, 0x200000
s_cbranch_scc1 L_end
s_branch L_sp_31
L_spd_33:
buffer_load_dwordx4 v[16:19], v6, s[48:51], s4 offen sc1
s_add_u32 s4, s4, 98304
buffer_load_dwordx4 v[20:23], v6, s[48:51], s4 offen sc1
s_add_u32 s4, s4, 98304
buffer_load_dwordx4 v[24:27], v6, s[48:51], s4 offen sc1
s_add_u32 s4, s4, 98304
buffer_load_dwordx4 v[28:31], v6, s[48:51], s4 offen sc1
s_add_u32 s4, s4, 98304
s_waitcnt lgkmcnt(0)
s_mov_b32 s16, 1
s_mov_b32 s17, 1
s_mov_b32 s18, 1
s_mov_b32 s19, 1
s_mov_b32 s20, 1
s_mov_b32 s21, 1
s_mov_b32 s22, 1
s_mov_b32 s23, 1
s_mov_b32 s24, 1
s_mov_b32 s25, 1
s_mov_b32 s26, 1
s_mov_b32 s27, 1
s_mov_b32 s28, 1
s_mov_b32 s29, 1
s_mov_b32 s30, 1
s_mov_b32 s31, 1
s_waitcnt vmcnt(4)
s_mov_b64 exec, 1
v_mov_b32 v136, 133120
v_mov_b32 v137, 1
ds_add_rtn_u32 v136, v136, v137
s_waitcnt lgkmcnt(0)
v_readfirstlane_b32 s78, v136
s_mov_b64 exec, -1
s_nop 0
s_cmp_lg_u32 s78, 3
s_cbranch_scc1 L_arr_34
s_atomic_add s16, s[72:73], 4 glc
s_atomic_add s17, s[72:73], 516 glc
s_atomic_add s18, s[72:73], 1028 glc
s_atomic_add s19, s[72:73], 1540 glc
s_atomic_add s20, s[72:73], 2052 glc
s_atomic_add s21, s[72:73], 2564 glc
s_atomic_add s22, s[72:73], 3076 glc
s_atomic_add s23, s[72:73], 3588 glc
s_atomic_add s24, s[72:73], 4100 glc
s_atomic_add s25, s[72:73], 4612 glc
s_atomic_add s26, s[72:73], 5124 glc
s_atomic_add s27, s[72:73], 5636 glc
s_atomic_add s28, s[72:73], 6148 glc
s_atomic_add s29, s[72:73], 6660 glc
s_atomic_add s30, s[72:73], 7172 glc
s_atomic_add s31, s[72:73], 7684 glc
L_arr_34:
s_waitcnt vmcnt(0)
v_pk_add_f32 v[16:17], v[16:17], v[20:21]
v_pk_add_f32 v[24:25], v[24:25], v[28:29]
v_pk_add_f32 v[18:19], v[18:19], v[22:23]
v_pk_add_f32 v[26:27], v[26:27], v[30:31]
v_pk_add_f32 v[16:17], v[16:17], v[24:25]
v_pk_add_f32 v[18:19], v[18:19], v[26:27]
v_mov_b32 v20, v16
v_mov_b32 v21, v17
v_mov_b32 v22, v18
v_mov_b32 v23, v19
v_permlane32_swap_b32 v20, v16
v_permlane32_swap_b32 v21, v17
v_permlane32_swap_b32 v22, v18
v_permlane32_swap_b32 v23, v19
v_pk_add_f32 v[16:17], v[16:17], v[20:21]
v_pk_add_f32 v[18:19], v[18:19], v[22:23]
v_mov_b32 v20, v16
v_mov_b32 v21, v17
v_mov_b32 v22, v18
v_mov_b32 v23, v19
v_permlane16_swap_b32 v20, v16
v_permlane16_swap_b32 v21, v17
v_permlane16_swap_b32 v22, v18
v_permlane16_swap_b32 v23, v19
v_pk_add_f32 v[16:17], v[16:17], v[20:21]
v_pk_add_f32 v[18:19], v[18:19], v[22:23]
v_cvt_pk_bf16_f32 v14, v16, v17
v_cvt_pk_bf16_f32 v15, v18, v19
buffer_store_dwordx2 v[14:15], v7, s[48:51], s7 offen sc1
s_waitcnt lgkmcnt(0)
s_mul_i32 s20, s65, 512
s_add_u32 s20, s20, s74
s_addc_u32 s21, s75, 0
s_mov_b32 s16, 1
s_mov_b32 s17, 1
s_mov_b32 s18, 1
s_mov_b32 s19, 1
s_waitcnt vmcnt(0)
s_waitcnt lgkmcnt(0)
s_mov_b64 exec, 1
v_mov_b32 v136, 133136
v_mov_b32 v137, 1
ds_add_u32 v136, v137
s_mov_b32 s79, 0
L_ls_35:
ds_read_b32 v137, v136
s_waitcnt lgkmcnt(0)
v_readfirstlane_b32 s78, v137
s_add_u32 s79, s79, 1
s_cmp_ge_u32 s79, 0x1000000
s_cbranch_scc1 L_end
s_cmp_lt_u32 s78, 4
s_cbranch_scc1 L_ls_35
s_mov_b64 exec, -1
s_atomic_add s16, s[20:21], 0 glc
s_atomic_add s17, s[20:21], 128 glc
s_atomic_add s18, s[20:21], 256 glc
s_atomic_add s19, s[20:21], 384 glc
s_endpgm
L_CQ:
v_mul_u32_u24 v128, 320, v4
v_lshl_add_u32 v128, v3, 3, v128
v_add_u32 v128, v128, v6
v_lshlrev_b32 v129, 5, v5
v_add_u32 v248, v128, v129
v_sub_u32 v250, v128, v129
v_add_u32 v250, 32, v250
v_add_u32 v249, 49152, v248
v_add_u32 v251, 49152, v250
s_mul_i32 s76, s15, 54
s_mul_i32 s77, s61, 5
s_add_u32 s76, s76, s77
s_add_u32 s76, s76, 16
s_lshl_b32 s76, s76, 12
s_and_b32 s77, s65, 1
s_lshl_b32 s77, s77, 11
s_add_u32 s12, s76, s77
v_mov_b32 v8, 0
v_mov_b32 v9, 0
v_mov_b32 v10, 0
v_mov_b32 v11, 0
v_mov_b32 v12, 0
v_mov_b32 v13, 0
v_mov_b32 v14, 0
v_mov_b32 v15, 0
v_mov_b32 v16, 0
v_mov_b32 v17, 0
v_mov_b32 v18, 0
v_mov_b32 v19, 0
v_mov_b32 v20, 0
v_mov_b32 v21, 0
v_mov_b32 v22, 0
v_mov_b32 v23, 0
v_mov_b32 v24, 0
v_mov_b32 v25, 0
v_mov_b32 v26, 0
v_mov_b32 v27, 0
v_mov_b32 v28, 0
v_mov_b32 v29, 0
v_mov_b32 v30, 0
v_mov_b32 v31, 0
v_mov_b32 v32, 0
v_mov_b32 v33, 0
v_mov_b32 v34, 0
v_mov_b32 v35, 0
v_mov_b32 v36, 0
v_mov_b32 v37, 0
v_mov_b32 v38, 0
v_mov_b32 v39, 0
v_mov_b32 v40, 0
v_mov_b32 v41, 0
v_mov_b32 v42, 0
v_mov_b32 v43, 0
v_mov_b32 v44, 0
v_mov_b32 v45, 0
v_mov_b32 v46, 0
v_mov_b32 v47, 0
v_lshlrev_b32 v156, 3, v1
v_add_u32 v156, 163328, v156
s_waitcnt vmcnt(4)
ds_read_b64 v[136:137], v156 offset:0
ds_read_b64 v[138:139], v156 offset:32
ds_read_b64 v[140:141], v156 offset:64
ds_read_b64 v[142:143], v156 offset:96
ds_read_b64 v[144:145], v156 offset:128
ds_read_b64 v[146:147], v156 offset:160
ds_read_b64 v[148:149], v156 offset:192
ds_read_b64 v[150:151], v156 offset:224
ds_read_b64 v[152:153], v156 offset:256
ds_read_b64 v[154:155], v156 offset:288
s_waitcnt lgkmcnt(0)
v_lshlrev_b32 v48, 16, v136
v_and_b32 v49, 0xffff0000, v136
v_lshlrev_b32 v50, 16, v137
v_and_b32 v51, 0xffff0000, v137
v_lshlrev_b32 v52, 16, v136
v_and_b32 v53, 0xffff0000, v136
v_lshlrev_b32 v54, 16, v137
v_and_b32 v55, 0xffff0000, v137
v_lshlrev_b32 v56, 16, v138
v_and_b32 v57, 0xffff0000, v138
v_lshlrev_b32 v58, 16, v139
v_and_b32 v59, 0xffff0000, v139
v_lshlrev_b32 v60, 16, v138
v_and_b32 v61, 0xffff0000, v138
v_lshlrev_b32 v62, 16, v139
v_and_b32 v63, 0xffff0000, v139
v_lshlrev_b32 v64, 16, v140
v_and_b32 v65, 0xffff0000, v140
v_lshlrev_b32 v66, 16, v141
v_and_b32 v67, 0xffff0000, v141
v_lshlrev_b32 v68, 16, v140
v_and_b32 v69, 0xffff0000, v140
v_lshlrev_b32 v70, 16, v141
v_and_b32 v71, 0xffff0000, v141
v_lshlrev_b32 v72, 16, v142
v_and_b32 v73, 0xffff0000, v142
v_lshlrev_b32 v74, 16, v143
v_and_b32 v75, 0xffff0000, v143
v_lshlrev_b32 v76, 16, v142
v_and_b32 v77, 0xffff0000, v142
v_lshlrev_b32 v78, 16, v143
v_and_b32 v79, 0xffff0000, v143
v_lshlrev_b32 v80, 16, v144
v_and_b32 v81, 0xffff0000, v144
v_lshlrev_b32 v82, 16, v145
v_and_b32 v83, 0xffff0000, v145
v_lshlrev_b32 v84, 16, v144
v_and_b32 v85, 0xffff0000, v144
v_lshlrev_b32 v86, 16, v145
v_and_b32 v87, 0xffff0000, v145
v_lshlrev_b32 v88, 16, v146
v_and_b32 v89, 0xffff0000, v146
v_lshlrev_b32 v90, 16, v147
v_and_b32 v91, 0xffff0000, v147
v_lshlrev_b32 v92, 16, v146
v_and_b32 v93, 0xffff0000, v146
v_lshlrev_b32 v94, 16, v147
v_and_b32 v95, 0xffff0000, v147
v_lshlrev_b32 v96, 16, v148
v_and_b32 v97, 0xffff0000, v148
v_lshlrev_b32 v98, 16, v149
v_and_b32 v99, 0xffff0000, v149
v_lshlrev_b32 v100, 16, v148
v_and_b32 v101, 0xffff0000, v148
v_lshlrev_b32 v102, 16, v149
v_and_b32 v103, 0xffff0000, v149
v_lshlrev_b32 v104, 16, v150
v_and_b32 v105, 0xffff0000, v150
v_lshlrev_b32 v106, 16, v151
v_and_b32 v107, 0xffff0000, v151
v_lshlrev_b32 v108, 16, v150
v_and_b32 v109, 0xffff0000, v150
v_lshlrev_b32 v110, 16, v151
v_and_b32 v111, 0xffff0000, v151
v_lshlrev_b32 v112, 16, v152
v_and_b32 v113, 0xffff0000, v152
v_lshlrev_b32 v114, 16, v153
v_and_b32 v115, 0xffff0000, v153
v_lshlrev_b32 v116, 16, v152
v_and_b32 v117, 0xffff0000, v152
v_lshlrev_b32 v118, 16, v153
v_and_b32 v119, 0xffff0000, v153
v_lshlrev_b32 v120, 16, v154
v_and_b32 v121, 0xffff0000, v154
v_lshlrev_b32 v122, 16, v155
v_and_b32 v123, 0xffff0000, v155
v_lshlrev_b32 v124, 16, v154
v_and_b32 v125, 0xffff0000, v154
v_lshlrev_b32 v126, 16, v155
v_and_b32 v127, 0xffff0000, v155
s_waitcnt vmcnt(0)
s_barrier
ds_read_b128 v[224:227], v246 offset:0
ds_read_b128 v[228:231], v246 offset:2048
ds_read_b64_tr_b16 v[192:193], v240 offset:0
ds_read_b64_tr_b16 v[194:195], v240 offset:4096
ds_read_b64_tr_b16 v[196:197], v240 offset:8
ds_read_b64_tr_b16 v[198:199], v240 offset:4104
ds_read_b64_tr_b16 v[200:201], v240 offset:16
ds_read_b64_tr_b16 v[202:203], v240 offset:4112
ds_read_b64_tr_b16 v[204:205], v240 offset:24
ds_read_b64_tr_b16 v[206:207], v240 offset:4120
ds_read_b64_tr_b16 v[208:209], v240 offset:32
ds_read_b64_tr_b16 v[210:211], v240 offset:4128
s_waitcnt lgkmcnt(6)
v_mfma_f32_16x16x32_bf16 v[8:11], v[192:195], v[224:227], v[8:11]
ds_read_b64_tr_b16 v[212:213], v248 offset:1280
v_mfma_f32_16x16x32_bf16 v[12:15], v[192:195], v[228:231], v[12:15]
ds_read_b64_tr_b16 v[214:215], v248 offset:5376
v_mfma_f32_16x16x32_bf16 v[16:19], v[196:199], v[224:227], v[16:19]
ds_read_b64_tr_b16 v[216:217], v250 offset:1280
v_mfma_f32_16x16x32_bf16 v[20:23], v[196:199], v[228:231], v[20:23]
ds_read_b64_tr_b16 v[218:219], v250 offset:5376
s_waitcnt lgkmcnt(6)
v_mfma_f32_16x16x32_bf16 v[24:27], v[200:203], v[224:227], v[24:27]
ds_read_b64_tr_b16 v[192:193], v248 offset:1344
v_mfma_f32_16x16x32_bf16 v[28:31], v[200:203], v[228:231], v[28:31]
ds_read_b64_tr_b16 v[194:195], v248 offset:5440
v_mfma_f32_16x16x32_bf16 v[32:35], v[204:207], v[224:227], v[32:35]
ds_read_b64_tr_b16 v[196:197], v250 offset:1344
v_mfma_f32_16x16x32_bf16 v[36:39], v[204:207], v[228:231], v[36:39]
ds_read_b64_tr_b16 v[198:199], v250 offset:5440
s_waitcnt lgkmcnt(6)
v_mfma_f32_16x16x32_bf16 v[40:43], v[208:211], v[224:227], v[40:43]
ds_read_b64_tr_b16 v[200:201], v248 offset:1408
v_mfma_f32_16x16x32_bf16 v[44:47], v[208:211], v[228:231], v[44:47]
ds_read_b64_tr_b16 v[202:203], v248 offset:5504
v_mfma_f32_16x16x32_bf16 v[48:51], v[212:215], v[224:227], v[48:51]
ds_read_b64_tr_b16 v[204:205], v250 offset:1408
v_mfma_f32_16x16x32_bf16 v[52:55], v[212:215], v[228:231], v[52:55]
ds_read_b64_tr_b16 v[206:207], v250 offset:5504
s_waitcnt lgkmcnt(6)
v_mfma_f32_16x16x32_bf16 v[56:59], v[216:219], v[224:227], v[56:59]
ds_read_b64_tr_b16 v[208:209], v248 offset:1472
v_mfma_f32_16x16x32_bf16 v[60:63], v[216:219], v[228:231], v[60:63]
ds_read_b64_tr_b16 v[210:211], v248 offset:5568
v_mfma_f32_16x16x32_bf16 v[64:67], v[192:195], v[224:227], v[64:67]
ds_read_b64_tr_b16 v[212:213], v250 offset:1472
v_mfma_f32_16x16x32_bf16 v[68:71], v[192:195], v[228:231], v[68:71]
ds_read_b64_tr_b16 v[214:215], v250 offset:5568
s_waitcnt lgkmcnt(6)
v_mfma_f32_16x16x32_bf16 v[72:75], v[196:199], v[224:227], v[72:75]
ds_read_b64_tr_b16 v[216:217], v248 offset:1536
v_mfma_f32_16x16x32_bf16 v[76:79], v[196:199], v[228:231], v[76:79]
ds_read_b64_tr_b16 v[218:219], v248 offset:5632
v_mfma_f32_16x16x32_bf16 v[80:83], v[200:203], v[224:227], v[80:83]
ds_read_b64_tr_b16 v[192:193], v250 offset:1536
v_mfma_f32_16x16x32_bf16 v[84:87], v[200:203], v[228:231], v[84:87]
ds_read_b64_tr_b16 v[194:195], v250 offset:5632
s_waitcnt lgkmcnt(6)
v_mfma_f32_16x16x32_bf16 v[88:91], v[204:207], v[224:227], v[88:91]
s_barrier
ds_read_b128 v[232:235], v247 offset:0
ds_read_b128 v[236:239], v247 offset:2048
v_mfma_f32_16x16x32_bf16 v[92:95], v[204:207], v[228:231], v[92:95]
ds_read_b64_tr_b16 v[196:197], v240 offset:16384
ds_read_b64_tr_b16 v[198:199], v240 offset:20480
v_mfma_f32_16x16x32_bf16 v[96:99], v[208:211], v[224:227], v[96:99]
ds_read_b64_tr_b16 v[200:201], v240 offset:16392
v_mfma_f32_16x16x32_bf16 v[100:103], v[208:211], v[228:231], v[100:103]
ds_read_b64_tr_b16 v[202:203], v240 offset:20488
s_waitcnt lgkmcnt(8)
v_mfma_f32_16x16x32_bf16 v[104:107], v[212:215], v[224:227], v[104:107]
ds_read_b64_tr_b16 v[204:205], v240 offset:16400
v_mfma_f32_16x16x32_bf16 v[108:111], v[212:215], v[228:231], v[108:111]
ds_read_b64_tr_b16 v[206:207], v240 offset:20496
v_mfma_f32_16x16x32_bf16 v[112:115], v[216:219], v[224:227], v[112:115]
ds_read_b64_tr_b16 v[208:209], v240 offset:16408
v_mfma_f32_16x16x32_bf16 v[116:119], v[216:219], v[228:231], v[116:119]
ds_read_b64_tr_b16 v[210:211], v240 offset:20504
s_waitcnt lgkmcnt(6)
v_mfma_f32_16x16x32_bf16 v[120:123], v[192:195], v[224:227], v[120:123]
ds_read_b64_tr_b16 v[212:213], v240 offset:16416
v_mfma_f32_16x16x32_bf16 v[124:127], v[192:195], v[228:231], v[124:127]
ds_read_b64_tr_b16 v[214:215], v240 offset:20512
v_mfma_f32_16x16x32_bf16 v[8:11], v[196:199], v[232:235], v[8:11]
ds_read_b64_tr_b16 v[216:217], v248 offset:17664
v_mfma_f32_16x16x32_bf16 v[12:15], v[196:199], v[236:239], v[12:15]
ds_read_b64_tr_b16 v[218:219], v248 offset:21760
s_waitcnt lgkmcnt(6)
v_mfma_f32_16x16x32_bf16 v[16:19], v[200:203], v[232:235], v[16:19]
ds_read_b64_tr_b16 v[192:193], v250 offset:17664
v_mfma_f32_16x16x32_bf16 v[20:23], v[200:203], v[236:239], v[20:23]
ds_read_b64_tr_b16 v[194:195], v250 offset:21760
v_mfma_f32_16x16x32_bf16 v[24:27], v[204:207], v[232:235], v[24:27]
ds_read_b64_tr_b16 v[196:197], v248 offset:17728
v_mfma_f32_16x16x32_bf16 v[28:31], v[204:207], v[236:239], v[28:31]
ds_read_b64_tr_b16 v[198:199], v248 offset:21824
s_waitcnt lgkmcnt(6)
v_mfma_f32_16x16x32_bf16 v[32:35], v[208:211], v[232:235], v[32:35]
ds_read_b64_tr_b16 v[200:201], v250 offset:17728
v_mfma_f32_16x16x32_bf16 v[36:39], v[208:211], v[236:239], v[36:39]
ds_read_b64_tr_b16 v[202:203], v250 offset:21824
v_mfma_f32_16x16x32_bf16 v[40:43], v[212:215], v[232:235], v[40:43]
ds_read_b64_tr_b16 v[204:205], v248 offset:17792
v_mfma_f32_16x16x32_bf16 v[44:47], v[212:215], v[236:239], v[44:47]
ds_read_b64_tr_b16 v[206:207], v248 offset:21888
s_waitcnt lgkmcnt(6)
v_mfma_f32_16x16x32_bf16 v[48:51], v[216:219], v[232:235], v[48:51]
ds_read_b64_tr_b16 v[208:209], v250 offset:17792
v_mfma_f32_16x16x32_bf16 v[52:55], v[216:219], v[236:239], v[52:55]
ds_read_b64_tr_b16 v[210:211], v250 offset:21888
v_mfma_f32_16x16x32_bf16 v[56:59], v[192:195], v[232:235], v[56:59]
ds_read_b64_tr_b16 v[212:213], v248 offset:17856
v_mfma_f32_16x16x32_bf16 v[60:63], v[192:195], v[236:239], v[60:63]
ds_read_b64_tr_b16 v[214:215], v248 offset:21952
s_waitcnt lgkmcnt(6)
v_mfma_f32_16x16x32_bf16 v[64:67], v[196:199], v[232:235], v[64:67]
ds_read_b64_tr_b16 v[216:217], v250 offset:17856
v_mfma_f32_16x16x32_bf16 v[68:71], v[196:199], v[236:239], v[68:71]
ds_read_b64_tr_b16 v[218:219], v250 offset:21952
v_mfma_f32_16x16x32_bf16 v[72:75], v[200:203], v[232:235], v[72:75]
ds_read_b64_tr_b16 v[192:193], v248 offset:17920
v_mfma_f32_16x16x32_bf16 v[76:79], v[200:203], v[236:239], v[76:79]
ds_read_b64_tr_b16 v[194:195], v248 offset:22016
s_waitcnt lgkmcnt(6)
v_mfma_f32_16x16x32_bf16 v[80:83], v[204:207], v[232:235], v[80:83]
ds_read_b64_tr_b16 v[196:197], v250 offset:17920
v_mfma_f32_16x16x32_bf16 v[84:87], v[204:207], v[236:239], v[84:87]
ds_read_b64_tr_b16 v[198:199], v250 offset:22016
v_mfma_f32_16x16x32_bf16 v[88:91], v[208:211], v[232:235], v[88:91]
s_barrier
ds_read_b128 v[224:227], v246 offset:16384
ds_read_b128 v[228:231], v246 offset:18432
v_mfma_f32_16x16x32_bf16 v[92:95], v[208:211], v[236:239], v[92:95]
ds_read_b64_tr_b16 v[200:201], v240 offset:32768
ds_read_b64_tr_b16 v[202:203], v240 offset:36864
s_waitcnt lgkmcnt(8)
v_mfma_f32_16x16x32_bf16 v[96:99], v[212:215], v[232:235], v[96:99]
ds_read_b64_tr_b16 v[204:205], v240 offset:32776
v_mfma_f32_16x16x32_bf16 v[100:103], v[212:215], v[236:239], v[100:103]
ds_read_b64_tr_b16 v[206:207], v240 offset:36872
v_mfma_f32_16x16x32_bf16 v[104:107], v[216:219], v[232:235], v[104:107]
ds_read_b64_tr_b16 v[208:209], v240 offset:32784
v_mfma_f32_16x16x32_bf16 v[108:111], v[216:219], v[236:239], v[108:111]
ds_read_b64_tr_b16 v[210:211], v240 offset:36880
s_waitcnt lgkmcnt(8)
v_mfma_f32_16x16x32_bf16 v[112:115], v[192:195], v[232:235], v[112:115]
ds_read_b64_tr_b16 v[212:213], v240 offset:32792
v_mfma_f32_16x16x32_bf16 v[116:119], v[192:195], v[236:239], v[116:119]
ds_read_b64_tr_b16 v[214:215], v240 offset:36888
v_mfma_f32_16x16x32_bf16 v[120:123], v[196:199], v[232:235], v[120:123]
ds_read_b64_tr_b16 v[216:217], v240 offset:32800
v_mfma_f32_16x16x32_bf16 v[124:127], v[196:199], v[236:239], v[124:127]
ds_read_b64_tr_b16 v[218:219], v240 offset:36896
s_waitcnt lgkmcnt(6)
v_mfma_f32_16x16x32_bf16 v[8:11], v[200:203], v[224:227], v[8:11]
ds_read_b64_tr_b16 v[192:193], v248 offset:34048
v_mfma_f32_16x16x32_bf16 v[12:15], v[200:203], v[228:231], v[12:15]
ds_read_b64_tr_b16 v[194:195], v248 offset:38144
v_mfma_f32_16x16x32_bf16 v[16:19], v[204:207], v[224:227], v[16:19]
ds_read_b64_tr_b16 v[196:197], v250 offset:34048
v_mfma_f32_16x16x32_bf16 v[20:23], v[204:207], v[228:231], v[20:23]
ds_read_b64_tr_b16 v[198:199], v250 offset:38144
s_waitcnt lgkmcnt(6)
v_mfma_f32_16x16x32_bf16 v[24:27], v[208:211], v[224:227], v[24:27]
ds_read_b64_tr_b16 v[200:201], v248 offset:34112
v_mfma_f32_16x16x32_bf16 v[28:31], v[208:211], v[228:231], v[28:31]
ds_read_b64_tr_b16 v[202:203], v248 offset:38208
v_mfma_f32_16x16x32_bf16 v[32:35], v[212:215], v[224:227], v[32:35]
ds_read_b64_tr_b16 v[204:205], v250 offset:34112
v_mfma_f32_16x16x32_bf16 v[36:39], v[212:215], v[228:231], v[36:39]
ds_read_b64_tr_b16 v[206:207], v250 offset:38208
s_waitcnt lgkmcnt(6)
v_mfma_f32_16x16x32_bf16 v[40:43], v[216:219], v[224:227], v[40:43]
ds_read_b64_tr_b16 v[208:209], v248 offset:34176
v_mfma_f32_16x16x32_bf16 v[44:47], v[216:219], v[228:231], v[44:47]
ds_read_b64_tr_b16 v[210:211], v248 offset:38272
v_mfma_f32_16x16x32_bf16 v[48:51], v[192:195], v[224:227], v[48:51]
ds_read_b64_tr_b16 v[212:213], v250 offset:34176
v_mfma_f32_16x16x32_bf16 v[52:55], v[192:195], v[228:231], v[52:55]
ds_read_b64_tr_b16 v[214:215], v250 offset:38272
s_waitcnt lgkmcnt(6)
v_mfma_f32_16x16x32_bf16 v[56:59], v[196:199], v[224:227], v[56:59]
ds_read_b64_tr_b16 v[216:217], v248 offset:34240
v_mfma_f32_16x16x32_bf16 v[60:63], v[196:199], v[228:231], v[60:63]
ds_read_b64_tr_b16 v[218:219], v248 offset:38336
v_mfma_f32_16x16x32_bf16 v[64:67], v[200:203], v[224:227], v[64:67]
ds_read_b64_tr_b16 v[192:193], v250 offset:34240
v_mfma_f32_16x16x32_bf16 v[68:71], v[200:203], v[228:231], v[68:71]
ds_read_b64_tr_b16 v[194:195], v250 offset:38336
s_waitcnt lgkmcnt(6)
v_mfma_f32_16x16x32_bf16 v[72:75], v[204:207], v[224:227], v[72:75]
ds_read_b64_tr_b16 v[196:197], v248 offset:34304
v_mfma_f32_16x16x32_bf16 v[76:79], v[204:207], v[228:231], v[76:79]
ds_read_b64_tr_b16 v[198:199], v248 offset:38400
v_mfma_f32_16x16x32_bf16 v[80:83], v[208:211], v[224:227], v[80:83]
ds_read_b64_tr_b16 v[200:201], v250 offset:34304
v_mfma_f32_16x16x32_bf16 v[84:87], v[208:211], v[228:231], v[84:87]
ds_read_b64_tr_b16 v[202:203], v250 offset:38400
s_waitcnt lgkmcnt(6)
v_mfma_f32_16x16x32_bf16 v[88:91], v[212:215], v[224:227], v[88:91]
s_barrier
ds_read_b128 v[232:235], v247 offset:16384
ds_read_b128 v[236:239], v247 offset:18432
v_mfma_f32_16x16x32_bf16 v[92:95], v[212:215], v[228:231], v[92:95]
ds_read_b64_tr_b16 v[204:205], v241 offset:0
ds_read_b64_tr_b16 v[206:207], v241 offset:4096
v_mfma_f32_16x16x32_bf16 v[96:99], v[216:219], v[224:227], v[96:99]
ds_read_b64_tr_b16 v[208:209], v241 offset:8
v_mfma_f32_16x16x32_bf16 v[100:103], v[216:219], v[228:231], v[100:103]
ds_read_b64_tr_b16 v[210:211], v241 offset:4104
s_waitcnt lgkmcnt(8)
v_mfma_f32_16x16x32_bf16 v[104:107], v[192:195], v[224:227], v[104:107]
ds_read_b64_tr_b16 v[212:213], v241 offset:16
v_mfma_f32_16x16x32_bf16 v[108:111], v[192:195], v[228:231], v[108:111]
ds_read_b64_tr_b16 v[214:215], v241 offset:4112
v_mfma_f32_16x16x32_bf16 v[112:115], v[196:199], v[224:227], v[112:115]
ds_read_b64_tr_b16 v[216:217], v241 offset:24
v_mfma_f32_16x16x32_bf16 v[116:119], v[196:199], v[228:231], v[116:119]
ds_read_b64_tr_b16 v[218:219], v241 offset:4120
s_waitcnt lgkmcnt(6)
v_mfma_f32_16x16x32_bf16 v[120:123], v[200:203], v[224:227], v[120:123]
ds_read_b64_tr_b16 v[192:193], v241 offset:32
v_mfma_f32_16x16x32_bf16 v[124:127], v[200:203], v[228:231], v[124:127]
ds_read_b64_tr_b16 v[194:195], v241 offset:4128
v_mfma_f32_16x16x32_bf16 v[8:11], v[204:207], v[232:235], v[8:11]
ds_read_b64_tr_b16 v[196:197], v249 offset:1280
v_mfma_f32_16x16x32_bf16 v[12:15], v[204:207], v[236:239], v[12:15]
ds_read_b64_tr_b16 v[198:199], v249 offset:5376
s_waitcnt lgkmcnt(6)
v_mfma_f32_16x16x32_bf16 v[16:19], v[208:211], v[232:235], v[16:19]
ds_read_b64_tr_b16 v[200:201], v251 offset:1280
v_mfma_f32_16x16x32_bf16 v[20:23], v[208:211], v[236:239], v[20:23]
ds_read_b64_tr_b16 v[202:203], v251 offset:5376
v_mfma_f32_16x16x32_bf16 v[24:27], v[212:215], v[232:235], v[24:27]
ds_read_b64_tr_b16 v[204:205], v249 offset:1344
v_mfma_f32_16x16x32_bf16 v[28:31], v[212:215], v[236:239], v[28:31]
ds_read_b64_tr_b16 v[206:207], v249 offset:5440
s_waitcnt lgkmcnt(6)
v_mfma_f32_16x16x32_bf16 v[32:35], v[216:219], v[232:235], v[32:35]
ds_read_b64_tr_b16 v[208:209], v251 offset:1344
v_mfma_f32_16x16x32_bf16 v[36:39], v[216:219], v[236:239], v[36:39]
ds_read_b64_tr_b16 v[210:211], v251 offset:5440
v_mfma_f32_16x16x32_bf16 v[40:43], v[192:195], v[232:235], v[40:43]
ds_read_b64_tr_b16 v[212:213], v249 offset:1408
v_mfma_f32_16x16x32_bf16 v[44:47], v[192:195], v[236:239], v[44:47]
ds_read_b64_tr_b16 v[214:215], v249 offset:5504
s_waitcnt lgkmcnt(6)
v_mfma_f32_16x16x32_bf16 v[48:51], v[196:199], v[232:235], v[48:51]
ds_read_b64_tr_b16 v[216:217], v251 offset:1408
v_mfma_f32_16x16x32_bf16 v[52:55], v[196:199], v[236:239], v[52:55]
ds_read_b64_tr_b16 v[218:219], v251 offset:5504
v_mfma_f32_16x16x32_bf16 v[56:59], v[200:203], v[232:235], v[56:59]
ds_read_b64_tr_b16 v[192:193], v249 offset:1472
v_mfma_f32_16x16x32_bf16 v[60:63], v[200:203], v[236:239], v[60:63]
ds_read_b64_tr_b16 v[194:195], v249 offset:5568
s_waitcnt lgkmcnt(6)
v_mfma_f32_16x16x32_bf16 v[64:67], v[204:207], v[232:235], v[64:67]
ds_read_b64_tr_b16 v[196:197], v251 offset:1472
v_mfma_f32_16x16x32_bf16 v[68:71], v[204:207], v[236:239], v[68:71]
ds_read_b64_tr_b16 v[198:199], v251 offset:5568
v_mfma_f32_16x16x32_bf16 v[72:75], v[208:211], v[232:235], v[72:75]
ds_read_b64_tr_b16 v[200:201], v249 offset:1536
v_mfma_f32_16x16x32_bf16 v[76:79], v[208:211], v[236:239], v[76:79]
ds_read_b64_tr_b16 v[202:203], v249 offset:5632
s_waitcnt lgkmcnt(6)
v_mfma_f32_16x16x32_bf16 v[80:83], v[212:215], v[232:235], v[80:83]
ds_read_b64_tr_b16 v[204:205], v251 offset:1536
v_mfma_f32_16x16x32_bf16 v[84:87], v[212:215], v[236:239], v[84:87]
ds_read_b64_tr_b16 v[206:207], v251 offset:5632
v_mfma_f32_16x16x32_bf16 v[88:91], v[216:219], v[232:235], v[88:91]
s_barrier
ds_read_b128 v[224:227], v246 offset:32768
ds_read_b128 v[228:231], v246 offset:34816
v_mfma_f32_16x16x32_bf16 v[92:95], v[216:219], v[236:239], v[92:95]
ds_read_b64_tr_b16 v[208:209], v241 offset:16384
ds_read_b64_tr_b16 v[210:211], v241 offset:20480
s_waitcnt lgkmcnt(8)
v_mfma_f32_16x16x32_bf16 v[96:99], v[192:195], v[232:235], v[96:99]
ds_read_b64_tr_b16 v[212:213], v241 offset:16392
v_mfma_f32_16x16x32_bf16 v[100:103], v[192:195], v[236:239], v[100:103]
ds_read_b64_tr_b16 v[214:215], v241 offset:20488
v_mfma_f32_16x16x32_bf16 v[104:107], v[196:199], v[232:235], v[104:107]
ds_read_b64_tr_b16 v[216:217], v241 offset:16400
v_mfma_f32_16x16x32_bf16 v[108:111], v[196:199], v[236:239], v[108:111]
ds_read_b64_tr_b16 v[218:219], v241 offset:20496
s_waitcnt lgkmcnt(8)
v_mfma_f32_16x16x32_bf16 v[112:115], v[200:203], v[232:235], v[112:115]
ds_read_b64_tr_b16 v[192:193], v241 offset:16408
v_mfma_f32_16x16x32_bf16 v[116:119], v[200:203], v[236:239], v[116:119]
ds_read_b64_tr_b16 v[194:195], v241 offset:20504
v_mfma_f32_16x16x32_bf16 v[120:123], v[204:207], v[232:235], v[120:123]
ds_read_b64_tr_b16 v[196:197], v241 offset:16416
v_mfma_f32_16x16x32_bf16 v[124:127], v[204:207], v[236:239], v[124:127]
ds_read_b64_tr_b16 v[198:199], v241 offset:20512
s_waitcnt lgkmcnt(6)
v_mfma_f32_16x16x32_bf16 v[8:11], v[208:211], v[224:227], v[8:11]
ds_read_b64_tr_b16 v[200:201], v249 offset:17664
v_mfma_f32_16x16x32_bf16 v[12:15], v[208:211], v[228:231], v[12:15]
ds_read_b64_tr_b16 v[202:203], v249 offset:21760
v_mfma_f32_16x16x32_bf16 v[16:19], v[212:215], v[224:227], v[16:19]
ds_read_b64_tr_b16 v[204:205], v251 offset:17664
v_mfma_f32_16x16x32_bf16 v[20:23], v[212:215], v[228:231], v[20:23]
ds_read_b64_tr_b16 v[206:207], v251 offset:21760
s_waitcnt lgkmcnt(6)
v_mfma_f32_16x16x32_bf16 v[24:27], v[216:219], v[224:227], v[24:27]
ds_read_b64_tr_b16 v[208:209], v249 offset:17728
v_mfma_f32_16x16x32_bf16 v[28:31], v[216:219], v[228:231], v[28:31]
ds_read_b64_tr_b16 v[210:211], v249 offset:21824
v_mfma_f32_16x16x32_bf16 v[32:35], v[192:195], v[224:227], v[32:35]
ds_read_b64_tr_b16 v[212:213], v251 offset:17728
v_mfma_f32_16x16x32_bf16 v[36:39], v[192:195], v[228:231], v[36:39]
ds_read_b64_tr_b16 v[214:215], v251 offset:21824
s_waitcnt lgkmcnt(6)
v_mfma_f32_16x16x32_bf16 v[40:43], v[196:199], v[224:227], v[40:43]
ds_read_b64_tr_b16 v[216:217], v249 offset:17792
v_mfma_f32_16x16x32_bf16 v[44:47], v[196:199], v[228:231], v[44:47]
ds_read_b64_tr_b16 v[218:219], v249 offset:21888
v_mfma_f32_16x16x32_bf16 v[48:51], v[200:203], v[224:227], v[48:51]
ds_read_b64_tr_b16 v[192:193], v251 offset:17792
v_mfma_f32_16x16x32_bf16 v[52:55], v[200:203], v[228:231], v[52:55]
ds_read_b64_tr_b16 v[194:195], v251 offset:21888
s_waitcnt lgkmcnt(6)
v_mfma_f32_16x16x32_bf16 v[56:59], v[204:207], v[224:227], v[56:59]
ds_read_b64_tr_b16 v[196:197], v249 offset:17856
v_mfma_f32_16x16x32_bf16 v[60:63], v[204:207], v[228:231], v[60:63]
ds_read_b64_tr_b16 v[198:199], v249 offset:21952
v_mfma_f32_16x16x32_bf16 v[64:67], v[208:211], v[224:227], v[64:67]
ds_read_b64_tr_b16 v[200:201], v251 offset:17856
v_mfma_f32_16x16x32_bf16 v[68:71], v[208:211], v[228:231], v[68:71]
ds_read_b64_tr_b16 v[202:203], v251 offset:21952
s_waitcnt lgkmcnt(6)
v_mfma_f32_16x16x32_bf16 v[72:75], v[212:215], v[224:227], v[72:75]
ds_read_b64_tr_b16 v[204:205], v249 offset:17920
v_mfma_f32_16x16x32_bf16 v[76:79], v[212:215], v[228:231], v[76:79]
ds_read_b64_tr_b16 v[206:207], v249 offset:22016
v_mfma_f32_16x16x32_bf16 v[80:83], v[216:219], v[224:227], v[80:83]
ds_read_b64_tr_b16 v[208:209], v251 offset:17920
v_mfma_f32_16x16x32_bf16 v[84:87], v[216:219], v[228:231], v[84:87]
ds_read_b64_tr_b16 v[210:211], v251 offset:22016
s_waitcnt lgkmcnt(6)
v_mfma_f32_16x16x32_bf16 v[88:91], v[192:195], v[224:227], v[88:91]
s_barrier
ds_read_b128 v[232:235], v247 offset:32768
ds_read_b128 v[236:239], v247 offset:34816
v_mfma_f32_16x16x32_bf16 v[92:95], v[192:195], v[228:231], v[92:95]
ds_read_b64_tr_b16 v[212:213], v240 offset:0
ds_read_b64_tr_b16 v[214:215], v240 offset:4096
v_mfma_f32_16x16x32_bf16 v[96:99], v[196:199], v[224:227], v[96:99]
ds_read_b64_tr_b16 v[216:217], v240 offset:8
v_mfma_f32_16x16x32_bf16 v[100:103], v[196:199], v[228:231], v[100:103]
ds_read_b64_tr_b16 v[218:219], v240 offset:4104
s_waitcnt lgkmcnt(8)
v_mfma_f32_16x16x32_bf16 v[104:107], v[200:203], v[224:227], v[104:107]
ds_read_b64_tr_b16 v[192:193], v240 offset:16
v_mfma_f32_16x16x32_bf16 v[108:111], v[200:203], v[228:231], v[108:111]
ds_read_b64_tr_b16 v[194:195], v240 offset:4112
v_mfma_f32_16x16x32_bf16 v[112:115], v[204:207], v[224:227], v[112:115]
ds_read_b64_tr_b16 v[196:197], v240 offset:24
v_mfma_f32_16x16x32_bf16 v[116:119], v[204:207], v[228:231], v[116:119]
ds_read_b64_tr_b16 v[198:199], v240 offset:4120
s_waitcnt lgkmcnt(6)
v_mfma_f32_16x16x32_bf16 v[120:123], v[208:211], v[224:227], v[120:123]
ds_read_b64_tr_b16 v[200:201], v240 offset:32
v_mfma_f32_16x16x32_bf16 v[124:127], v[208:211], v[228:231], v[124:127]
ds_read_b64_tr_b16 v[202:203], v240 offset:4128
v_mfma_f32_16x16x32_bf16 v[8:11], v[212:215], v[232:235], v[8:11]
ds_read_b64_tr_b16 v[204:205], v248 offset:1280
v_mfma_f32_16x16x32_bf16 v[12:15], v[212:215], v[236:239], v[12:15]
ds_read_b64_tr_b16 v[206:207], v248 offset:5376
s_waitcnt lgkmcnt(6)
v_mfma_f32_16x16x32_bf16 v[16:19], v[216:219], v[232:235], v[16:19]
ds_read_b64_tr_b16 v[208:209], v250 offset:1280
v_mfma_f32_16x16x32_bf16 v[20:23], v[216:219], v[236:239], v[20:23]
ds_read_b64_tr_b16 v[210:211], v250 offset:5376
v_mfma_f32_16x16x32_bf16 v[24:27], v[192:195], v[232:235], v[24:27]
ds_read_b64_tr_b16 v[212:213], v248 offset:1344
v_mfma_f32_16x16x32_bf16 v[28:31], v[192:195], v[236:239], v[28:31]
ds_read_b64_tr_b16 v[214:215], v248 offset:5440
s_waitcnt lgkmcnt(6)
v_mfma_f32_16x16x32_bf16 v[32:35], v[196:199], v[232:235], v[32:35]
ds_read_b64_tr_b16 v[216:217], v250 offset:1344
v_mfma_f32_16x16x32_bf16 v[36:39], v[196:199], v[236:239], v[36:39]
ds_read_b64_tr_b16 v[218:219], v250 offset:5440
v_mfma_f32_16x16x32_bf16 v[40:43], v[200:203], v[232:235], v[40:43]
ds_read_b64_tr_b16 v[192:193], v248 offset:1408
v_mfma_f32_16x16x32_bf16 v[44:47], v[200:203], v[236:239], v[44:47]
ds_read_b64_tr_b16 v[194:195], v248 offset:5504
s_waitcnt lgkmcnt(6)
v_mfma_f32_16x16x32_bf16 v[48:51], v[204:207], v[232:235], v[48:51]
ds_read_b64_tr_b16 v[196:197], v250 offset:1408
v_mfma_f32_16x16x32_bf16 v[52:55], v[204:207], v[236:239], v[52:55]
ds_read_b64_tr_b16 v[198:199], v250 offset:5504
v_mfma_f32_16x16x32_bf16 v[56:59], v[208:211], v[232:235], v[56:59]
ds_read_b64_tr_b16 v[200:201], v248 offset:1472
v_mfma_f32_16x16x32_bf16 v[60:63], v[208:211], v[236:239], v[60:63]
ds_read_b64_tr_b16 v[202:203], v248 offset:5568
s_waitcnt lgkmcnt(6)
v_mfma_f32_16x16x32_bf16 v[64:67], v[212:215], v[232:235], v[64:67]
ds_read_b64_tr_b16 v[204:205], v250 offset:1472
v_mfma_f32_16x16x32_bf16 v[68:71], v[212:215], v[236:239], v[68:71]
ds_read_b64_tr_b16 v[206:207], v250 offset:5568
v_mfma_f32_16x16x32_bf16 v[72:75], v[216:219], v[232:235], v[72:75]
ds_read_b64_tr_b16 v[208:209], v248 offset:1536
v_mfma_f32_16x16x32_bf16 v[76:79], v[216:219], v[236:239], v[76:79]
ds_read_b64_tr_b16 v[210:211], v248 offset:5632
s_waitcnt lgkmcnt(6)
v_mfma_f32_16x16x32_bf16 v[80:83], v[192:195], v[232:235], v[80:83]
ds_read_b64_tr_b16 v[212:213], v250 offset:1536
v_mfma_f32_16x16x32_bf16 v[84:87], v[192:195], v[236:239], v[84:87]
ds_read_b64_tr_b16 v[214:215], v250 offset:5632
v_mfma_f32_16x16x32_bf16 v[88:91], v[196:199], v[232:235], v[88:91]
s_barrier
ds_read_b128 v[224:227], v246 offset:0
ds_read_b128 v[228:231], v246 offset:2048
v_mfma_f32_16x16x32_bf16 v[92:95], v[196:199], v[236:239], v[92:95]
ds_read_b64_tr_b16 v[216:217], v240 offset:16384
ds_read_b64_tr_b16 v[218:219], v240 offset:20480
s_waitcnt lgkmcnt(8)
v_mfma_f32_16x16x32_bf16 v[96:99], v[200:203], v[232:235], v[96:99]
ds_read_b64_tr_b16 v[192:193], v240 offset:16392
v_mfma_f32_16x16x32_bf16 v[100:103], v[200:203], v[236:239], v[100:103]
ds_read_b64_tr_b16 v[194:195], v240 offset:20488
v_mfma_f32_16x16x32_bf16 v[104:107], v[204:207], v[232:235], v[104:107]
ds_read_b64_tr_b16 v[196:197], v240 offset:16400
v_mfma_f32_16x16x32_bf16 v[108:111], v[204:207], v[236:239], v[108:111]
ds_read_b64_tr_b16 v[198:199], v240 offset:20496
s_waitcnt lgkmcnt(8)
v_mfma_f32_16x16x32_bf16 v[112:115], v[208:211], v[232:235], v[112:115]
ds_read_b64_tr_b16 v[200:201], v240 offset:16408
v_mfma_f32_16x16x32_bf16 v[116:119], v[208:211], v[236:239], v[116:119]
ds_read_b64_tr_b16 v[202:203], v240 offset:20504
v_mfma_f32_16x16x32_bf16 v[120:123], v[212:215], v[232:235], v[120:123]
ds_read_b64_tr_b16 v[204:205], v240 offset:16416
v_mfma_f32_16x16x32_bf16 v[124:127], v[212:215], v[236:239], v[124:127]
ds_read_b64_tr_b16 v[206:207], v240 offset:20512
s_waitcnt lgkmcnt(6)
v_mfma_f32_16x16x32_bf16 v[8:11], v[216:219], v[224:227], v[8:11]
ds_read_b64_tr_b16 v[208:209], v248 offset:17664
v_mfma_f32_16x16x32_bf16 v[12:15], v[216:219], v[228:231], v[12:15]
ds_read_b64_tr_b16 v[210:211], v248 offset:21760
v_mfma_f32_16x16x32_bf16 v[16:19], v[192:195], v[224:227], v[16:19]
ds_read_b64_tr_b16 v[212:213], v250 offset:17664
v_mfma_f32_16x16x32_bf16 v[20:23], v[192:195], v[228:231], v[20:23]
ds_read_b64_tr_b16 v[214:215], v250 offset:21760
s_waitcnt lgkmcnt(6)
v_mfma_f32_16x16x32_bf16 v[24:27], v[196:199], v[224:227], v[24:27]
ds_read_b64_tr_b16 v[216:217], v248 offset:17728
v_mfma_f32_16x16x32_bf16 v[28:31], v[196:199], v[228:231], v[28:31]
ds_read_b64_tr_b16 v[218:219], v248 offset:21824
v_mfma_f32_16x16x32_bf16 v[32:35], v[200:203], v[224:227], v[32:35]
ds_read_b64_tr_b16 v[192:193], v250 offset:17728
v_mfma_f32_16x16x32_bf16 v[36:39], v[200:203], v[228:231], v[36:39]
ds_read_b64_tr_b16 v[194:195], v250 offset:21824
s_waitcnt lgkmcnt(6)
v_mfma_f32_16x16x32_bf16 v[40:43], v[204:207], v[224:227], v[40:43]
ds_read_b64_tr_b16 v[196:197], v248 offset:17792
v_mfma_f32_16x16x32_bf16 v[44:47], v[204:207], v[228:231], v[44:47]
ds_read_b64_tr_b16 v[198:199], v248 offset:21888
v_mfma_f32_16x16x32_bf16 v[48:51], v[208:211], v[224:227], v[48:51]
ds_read_b64_tr_b16 v[200:201], v250 offset:17792
v_mfma_f32_16x16x32_bf16 v[52:55], v[208:211], v[228:231], v[52:55]
ds_read_b64_tr_b16 v[202:203], v250 offset:21888
s_waitcnt lgkmcnt(6)
v_mfma_f32_16x16x32_bf16 v[56:59], v[212:215], v[224:227], v[56:59]
ds_read_b64_tr_b16 v[204:205], v248 offset:17856
v_mfma_f32_16x16x32_bf16 v[60:63], v[212:215], v[228:231], v[60:63]
ds_read_b64_tr_b16 v[206:207], v248 offset:21952
v_mfma_f32_16x16x32_bf16 v[64:67], v[216:219], v[224:227], v[64:67]
ds_read_b64_tr_b16 v[208:209], v250 offset:17856
v_mfma_f32_16x16x32_bf16 v[68:71], v[216:219], v[228:231], v[68:71]
ds_read_b64_tr_b16 v[210:211], v250 offset:21952
s_waitcnt lgkmcnt(6)
v_mfma_f32_16x16x32_bf16 v[72:75], v[192:195], v[224:227], v[72:75]
ds_read_b64_tr_b16 v[212:213], v248 offset:17920
v_mfma_f32_16x16x32_bf16 v[76:79], v[192:195], v[228:231], v[76:79]
ds_read_b64_tr_b16 v[214:215], v248 offset:22016
v_mfma_f32_16x16x32_bf16 v[80:83], v[196:199], v[224:227], v[80:83]
ds_read_b64_tr_b16 v[216:217], v250 offset:17920
v_mfma_f32_16x16x32_bf16 v[84:87], v[196:199], v[228:231], v[84:87]
ds_read_b64_tr_b16 v[218:219], v250 offset:22016
s_waitcnt lgkmcnt(6)
v_mfma_f32_16x16x32_bf16 v[88:91], v[200:203], v[224:227], v[88:91]
s_barrier
ds_read_b128 v[232:235], v247 offset:0
ds_read_b128 v[236:239], v247 offset:2048
v_mfma_f32_16x16x32_bf16 v[92:95], v[200:203], v[228:231], v[92:95]
ds_read_b64_tr_b16 v[192:193], v240 offset:32768
ds_read_b64_tr_b16 v[194:195], v240 offset:36864
v_mfma_f32_16x16x32_bf16 v[96:99], v[204:207], v[224:227], v[96:99]
ds_read_b64_tr_b16 v[196:197], v240 offset:32776
v_mfma_f32_16x16x32_bf16 v[100:103], v[204:207], v[228:231], v[100:103]
ds_read_b64_tr_b16 v[198:199], v240 offset:36872
s_waitcnt lgkmcnt(8)
v_mfma_f32_16x16x32_bf16 v[104:107], v[208:211], v[224:227], v[104:107]
ds_read_b64_tr_b16 v[200:201], v240 offset:32784
v_mfma_f32_16x16x32_bf16 v[108:111], v[208:211], v[228:231], v[108:111]
ds_read_b64_tr_b16 v[202:203], v240 offset:36880
v_mfma_f32_16x16x32_bf16 v[112:115], v[212:215], v[224:227], v[112:115]
ds_read_b64_tr_b16 v[204:205], v240 offset:32792
v_mfma_f32_16x16x32_bf16 v[116:119], v[212:215], v[228:231], v[116:119]
ds_read_b64_tr_b16 v[206:207], v240 offset:36888
s_waitcnt lgkmcnt(6)
v_mfma_f32_16x16x32_bf16 v[120:123], v[216:219], v[224:227], v[120:123]
ds_read_b64_tr_b16 v[208:209], v240 offset:32800
v_mfma_f32_16x16x32_bf16 v[124:127], v[216:219], v[228:231], v[124:127]
ds_read_b64_tr_b16 v[210:211], v240 offset:36896
v_mfma_f32_16x16x32_bf16 v[8:11], v[192:195], v[232:235], v[8:11]
ds_read_b64_tr_b16 v[212:213], v248 offset:34048
v_mfma_f32_16x16x32_bf16 v[12:15], v[192:195], v[236:239], v[12:15]
ds_read_b64_tr_b16 v[214:215], v248 offset:38144
s_waitcnt lgkmcnt(6)
v_mfma_f32_16x16x32_bf16 v[16:19], v[196:199], v[232:235], v[16:19]
ds_read_b64_tr_b16 v[216:217], v250 offset:34048
v_mfma_f32_16x16x32_bf16 v[20:23], v[196:199], v[236:239], v[20:23]
ds_read_b64_tr_b16 v[218:219], v250 offset:38144
v_mfma_f32_16x16x32_bf16 v[24:27], v[200:203], v[232:235], v[24:27]
ds_read_b64_tr_b16 v[192:193], v248 offset:34112
v_mfma_f32_16x16x32_bf16 v[28:31], v[200:203], v[236:239], v[28:31]
ds_read_b64_tr_b16 v[194:195], v248 offset:38208
s_waitcnt lgkmcnt(6)
v_mfma_f32_16x16x32_bf16 v[32:35], v[204:207], v[232:235], v[32:35]
ds_read_b64_tr_b16 v[196:197], v250 offset:34112
v_mfma_f32_16x16x32_bf16 v[36:39], v[204:207], v[236:239], v[36:39]
ds_read_b64_tr_b16 v[198:199], v250 offset:38208
v_mfma_f32_16x16x32_bf16 v[40:43], v[208:211], v[232:235], v[40:43]
ds_read_b64_tr_b16 v[200:201], v248 offset:34176
v_mfma_f32_16x16x32_bf16 v[44:47], v[208:211], v[236:239], v[44:47]
ds_read_b64_tr_b16 v[202:203], v248 offset:38272
s_waitcnt lgkmcnt(6)
v_mfma_f32_16x16x32_bf16 v[48:51], v[212:215], v[232:235], v[48:51]
ds_read_b64_tr_b16 v[204:205], v250 offset:34176
v_mfma_f32_16x16x32_bf16 v[52:55], v[212:215], v[236:239], v[52:55]
ds_read_b64_tr_b16 v[206:207], v250 offset:38272
v_mfma_f32_16x16x32_bf16 v[56:59], v[216:219], v[232:235], v[56:59]
ds_read_b64_tr_b16 v[208:209], v248 offset:34240
v_mfma_f32_16x16x32_bf16 v[60:63], v[216:219], v[236:239], v[60:63]
ds_read_b64_tr_b16 v[210:211], v248 offset:38336
s_waitcnt lgkmcnt(6)
v_mfma_f32_16x16x32_bf16 v[64:67], v[192:195], v[232:235], v[64:67]
ds_read_b64_tr_b16 v[212:213], v250 offset:34240
v_mfma_f32_16x16x32_bf16 v[68:71], v[192:195], v[236:239], v[68:71]
ds_read_b64_tr_b16 v[214:215], v250 offset:38336
v_mfma_f32_16x16x32_bf16 v[72:75], v[196:199], v[232:235], v[72:75]
ds_read_b64_tr_b16 v[216:217], v248 offset:34304
v_mfma_f32_16x16x32_bf16 v[76:79], v[196:199], v[236:239], v[76:79]
ds_read_b64_tr_b16 v[218:219], v248 offset:38400
s_waitcnt lgkmcnt(6)
v_mfma_f32_16x16x32_bf16 v[80:83], v[200:203], v[232:235], v[80:83]
ds_read_b64_tr_b16 v[192:193], v250 offset:34304
v_mfma_f32_16x16x32_bf16 v[84:87], v[200:203], v[236:239], v[84:87]
ds_read_b64_tr_b16 v[194:195], v250 offset:38400
v_mfma_f32_16x16x32_bf16 v[88:91], v[204:207], v[232:235], v[88:91]
s_barrier
ds_read_b128 v[224:227], v246 offset:16384
ds_read_b128 v[228:231], v246 offset:18432
v_mfma_f32_16x16x32_bf16 v[92:95], v[204:207], v[236:239], v[92:95]
ds_read_b64_tr_b16 v[196:197], v241 offset:0
ds_read_b64_tr_b16 v[198:199], v241 offset:4096
s_waitcnt lgkmcnt(8)
v_mfma_f32_16x16x32_bf16 v[96:99], v[208:211], v[232:235], v[96:99]
ds_read_b64_tr_b16 v[200:201], v241 offset:8
v_mfma_f32_16x16x32_bf16 v[100:103], v[208:211], v[236:239], v[100:103]
ds_read_b64_tr_b16 v[202:203], v241 offset:4104
v_mfma_f32_16x16x32_bf16 v[104:107], v[212:215], v[232:235], v[104:107]
ds_read_b64_tr_b16 v[204:205], v241 offset:16
v_mfma_f32_16x16x32_bf16 v[108:111], v[212:215], v[236:239], v[108:111]
ds_read_b64_tr_b16 v[206:207], v241 offset:4112
s_waitcnt lgkmcnt(8)
v_mfma_f32_16x16x32_bf16 v[112:115], v[216:219], v[232:235], v[112:115]
ds_read_b64_tr_b16 v[208:209], v241 offset:24
v_mfma_f32_16x16x32_bf16 v[116:119], v[216:219], v[236:239], v[116:119]
ds_read_b64_tr_b16 v[210:211], v241 offset:4120
v_mfma_f32_16x16x32_bf16 v[120:123], v[192:195], v[232:235], v[120:123]
ds_read_b64_tr_b16 v[212:213], v241 offset:32
v_mfma_f32_16x16x32_bf16 v[124:127], v[192:195], v[236:239], v[124:127]
ds_read_b64_tr_b16 v[214:215], v241 offset:4128
s_waitcnt lgkmcnt(6)
v_mfma_f32_16x16x32_bf16 v[8:11], v[196:199], v[224:227], v[8:11]
ds_read_b64_tr_b16 v[216:217], v249 offset:1280
v_mfma_f32_16x16x32_bf16 v[12:15], v[196:199], v[228:231], v[12:15]
ds_read_b64_tr_b16 v[218:219], v249 offset:5376
v_mfma_f32_16x16x32_bf16 v[16:19], v[200:203], v[224:227], v[16:19]
ds_read_b64_tr_b16 v[192:193], v251 offset:1280
v_mfma_f32_16x16x32_bf16 v[20:23], v[200:203], v[228:231], v[20:23]
ds_read_b64_tr_b16 v[194:195], v251 offset:5376
s_waitcnt lgkmcnt(6)
v_mfma_f32_16x16x32_bf16 v[24:27], v[204:207], v[224:227], v[24:27]
ds_read_b64_tr_b16 v[196:197], v249 offset:1344
v_mfma_f32_16x16x32_bf16 v[28:31], v[204:207], v[228:231], v[28:31]
ds_read_b64_tr_b16 v[198:199], v249 offset:5440
v_mfma_f32_16x16x32_bf16 v[32:35], v[208:211], v[224:227], v[32:35]
ds_read_b64_tr_b16 v[200:201], v251 offset:1344
v_mfma_f32_16x16x32_bf16 v[36:39], v[208:211], v[228:231], v[36:39]
ds_read_b64_tr_b16 v[202:203], v251 offset:5440
s_waitcnt lgkmcnt(6)
v_mfma_f32_16x16x32_bf16 v[40:43], v[212:215], v[224:227], v[40:43]
ds_read_b64_tr_b16 v[204:205], v249 offset:1408
v_mfma_f32_16x16x32_bf16 v[44:47], v[212:215], v[228:231], v[44:47]
ds_read_b64_tr_b16 v[206:207], v249 offset:5504
v_mfma_f32_16x16x32_bf16 v[48:51], v[216:219], v[224:227], v[48:51]
ds_read_b64_tr_b16 v[208:209], v251 offset:1408
v_mfma_f32_16x16x32_bf16 v[52:55], v[216:219], v[228:231], v[52:55]
ds_read_b64_tr_b16 v[210:211], v251 offset:5504
s_waitcnt lgkmcnt(6)
v_mfma_f32_16x16x32_bf16 v[56:59], v[192:195], v[224:227], v[56:59]
ds_read_b64_tr_b16 v[212:213], v249 offset:1472
v_mfma_f32_16x16x32_bf16 v[60:63], v[192:195], v[228:231], v[60:63]
ds_read_b64_tr_b16 v[214:215], v249 offset:5568
v_mfma_f32_16x16x32_bf16 v[64:67], v[196:199], v[224:227], v[64:67]
ds_read_b64_tr_b16 v[216:217], v251 offset:1472
v_mfma_f32_16x16x32_bf16 v[68:71], v[196:199], v[228:231], v[68:71]
ds_read_b64_tr_b16 v[218:219], v251 offset:5568
s_waitcnt lgkmcnt(6)
v_mfma_f32_16x16x32_bf16 v[72:75], v[200:203], v[224:227], v[72:75]
ds_read_b64_tr_b16 v[192:193], v249 offset:1536
v_mfma_f32_16x16x32_bf16 v[76:79], v[200:203], v[228:231], v[76:79]
ds_read_b64_tr_b16 v[194:195], v249 offset:5632
v_mfma_f32_16x16x32_bf16 v[80:83], v[204:207], v[224:227], v[80:83]
ds_read_b64_tr_b16 v[196:197], v251 offset:1536
v_mfma_f32_16x16x32_bf16 v[84:87], v[204:207], v[228:231], v[84:87]
ds_read_b64_tr_b16 v[198:199], v251 offset:5632
s_waitcnt lgkmcnt(6)
v_mfma_f32_16x16x32_bf16 v[88:91], v[208:211], v[224:227], v[88:91]
s_barrier
ds_read_b128 v[232:235], v247 offset:16384
ds_read_b128 v[236:239], v247 offset:18432
v_mfma_f32_16x16x32_bf16 v[92:95], v[208:211], v[228:231], v[92:95]
ds_read_b64_tr_b16 v[200:201], v241 offset:16384
ds_read_b64_tr_b16 v[202:203], v241 offset:20480
v_mfma_f32_16x16x32_bf16 v[96:99], v[212:215], v[224:227], v[96:99]
ds_read_b64_tr_b16 v[204:205], v241 offset:16392
v_mfma_f32_16x16x32_bf16 v[100:103], v[212:215], v[228:231], v[100:103]
ds_read_b64_tr_b16 v[206:207], v241 offset:20488
s_waitcnt lgkmcnt(8)
v_mfma_f32_16x16x32_bf16 v[104:107], v[216:219], v[224:227], v[104:107]
ds_read_b64_tr_b16 v[208:209], v241 offset:16400
v_mfma_f32_16x16x32_bf16 v[108:111], v[216:219], v[228:231], v[108:111]
ds_read_b64_tr_b16 v[210:211], v241 offset:20496
v_mfma_f32_16x16x32_bf16 v[112:115], v[192:195], v[224:227], v[112:115]
ds_read_b64_tr_b16 v[212:213], v241 offset:16408
v_mfma_f32_16x16x32_bf16 v[116:119], v[192:195], v[228:231], v[116:119]
ds_read_b64_tr_b16 v[214:215], v241 offset:20504
s_waitcnt lgkmcnt(6)
v_mfma_f32_16x16x32_bf16 v[120:123], v[196:199], v[224:227], v[120:123]
ds_read_b64_tr_b16 v[216:217], v241 offset:16416
v_mfma_f32_16x16x32_bf16 v[124:127], v[196:199], v[228:231], v[124:127]
ds_read_b64_tr_b16 v[218:219], v241 offset:20512
v_mfma_f32_16x16x32_bf16 v[8:11], v[200:203], v[232:235], v[8:11]
ds_read_b64_tr_b16 v[192:193], v249 offset:17664
v_mfma_f32_16x16x32_bf16 v[12:15], v[200:203], v[236:239], v[12:15]
ds_read_b64_tr_b16 v[194:195], v249 offset:21760
s_waitcnt lgkmcnt(6)
v_mfma_f32_16x16x32_bf16 v[16:19], v[204:207], v[232:235], v[16:19]
ds_read_b64_tr_b16 v[196:197], v251 offset:17664
v_mfma_f32_16x16x32_bf16 v[20:23], v[204:207], v[236:239], v[20:23]
ds_read_b64_tr_b16 v[198:199], v251 offset:21760
v_mfma_f32_16x16x32_bf16 v[24:27], v[208:211], v[232:235], v[24:27]
ds_read_b64_tr_b16 v[200:201], v249 offset:17728
v_mfma_f32_16x16x32_bf16 v[28:31], v[208:211], v[236:239], v[28:31]
ds_read_b64_tr_b16 v[202:203], v249 offset:21824
s_waitcnt lgkmcnt(6)
v_mfma_f32_16x16x32_bf16 v[32:35], v[212:215], v[232:235], v[32:35]
ds_read_b64_tr_b16 v[204:205], v251 offset:17728
v_mfma_f32_16x16x32_bf16 v[36:39], v[212:215], v[236:239], v[36:39]
ds_read_b64_tr_b16 v[206:207], v251 offset:21824
v_mfma_f32_16x16x32_bf16 v[40:43], v[216:219], v[232:235], v[40:43]
ds_read_b64_tr_b16 v[208:209], v249 offset:17792
v_mfma_f32_16x16x32_bf16 v[44:47], v[216:219], v[236:239], v[44:47]
ds_read_b64_tr_b16 v[210:211], v249 offset:21888
s_waitcnt lgkmcnt(6)
v_mfma_f32_16x16x32_bf16 v[48:51], v[192:195], v[232:235], v[48:51]
ds_read_b64_tr_b16 v[212:213], v251 offset:17792
v_mfma_f32_16x16x32_bf16 v[52:55], v[192:195], v[236:239], v[52:55]
ds_read_b64_tr_b16 v[214:215], v251 offset:21888
v_mfma_f32_16x16x32_bf16 v[56:59], v[196:199], v[232:235], v[56:59]
ds_read_b64_tr_b16 v[216:217], v249 offset:17856
v_mfma_f32_16x16x32_bf16 v[60:63], v[196:199], v[236:239], v[60:63]
ds_read_b64_tr_b16 v[218:219], v249 offset:21952
s_waitcnt lgkmcnt(6)
v_mfma_f32_16x16x32_bf16 v[64:67], v[200:203], v[232:235], v[64:67]
ds_read_b64_tr_b16 v[192:193], v251 offset:17856
v_mfma_f32_16x16x32_bf16 v[68:71], v[200:203], v[236:239], v[68:71]
ds_read_b64_tr_b16 v[194:195], v251 offset:21952
v_mfma_f32_16x16x32_bf16 v[72:75], v[204:207], v[232:235], v[72:75]
ds_read_b64_tr_b16 v[196:197], v249 offset:17920
v_mfma_f32_16x16x32_bf16 v[76:79], v[204:207], v[236:239], v[76:79]
ds_read_b64_tr_b16 v[198:199], v249 offset:22016
s_waitcnt lgkmcnt(6)
v_mfma_f32_16x16x32_bf16 v[80:83], v[208:211], v[232:235], v[80:83]
ds_read_b64_tr_b16 v[200:201], v251 offset:17920
v_mfma_f32_16x16x32_bf16 v[84:87], v[208:211], v[236:239], v[84:87]
ds_read_b64_tr_b16 v[202:203], v251 offset:22016
v_mfma_f32_16x16x32_bf16 v[88:91], v[212:215], v[232:235], v[88:91]
s_barrier
ds_read_b128 v[224:227], v246 offset:32768
ds_read_b128 v[228:231], v246 offset:34816
v_mfma_f32_16x16x32_bf16 v[92:95], v[212:215], v[236:239], v[92:95]
ds_read_b64_tr_b16 v[204:205], v240 offset:0
ds_read_b64_tr_b16 v[206:207], v240 offset:4096
s_waitcnt lgkmcnt(8)
v_mfma_f32_16x16x32_bf16 v[96:99], v[216:219], v[232:235], v[96:99]
ds_read_b64_tr_b16 v[208:209], v240 offset:8
v_mfma_f32_16x16x32_bf16 v[100:103], v[216:219], v[236:239], v[100:103]
ds_read_b64_tr_b16 v[210:211], v240 offset:4104
v_mfma_f32_16x16x32_bf16 v[104:107], v[192:195], v[232:235], v[104:107]
ds_read_b64_tr_b16 v[212:213], v240 offset:16
v_mfma_f32_16x16x32_bf16 v[108:111], v[192:195], v[236:239], v[108:111]
ds_read_b64_tr_b16 v[214:215], v240 offset:4112
s_waitcnt lgkmcnt(8)
v_mfma_f32_16x16x32_bf16 v[112:115], v[196:199], v[232:235], v[112:115]
ds_read_b64_tr_b16 v[216:217], v240 offset:24
v_mfma_f32_16x16x32_bf16 v[116:119], v[196:199], v[236:239], v[116:119]
ds_read_b64_tr_b16 v[218:219], v240 offset:4120
v_mfma_f32_16x16x32_bf16 v[120:123], v[200:203], v[232:235], v[120:123]
ds_read_b64_tr_b16 v[192:193], v240 offset:32
v_mfma_f32_16x16x32_bf16 v[124:127], v[200:203], v[236:239], v[124:127]
ds_read_b64_tr_b16 v[194:195], v240 offset:4128
s_waitcnt lgkmcnt(6)
v_mfma_f32_16x16x32_bf16 v[8:11], v[204:207], v[224:227], v[8:11]
ds_read_b64_tr_b16 v[196:197], v248 offset:1280
v_mfma_f32_16x16x32_bf16 v[12:15], v[204:207], v[228:231], v[12:15]
ds_read_b64_tr_b16 v[198:199], v248 offset:5376
v_mfma_f32_16x16x32_bf16 v[16:19], v[208:211], v[224:227], v[16:19]
ds_read_b64_tr_b16 v[200:201], v250 offset:1280
v_mfma_f32_16x16x32_bf16 v[20:23], v[208:211], v[228:231], v[20:23]
ds_read_b64_tr_b16 v[202:203], v250 offset:5376
s_waitcnt lgkmcnt(6)
v_mfma_f32_16x16x32_bf16 v[24:27], v[212:215], v[224:227], v[24:27]
ds_read_b64_tr_b16 v[204:205], v248 offset:1344
v_mfma_f32_16x16x32_bf16 v[28:31], v[212:215], v[228:231], v[28:31]
ds_read_b64_tr_b16 v[206:207], v248 offset:5440
v_mfma_f32_16x16x32_bf16 v[32:35], v[216:219], v[224:227], v[32:35]
ds_read_b64_tr_b16 v[208:209], v250 offset:1344
v_mfma_f32_16x16x32_bf16 v[36:39], v[216:219], v[228:231], v[36:39]
ds_read_b64_tr_b16 v[210:211], v250 offset:5440
s_waitcnt lgkmcnt(6)
v_mfma_f32_16x16x32_bf16 v[40:43], v[192:195], v[224:227], v[40:43]
ds_read_b64_tr_b16 v[212:213], v248 offset:1408
v_mfma_f32_16x16x32_bf16 v[44:47], v[192:195], v[228:231], v[44:47]
ds_read_b64_tr_b16 v[214:215], v248 offset:5504
v_mfma_f32_16x16x32_bf16 v[48:51], v[196:199], v[224:227], v[48:51]
ds_read_b64_tr_b16 v[216:217], v250 offset:1408
v_mfma_f32_16x16x32_bf16 v[52:55], v[196:199], v[228:231], v[52:55]
ds_read_b64_tr_b16 v[218:219], v250 offset:5504
s_waitcnt lgkmcnt(6)
v_mfma_f32_16x16x32_bf16 v[56:59], v[200:203], v[224:227], v[56:59]
ds_read_b64_tr_b16 v[192:193], v248 offset:1472
v_mfma_f32_16x16x32_bf16 v[60:63], v[200:203], v[228:231], v[60:63]
ds_read_b64_tr_b16 v[194:195], v248 offset:5568
v_mfma_f32_16x16x32_bf16 v[64:67], v[204:207], v[224:227], v[64:67]
ds_read_b64_tr_b16 v[196:197], v250 offset:1472
v_mfma_f32_16x16x32_bf16 v[68:71], v[204:207], v[228:231], v[68:71]
ds_read_b64_tr_b16 v[198:199], v250 offset:5568
s_waitcnt lgkmcnt(6)
v_mfma_f32_16x16x32_bf16 v[72:75], v[208:211], v[224:227], v[72:75]
ds_read_b64_tr_b16 v[200:201], v248 offset:1536
v_mfma_f32_16x16x32_bf16 v[76:79], v[208:211], v[228:231], v[76:79]
ds_read_b64_tr_b16 v[202:203], v248 offset:5632
v_mfma_f32_16x16x32_bf16 v[80:83], v[212:215], v[224:227], v[80:83]
ds_read_b64_tr_b16 v[204:205], v250 offset:1536
v_mfma_f32_16x16x32_bf16 v[84:87], v[212:215], v[228:231], v[84:87]
ds_read_b64_tr_b16 v[206:207], v250 offset:5632
s_waitcnt lgkmcnt(6)
v_mfma_f32_16x16x32_bf16 v[88:91], v[216:219], v[224:227], v[88:91]
s_barrier
ds_read_b128 v[232:235], v247 offset:32768
ds_read_b128 v[236:239], v247 offset:34816
v_mfma_f32_16x16x32_bf16 v[92:95], v[216:219], v[228:231], v[92:95]
ds_read_b64_tr_b16 v[208:209], v240 offset:16384
ds_read_b64_tr_b16 v[210:211], v240 offset:20480
v_mfma_f32_16x16x32_bf16 v[96:99], v[192:195], v[224:227], v[96:99]
ds_read_b64_tr_b16 v[212:213], v240 offset:16392
v_mfma_f32_16x16x32_bf16 v[100:103], v[192:195], v[228:231], v[100:103]
ds_read_b64_tr_b16 v[214:215], v240 offset:20488
s_waitcnt lgkmcnt(8)
v_mfma_f32_16x16x32_bf16 v[104:107], v[196:199], v[224:227], v[104:107]
ds_read_b64_tr_b16 v[216:217], v240 offset:16400
v_mfma_f32_16x16x32_bf16 v[108:111], v[196:199], v[228:231], v[108:111]
ds_read_b64_tr_b16 v[218:219], v240 offset:20496
v_mfma_f32_16x16x32_bf16 v[112:115], v[200:203], v[224:227], v[112:115]
ds_read_b64_tr_b16 v[192:193], v240 offset:16408
v_mfma_f32_16x16x32_bf16 v[116:119], v[200:203], v[228:231], v[116:119]
ds_read_b64_tr_b16 v[194:195], v240 offset:20504
s_waitcnt lgkmcnt(6)
v_mfma_f32_16x16x32_bf16 v[120:123], v[204:207], v[224:227], v[120:123]
ds_read_b64_tr_b16 v[196:197], v240 offset:16416
v_mfma_f32_16x16x32_bf16 v[124:127], v[204:207], v[228:231], v[124:127]
ds_read_b64_tr_b16 v[198:199], v240 offset:20512
v_mfma_f32_16x16x32_bf16 v[8:11], v[208:211], v[232:235], v[8:11]
ds_read_b64_tr_b16 v[200:201], v248 offset:17664
v_mfma_f32_16x16x32_bf16 v[12:15], v[208:211], v[236:239], v[12:15]
ds_read_b64_tr_b16 v[202:203], v248 offset:21760
s_waitcnt lgkmcnt(6)
v_mfma_f32_16x16x32_bf16 v[16:19], v[212:215], v[232:235], v[16:19]
ds_read_b64_tr_b16 v[204:205], v250 offset:17664
v_mfma_f32_16x16x32_bf16 v[20:23], v[212:215], v[236:239], v[20:23]
ds_read_b64_tr_b16 v[206:207], v250 offset:21760
v_mfma_f32_16x16x32_bf16 v[24:27], v[216:219], v[232:235], v[24:27]
ds_read_b64_tr_b16 v[208:209], v248 offset:17728
v_mfma_f32_16x16x32_bf16 v[28:31], v[216:219], v[236:239], v[28:31]
ds_read_b64_tr_b16 v[210:211], v248 offset:21824
s_waitcnt lgkmcnt(6)
v_mfma_f32_16x16x32_bf16 v[32:35], v[192:195], v[232:235], v[32:35]
ds_read_b64_tr_b16 v[212:213], v250 offset:17728
v_mfma_f32_16x16x32_bf16 v[36:39], v[192:195], v[236:239], v[36:39]
ds_read_b64_tr_b16 v[214:215], v250 offset:21824
v_mfma_f32_16x16x32_bf16 v[40:43], v[196:199], v[232:235], v[40:43]
ds_read_b64_tr_b16 v[216:217], v248 offset:17792
v_mfma_f32_16x16x32_bf16 v[44:47], v[196:199], v[236:239], v[44:47]
ds_read_b64_tr_b16 v[218:219], v248 offset:21888
s_waitcnt lgkmcnt(6)
v_mfma_f32_16x16x32_bf16 v[48:51], v[200:203], v[232:235], v[48:51]
ds_read_b64_tr_b16 v[192:193], v250 offset:17792
v_mfma_f32_16x16x32_bf16 v[52:55], v[200:203], v[236:239], v[52:55]
ds_read_b64_tr_b16 v[194:195], v250 offset:21888
v_mfma_f32_16x16x32_bf16 v[56:59], v[204:207], v[232:235], v[56:59]
ds_read_b64_tr_b16 v[196:197], v248 offset:17856
v_mfma_f32_16x16x32_bf16 v[60:63], v[204:207], v[236:239], v[60:63]
ds_read_b64_tr_b16 v[198:199], v248 offset:21952
s_waitcnt lgkmcnt(6)
v_mfma_f32_16x16x32_bf16 v[64:67], v[208:211], v[232:235], v[64:67]
ds_read_b64_tr_b16 v[200:201], v250 offset:17856
v_mfma_f32_16x16x32_bf16 v[68:71], v[208:211], v[236:239], v[68:71]
ds_read_b64_tr_b16 v[202:203], v250 offset:21952
v_mfma_f32_16x16x32_bf16 v[72:75], v[212:215], v[232:235], v[72:75]
ds_read_b64_tr_b16 v[204:205], v248 offset:17920
v_mfma_f32_16x16x32_bf16 v[76:79], v[212:215], v[236:239], v[76:79]
ds_read_b64_tr_b16 v[206:207], v248 offset:22016
s_waitcnt lgkmcnt(6)
v_mfma_f32_16x16x32_bf16 v[80:83], v[216:219], v[232:235], v[80:83]
ds_read_b64_tr_b16 v[208:209], v250 offset:17920
v_mfma_f32_16x16x32_bf16 v[84:87], v[216:219], v[236:239], v[84:87]
ds_read_b64_tr_b16 v[210:211], v250 offset:22016
v_mfma_f32_16x16x32_bf16 v[88:91], v[192:195], v[232:235], v[88:91]
s_barrier
ds_read_b128 v[224:227], v246 offset:0
ds_read_b128 v[228:231], v246 offset:2048
v_mfma_f32_16x16x32_bf16 v[92:95], v[192:195], v[236:239], v[92:95]
ds_read_b64_tr_b16 v[212:213], v240 offset:32768
ds_read_b64_tr_b16 v[214:215], v240 offset:36864
s_waitcnt lgkmcnt(8)
v_mfma_f32_16x16x32_bf16 v[96:99], v[196:199], v[232:235], v[96:99]
ds_read_b64_tr_b16 v[216:217], v240 offset:32776
v_mfma_f32_16x16x32_bf16 v[100:103], v[196:199], v[236:239], v[100:103]
ds_read_b64_tr_b16 v[218:219], v240 offset:36872
v_mfma_f32_16x16x32_bf16 v[104:107], v[200:203], v[232:235], v[104:107]
ds_read_b64_tr_b16 v[192:193], v240 offset:32784
v_mfma_f32_16x16x32_bf16 v[108:111], v[200:203], v[236:239], v[108:111]
ds_read_b64_tr_b16 v[194:195], v240 offset:36880
s_waitcnt lgkmcnt(8)
v_mfma_f32_16x16x32_bf16 v[112:115], v[204:207], v[232:235], v[112:115]
ds_read_b64_tr_b16 v[196:197], v240 offset:32792
v_mfma_f32_16x16x32_bf16 v[116:119], v[204:207], v[236:239], v[116:119]
ds_read_b64_tr_b16 v[198:199], v240 offset:36888
v_mfma_f32_16x16x32_bf16 v[120:123], v[208:211], v[232:235], v[120:123]
ds_read_b64_tr_b16 v[200:201], v240 offset:32800
v_mfma_f32_16x16x32_bf16 v[124:127], v[208:211], v[236:239], v[124:127]
ds_read_b64_tr_b16 v[202:203], v240 offset:36896
s_waitcnt lgkmcnt(6)
v_mfma_f32_16x16x32_bf16 v[8:11], v[212:215], v[224:227], v[8:11]
ds_read_b64_tr_b16 v[204:205], v248 offset:34048
v_mfma_f32_16x16x32_bf16 v[12:15], v[212:215], v[228:231], v[12:15]
ds_read_b64_tr_b16 v[206:207], v248 offset:38144
v_mfma_f32_16x16x32_bf16 v[16:19], v[216:219], v[224:227], v[16:19]
ds_read_b64_tr_b16 v[208:209], v250 offset:34048
v_mfma_f32_16x16x32_bf16 v[20:23], v[216:219], v[228:231], v[20:23]
ds_read_b64_tr_b16 v[210:211], v250 offset:38144
s_waitcnt lgkmcnt(6)
v_mfma_f32_16x16x32_bf16 v[24:27], v[192:195], v[224:227], v[24:27]
ds_read_b64_tr_b16 v[212:213], v248 offset:34112
v_mfma_f32_16x16x32_bf16 v[28:31], v[192:195], v[228:231], v[28:31]
ds_read_b64_tr_b16 v[214:215], v248 offset:38208
v_mfma_f32_16x16x32_bf16 v[32:35], v[196:199], v[224:227], v[32:35]
ds_read_b64_tr_b16 v[216:217], v250 offset:34112
v_mfma_f32_16x16x32_bf16 v[36:39], v[196:199], v[228:231], v[36:39]
ds_read_b64_tr_b16 v[218:219], v250 offset:38208
s_waitcnt lgkmcnt(6)
v_mfma_f32_16x16x32_bf16 v[40:43], v[200:203], v[224:227], v[40:43]
ds_read_b64_tr_b16 v[192:193], v248 offset:34176
v_mfma_f32_16x16x32_bf16 v[44:47], v[200:203], v[228:231], v[44:47]
ds_read_b64_tr_b16 v[194:195], v248 offset:38272
v_mfma_f32_16x16x32_bf16 v[48:51], v[204:207], v[224:227], v[48:51]
ds_read_b64_tr_b16 v[196:197], v250 offset:34176
v_mfma_f32_16x16x32_bf16 v[52:55], v[204:207], v[228:231], v[52:55]
ds_read_b64_tr_b16 v[198:199], v250 offset:38272
s_waitcnt lgkmcnt(6)
v_mfma_f32_16x16x32_bf16 v[56:59], v[208:211], v[224:227], v[56:59]
ds_read_b64_tr_b16 v[200:201], v248 offset:34240
v_mfma_f32_16x16x32_bf16 v[60:63], v[208:211], v[228:231], v[60:63]
ds_read_b64_tr_b16 v[202:203], v248 offset:38336
v_mfma_f32_16x16x32_bf16 v[64:67], v[212:215], v[224:227], v[64:67]
ds_read_b64_tr_b16 v[204:205], v250 offset:34240
v_mfma_f32_16x16x32_bf16 v[68:71], v[212:215], v[228:231], v[68:71]
ds_read_b64_tr_b16 v[206:207], v250 offset:38336
s_waitcnt lgkmcnt(6)
v_mfma_f32_16x16x32_bf16 v[72:75], v[216:219], v[224:227], v[72:75]
ds_read_b64_tr_b16 v[208:209], v248 offset:34304
v_mfma_f32_16x16x32_bf16 v[76:79], v[216:219], v[228:231], v[76:79]
ds_read_b64_tr_b16 v[210:211], v248 offset:38400
v_mfma_f32_16x16x32_bf16 v[80:83], v[192:195], v[224:227], v[80:83]
ds_read_b64_tr_b16 v[212:213], v250 offset:34304
v_mfma_f32_16x16x32_bf16 v[84:87], v[192:195], v[228:231], v[84:87]
ds_read_b64_tr_b16 v[214:215], v250 offset:38400
s_waitcnt lgkmcnt(6)
v_mfma_f32_16x16x32_bf16 v[88:91], v[196:199], v[224:227], v[88:91]
s_barrier
ds_read_b128 v[232:235], v247 offset:0
ds_read_b128 v[236:239], v247 offset:2048
v_mfma_f32_16x16x32_bf16 v[92:95], v[196:199], v[228:231], v[92:95]
ds_read_b64_tr_b16 v[216:217], v241 offset:0
ds_read_b64_tr_b16 v[218:219], v241 offset:4096
v_mfma_f32_16x16x32_bf16 v[96:99], v[200:203], v[224:227], v[96:99]
ds_read_b64_tr_b16 v[192:193], v241 offset:8
v_mfma_f32_16x16x32_bf16 v[100:103], v[200:203], v[228:231], v[100:103]
ds_read_b64_tr_b16 v[194:195], v241 offset:4104
s_waitcnt lgkmcnt(8)
v_mfma_f32_16x16x32_bf16 v[104:107], v[204:207], v[224:227], v[104:107]
ds_read_b64_tr_b16 v[196:197], v241 offset:16
v_mfma_f32_16x16x32_bf16 v[108:111], v[204:207], v[228:231], v[108:111]
ds_read_b64_tr_b16 v[198:199], v241 offset:4112
v_mfma_f32_16x16x32_bf16 v[112:115], v[208:211], v[224:227], v[112:115]
ds_read_b64_tr_b16 v[200:201], v241 offset:24
v_mfma_f32_16x16x32_bf16 v[116:119], v[208:211], v[228:231], v[116:119]
ds_read_b64_tr_b16 v[202:203], v241 offset:4120
s_waitcnt lgkmcnt(6)
v_mfma_f32_16x16x32_bf16 v[120:123], v[212:215], v[224:227], v[120:123]
ds_read_b64_tr_b16 v[204:205], v241 offset:32
v_mfma_f32_16x16x32_bf16 v[124:127], v[212:215], v[228:231], v[124:127]
ds_read_b64_tr_b16 v[206:207], v241 offset:4128
v_mfma_f32_16x16x32_bf16 v[8:11], v[216:219], v[232:235], v[8:11]
ds_read_b64_tr_b16 v[208:209], v249 offset:1280
v_mfma_f32_16x16x32_bf16 v[12:15], v[216:219], v[236:239], v[12:15]
ds_read_b64_tr_b16 v[210:211], v249 offset:5376
s_waitcnt lgkmcnt(6)
v_mfma_f32_16x16x32_bf16 v[16:19], v[192:195], v[232:235], v[16:19]
ds_read_b64_tr_b16 v[212:213], v251 offset:1280
v_mfma_f32_16x16x32_bf16 v[20:23], v[192:195], v[236:239], v[20:23]
ds_read_b64_tr_b16 v[214:215], v251 offset:5376
v_mfma_f32_16x16x32_bf16 v[24:27], v[196:199], v[232:235], v[24:27]
ds_read_b64_tr_b16 v[216:217], v249 offset:1344
v_mfma_f32_16x16x32_bf16 v[28:31], v[196:199], v[236:239], v[28:31]
ds_read_b64_tr_b16 v[218:219], v249 offset:5440
s_waitcnt lgkmcnt(6)
v_mfma_f32_16x16x32_bf16 v[32:35], v[200:203], v[232:235], v[32:35]
ds_read_b64_tr_b16 v[192:193], v251 offset:1344
v_mfma_f32_16x16x32_bf16 v[36:39], v[200:203], v[236:239], v[36:39]
ds_read_b64_tr_b16 v[194:195], v251 offset:5440
v_mfma_f32_16x16x32_bf16 v[40:43], v[204:207], v[232:235], v[40:43]
ds_read_b64_tr_b16 v[196:197], v249 offset:1408
v_mfma_f32_16x16x32_bf16 v[44:47], v[204:207], v[236:239], v[44:47]
ds_read_b64_tr_b16 v[198:199], v249 offset:5504
s_waitcnt lgkmcnt(6)
v_mfma_f32_16x16x32_bf16 v[48:51], v[208:211], v[232:235], v[48:51]
ds_read_b64_tr_b16 v[200:201], v251 offset:1408
v_mfma_f32_16x16x32_bf16 v[52:55], v[208:211], v[236:239], v[52:55]
ds_read_b64_tr_b16 v[202:203], v251 offset:5504
v_mfma_f32_16x16x32_bf16 v[56:59], v[212:215], v[232:235], v[56:59]
ds_read_b64_tr_b16 v[204:205], v249 offset:1472
v_mfma_f32_16x16x32_bf16 v[60:63], v[212:215], v[236:239], v[60:63]
ds_read_b64_tr_b16 v[206:207], v249 offset:5568
s_waitcnt lgkmcnt(6)
v_mfma_f32_16x16x32_bf16 v[64:67], v[216:219], v[232:235], v[64:67]
ds_read_b64_tr_b16 v[208:209], v251 offset:1472
v_mfma_f32_16x16x32_bf16 v[68:71], v[216:219], v[236:239], v[68:71]
ds_read_b64_tr_b16 v[210:211], v251 offset:5568
v_mfma_f32_16x16x32_bf16 v[72:75], v[192:195], v[232:235], v[72:75]
ds_read_b64_tr_b16 v[212:213], v249 offset:1536
v_mfma_f32_16x16x32_bf16 v[76:79], v[192:195], v[236:239], v[76:79]
ds_read_b64_tr_b16 v[214:215], v249 offset:5632
s_waitcnt lgkmcnt(6)
v_mfma_f32_16x16x32_bf16 v[80:83], v[196:199], v[232:235], v[80:83]
ds_read_b64_tr_b16 v[216:217], v251 offset:1536
v_mfma_f32_16x16x32_bf16 v[84:87], v[196:199], v[236:239], v[84:87]
ds_read_b64_tr_b16 v[218:219], v251 offset:5632
v_mfma_f32_16x16x32_bf16 v[88:91], v[200:203], v[232:235], v[88:91]
s_barrier
ds_read_b128 v[224:227], v246 offset:16384
ds_read_b128 v[228:231], v246 offset:18432
v_mfma_f32_16x16x32_bf16 v[92:95], v[200:203], v[236:239], v[92:95]
ds_read_b64_tr_b16 v[192:193], v241 offset:16384
ds_read_b64_tr_b16 v[194:195], v241 offset:20480
s_waitcnt lgkmcnt(8)
v_mfma_f32_16x16x32_bf16 v[96:99], v[204:207], v[232:235], v[96:99]
ds_read_b64_tr_b16 v[196:197], v241 offset:16392
v_mfma_f32_16x16x32_bf16 v[100:103], v[204:207], v[236:239], v[100:103]
ds_read_b64_tr_b16 v[198:199], v241 offset:20488
v_mfma_f32_16x16x32_bf16 v[104:107], v[208:211], v[232:235], v[104:107]
ds_read_b64_tr_b16 v[200:201], v241 offset:16400
v_mfma_f32_16x16x32_bf16 v[108:111], v[208:211], v[236:239], v[108:111]
ds_read_b64_tr_b16 v[202:203], v241 offset:20496
s_waitcnt lgkmcnt(8)
v_mfma_f32_16x16x32_bf16 v[112:115], v[212:215], v[232:235], v[112:115]
ds_read_b64_tr_b16 v[204:205], v241 offset:16408
v_mfma_f32_16x16x32_bf16 v[116:119], v[212:215], v[236:239], v[116:119]
ds_read_b64_tr_b16 v[206:207], v241 offset:20504
v_mfma_f32_16x16x32_bf16 v[120:123], v[216:219], v[232:235], v[120:123]
ds_read_b64_tr_b16 v[208:209], v241 offset:16416
v_mfma_f32_16x16x32_bf16 v[124:127], v[216:219], v[236:239], v[124:127]
ds_read_b64_tr_b16 v[210:211], v241 offset:20512
s_waitcnt lgkmcnt(6)
v_mfma_f32_16x16x32_bf16 v[8:11], v[192:195], v[224:227], v[8:11]
ds_read_b64_tr_b16 v[212:213], v249 offset:17664
v_mfma_f32_16x16x32_bf16 v[12:15], v[192:195], v[228:231], v[12:15]
ds_read_b64_tr_b16 v[214:215], v249 offset:21760
v_mfma_f32_16x16x32_bf16 v[16:19], v[196:199], v[224:227], v[16:19]
ds_read_b64_tr_b16 v[216:217], v251 offset:17664
v_mfma_f32_16x16x32_bf16 v[20:23], v[196:199], v[228:231], v[20:23]
ds_read_b64_tr_b16 v[218:219], v251 offset:21760
s_waitcnt lgkmcnt(6)
v_mfma_f32_16x16x32_bf16 v[24:27], v[200:203], v[224:227], v[24:27]
ds_read_b64_tr_b16 v[192:193], v249 offset:17728
v_mfma_f32_16x16x32_bf16 v[28:31], v[200:203], v[228:231], v[28:31]
ds_read_b64_tr_b16 v[194:195], v249 offset:21824
v_mfma_f32_16x16x32_bf16 v[32:35], v[204:207], v[224:227], v[32:35]
ds_read_b64_tr_b16 v[196:197], v251 offset:17728
v_mfma_f32_16x16x32_bf16 v[36:39], v[204:207], v[228:231], v[36:39]
ds_read_b64_tr_b16 v[198:199], v251 offset:21824
s_waitcnt lgkmcnt(6)
v_mfma_f32_16x16x32_bf16 v[40:43], v[208:211], v[224:227], v[40:43]
ds_read_b64_tr_b16 v[200:201], v249 offset:17792
v_mfma_f32_16x16x32_bf16 v[44:47], v[208:211], v[228:231], v[44:47]
ds_read_b64_tr_b16 v[202:203], v249 offset:21888
v_mfma_f32_16x16x32_bf16 v[48:51], v[212:215], v[224:227], v[48:51]
ds_read_b64_tr_b16 v[204:205], v251 offset:17792
v_mfma_f32_16x16x32_bf16 v[52:55], v[212:215], v[228:231], v[52:55]
ds_read_b64_tr_b16 v[206:207], v251 offset:21888
s_waitcnt lgkmcnt(6)
v_mfma_f32_16x16x32_bf16 v[56:59], v[216:219], v[224:227], v[56:59]
ds_read_b64_tr_b16 v[208:209], v249 offset:17856
v_mfma_f32_16x16x32_bf16 v[60:63], v[216:219], v[228:231], v[60:63]
ds_read_b64_tr_b16 v[210:211], v249 offset:21952
v_mfma_f32_16x16x32_bf16 v[64:67], v[192:195], v[224:227], v[64:67]
ds_read_b64_tr_b16 v[212:213], v251 offset:17856
v_mfma_f32_16x16x32_bf16 v[68:71], v[192:195], v[228:231], v[68:71]
ds_read_b64_tr_b16 v[214:215], v251 offset:21952
s_waitcnt lgkmcnt(6)
v_mfma_f32_16x16x32_bf16 v[72:75], v[196:199], v[224:227], v[72:75]
ds_read_b64_tr_b16 v[216:217], v249 offset:17920
v_mfma_f32_16x16x32_bf16 v[76:79], v[196:199], v[228:231], v[76:79]
ds_read_b64_tr_b16 v[218:219], v249 offset:22016
v_mfma_f32_16x16x32_bf16 v[80:83], v[200:203], v[224:227], v[80:83]
ds_read_b64_tr_b16 v[192:193], v251 offset:17920
v_mfma_f32_16x16x32_bf16 v[84:87], v[200:203], v[228:231], v[84:87]
ds_read_b64_tr_b16 v[194:195], v251 offset:22016
s_waitcnt lgkmcnt(6)
v_mfma_f32_16x16x32_bf16 v[88:91], v[204:207], v[224:227], v[88:91]
s_barrier
ds_read_b128 v[232:235], v247 offset:16384
ds_read_b128 v[236:239], v247 offset:18432
v_mfma_f32_16x16x32_bf16 v[92:95], v[204:207], v[228:231], v[92:95]
ds_read_b64_tr_b16 v[196:197], v240 offset:0
ds_read_b64_tr_b16 v[198:199], v240 offset:4096
v_mfma_f32_16x16x32_bf16 v[96:99], v[208:211], v[224:227], v[96:99]
ds_read_b64_tr_b16 v[200:201], v240 offset:8
v_mfma_f32_16x16x32_bf16 v[100:103], v[208:211], v[228:231], v[100:103]
ds_read_b64_tr_b16 v[202:203], v240 offset:4104
s_waitcnt lgkmcnt(8)
v_mfma_f32_16x16x32_bf16 v[104:107], v[212:215], v[224:227], v[104:107]
ds_read_b64_tr_b16 v[204:205], v240 offset:16
v_mfma_f32_16x16x32_bf16 v[108:111], v[212:215], v[228:231], v[108:111]
ds_read_b64_tr_b16 v[206:207], v240 offset:4112
v_mfma_f32_16x16x32_bf16 v[112:115], v[216:219], v[224:227], v[112:115]
ds_read_b64_tr_b16 v[208:209], v240 offset:24
v_mfma_f32_16x16x32_bf16 v[116:119], v[216:219], v[228:231], v[116:119]
ds_read_b64_tr_b16 v[210:211], v240 offset:4120
s_waitcnt lgkmcnt(6)
v_mfma_f32_16x16x32_bf16 v[120:123], v[192:195], v[224:227], v[120:123]
ds_read_b64_tr_b16 v[212:213], v240 offset:32
v_mfma_f32_16x16x32_bf16 v[124:127], v[192:195], v[228:231], v[124:127]
ds_read_b64_tr_b16 v[214:215], v240 offset:4128
v_mfma_f32_16x16x32_bf16 v[8:11], v[196:199], v[232:235], v[8:11]
ds_read_b64_tr_b16 v[216:217], v248 offset:1280
v_mfma_f32_16x16x32_bf16 v[12:15], v[196:199], v[236:239], v[12:15]
ds_read_b64_tr_b16 v[218:219], v248 offset:5376
s_waitcnt lgkmcnt(6)
v_mfma_f32_16x16x32_bf16 v[16:19], v[200:203], v[232:235], v[16:19]
ds_read_b64_tr_b16 v[192:193], v250 offset:1280
v_mfma_f32_16x16x32_bf16 v[20:23], v[200:203], v[236:239], v[20:23]
ds_read_b64_tr_b16 v[194:195], v250 offset:5376
v_mfma_f32_16x16x32_bf16 v[24:27], v[204:207], v[232:235], v[24:27]
ds_read_b64_tr_b16 v[196:197], v248 offset:1344
v_mfma_f32_16x16x32_bf16 v[28:31], v[204:207], v[236:239], v[28:31]
ds_read_b64_tr_b16 v[198:199], v248 offset:5440
s_waitcnt lgkmcnt(6)
v_mfma_f32_16x16x32_bf16 v[32:35], v[208:211], v[232:235], v[32:35]
ds_read_b64_tr_b16 v[200:201], v250 offset:1344
v_mfma_f32_16x16x32_bf16 v[36:39], v[208:211], v[236:239], v[36:39]
ds_read_b64_tr_b16 v[202:203], v250 offset:5440
v_mfma_f32_16x16x32_bf16 v[40:43], v[212:215], v[232:235], v[40:43]
ds_read_b64_tr_b16 v[204:205], v248 offset:1408
v_mfma_f32_16x16x32_bf16 v[44:47], v[212:215], v[236:239], v[44:47]
ds_read_b64_tr_b16 v[206:207], v248 offset:5504
s_waitcnt lgkmcnt(6)
v_mfma_f32_16x16x32_bf16 v[48:51], v[216:219], v[232:235], v[48:51]
ds_read_b64_tr_b16 v[208:209], v250 offset:1408
v_mfma_f32_16x16x32_bf16 v[52:55], v[216:219], v[236:239], v[52:55]
ds_read_b64_tr_b16 v[210:211], v250 offset:5504
v_mfma_f32_16x16x32_bf16 v[56:59], v[192:195], v[232:235], v[56:59]
ds_read_b64_tr_b16 v[212:213], v248 offset:1472
v_mfma_f32_16x16x32_bf16 v[60:63], v[192:195], v[236:239], v[60:63]
ds_read_b64_tr_b16 v[214:215], v248 offset:5568
s_waitcnt lgkmcnt(6)
v_mfma_f32_16x16x32_bf16 v[64:67], v[196:199], v[232:235], v[64:67]
ds_read_b64_tr_b16 v[216:217], v250 offset:1472
v_mfma_f32_16x16x32_bf16 v[68:71], v[196:199], v[236:239], v[68:71]
ds_read_b64_tr_b16 v[218:219], v250 offset:5568
v_mfma_f32_16x16x32_bf16 v[72:75], v[200:203], v[232:235], v[72:75]
ds_read_b64_tr_b16 v[192:193], v248 offset:1536
v_mfma_f32_16x16x32_bf16 v[76:79], v[200:203], v[236:239], v[76:79]
ds_read_b64_tr_b16 v[194:195], v248 offset:5632
s_waitcnt lgkmcnt(6)
v_mfma_f32_16x16x32_bf16 v[80:83], v[204:207], v[232:235], v[80:83]
ds_read_b64_tr_b16 v[196:197], v250 offset:1536
v_mfma_f32_16x16x32_bf16 v[84:87], v[204:207], v[236:239], v[84:87]
ds_read_b64_tr_b16 v[198:199], v250 offset:5632
v_mfma_f32_16x16x32_bf16 v[88:91], v[208:211], v[232:235], v[88:91]
s_barrier
ds_read_b128 v[224:227], v246 offset:32768
ds_read_b128 v[228:231], v246 offset:34816
v_mfma_f32_16x16x32_bf16 v[92:95], v[208:211], v[236:239], v[92:95]
ds_read_b64_tr_b16 v[200:201], v240 offset:16384
ds_read_b64_tr_b16 v[202:203], v240 offset:20480
s_waitcnt lgkmcnt(8)
v_mfma_f32_16x16x32_bf16 v[96:99], v[212:215], v[232:235], v[96:99]
ds_read_b64_tr_b16 v[204:205], v240 offset:16392
v_mfma_f32_16x16x32_bf16 v[100:103], v[212:215], v[236:239], v[100:103]
ds_read_b64_tr_b16 v[206:207], v240 offset:20488
v_mfma_f32_16x16x32_bf16 v[104:107], v[216:219], v[232:235], v[104:107]
ds_read_b64_tr_b16 v[208:209], v240 offset:16400
v_mfma_f32_16x16x32_bf16 v[108:111], v[216:219], v[236:239], v[108:111]
ds_read_b64_tr_b16 v[210:211], v240 offset:20496
s_waitcnt lgkmcnt(8)
v_mfma_f32_16x16x32_bf16 v[112:115], v[192:195], v[232:235], v[112:115]
ds_read_b64_tr_b16 v[212:213], v240 offset:16408
v_mfma_f32_16x16x32_bf16 v[116:119], v[192:195], v[236:239], v[116:119]
ds_read_b64_tr_b16 v[214:215], v240 offset:20504
v_mfma_f32_16x16x32_bf16 v[120:123], v[196:199], v[232:235], v[120:123]
ds_read_b64_tr_b16 v[216:217], v240 offset:16416
v_mfma_f32_16x16x32_bf16 v[124:127], v[196:199], v[236:239], v[124:127]
ds_read_b64_tr_b16 v[218:219], v240 offset:20512
s_waitcnt lgkmcnt(6)
v_mfma_f32_16x16x32_bf16 v[8:11], v[200:203], v[224:227], v[8:11]
ds_read_b64_tr_b16 v[192:193], v248 offset:17664
v_mfma_f32_16x16x32_bf16 v[12:15], v[200:203], v[228:231], v[12:15]
ds_read_b64_tr_b16 v[194:195], v248 offset:21760
v_mfma_f32_16x16x32_bf16 v[16:19], v[204:207], v[224:227], v[16:19]
ds_read_b64_tr_b16 v[196:197], v250 offset:17664
v_mfma_f32_16x16x32_bf16 v[20:23], v[204:207], v[228:231], v[20:23]
ds_read_b64_tr_b16 v[198:199], v250 offset:21760
s_waitcnt lgkmcnt(6)
v_mfma_f32_16x16x32_bf16 v[24:27], v[208:211], v[224:227], v[24:27]
ds_read_b64_tr_b16 v[200:201], v248 offset:17728
v_mfma_f32_16x16x32_bf16 v[28:31], v[208:211], v[228:231], v[28:31]
ds_read_b64_tr_b16 v[202:203], v248 offset:21824
v_mfma_f32_16x16x32_bf16 v[32:35], v[212:215], v[224:227], v[32:35]
ds_read_b64_tr_b16 v[204:205], v250 offset:17728
v_mfma_f32_16x16x32_bf16 v[36:39], v[212:215], v[228:231], v[36:39]
ds_read_b64_tr_b16 v[206:207], v250 offset:21824
s_waitcnt lgkmcnt(6)
v_mfma_f32_16x16x32_bf16 v[40:43], v[216:219], v[224:227], v[40:43]
ds_read_b64_tr_b16 v[208:209], v248 offset:17792
v_mfma_f32_16x16x32_bf16 v[44:47], v[216:219], v[228:231], v[44:47]
ds_read_b64_tr_b16 v[210:211], v248 offset:21888
v_mfma_f32_16x16x32_bf16 v[48:51], v[192:195], v[224:227], v[48:51]
ds_read_b64_tr_b16 v[212:213], v250 offset:17792
v_mfma_f32_16x16x32_bf16 v[52:55], v[192:195], v[228:231], v[52:55]
ds_read_b64_tr_b16 v[214:215], v250 offset:21888
s_waitcnt lgkmcnt(6)
v_mfma_f32_16x16x32_bf16 v[56:59], v[196:199], v[224:227], v[56:59]
ds_read_b64_tr_b16 v[216:217], v248 offset:17856
v_mfma_f32_16x16x32_bf16 v[60:63], v[196:199], v[228:231], v[60:63]
ds_read_b64_tr_b16 v[218:219], v248 offset:21952
v_mfma_f32_16x16x32_bf16 v[64:67], v[200:203], v[224:227], v[64:67]
ds_read_b64_tr_b16 v[192:193], v250 offset:17856
v_mfma_f32_16x16x32_bf16 v[68:71], v[200:203], v[228:231], v[68:71]
ds_read_b64_tr_b16 v[194:195], v250 offset:21952
s_waitcnt lgkmcnt(6)
v_mfma_f32_16x16x32_bf16 v[72:75], v[204:207], v[224:227], v[72:75]
ds_read_b64_tr_b16 v[196:197], v248 offset:17920
v_mfma_f32_16x16x32_bf16 v[76:79], v[204:207], v[228:231], v[76:79]
ds_read_b64_tr_b16 v[198:199], v248 offset:22016
v_mfma_f32_16x16x32_bf16 v[80:83], v[208:211], v[224:227], v[80:83]
ds_read_b64_tr_b16 v[200:201], v250 offset:17920
v_mfma_f32_16x16x32_bf16 v[84:87], v[208:211], v[228:231], v[84:87]
ds_read_b64_tr_b16 v[202:203], v250 offset:22016
s_waitcnt lgkmcnt(6)
v_mfma_f32_16x16x32_bf16 v[88:91], v[212:215], v[224:227], v[88:91]
s_barrier
ds_read_b128 v[232:235], v247 offset:32768
ds_read_b128 v[236:239], v247 offset:34816
v_mfma_f32_16x16x32_bf16 v[92:95], v[212:215], v[228:231], v[92:95]
ds_read_b64_tr_b16 v[204:205], v240 offset:32768
ds_read_b64_tr_b16 v[206:207], v240 offset:36864
v_mfma_f32_16x16x32_bf16 v[96:99], v[216:219], v[224:227], v[96:99]
ds_read_b64_tr_b16 v[208:209], v240 offset:32776
v_mfma_f32_16x16x32_bf16 v[100:103], v[216:219], v[228:231], v[100:103]
ds_read_b64_tr_b16 v[210:211], v240 offset:36872
s_waitcnt lgkmcnt(8)
v_mfma_f32_16x16x32_bf16 v[104:107], v[192:195], v[224:227], v[104:107]
ds_read_b64_tr_b16 v[212:213], v240 offset:32784
v_mfma_f32_16x16x32_bf16 v[108:111], v[192:195], v[228:231], v[108:111]
ds_read_b64_tr_b16 v[214:215], v240 offset:36880
v_mfma_f32_16x16x32_bf16 v[112:115], v[196:199], v[224:227], v[112:115]
ds_read_b64_tr_b16 v[216:217], v240 offset:32792
v_mfma_f32_16x16x32_bf16 v[116:119], v[196:199], v[228:231], v[116:119]
ds_read_b64_tr_b16 v[218:219], v240 offset:36888
s_waitcnt lgkmcnt(6)
v_mfma_f32_16x16x32_bf16 v[120:123], v[200:203], v[224:227], v[120:123]
ds_read_b64_tr_b16 v[192:193], v240 offset:32800
v_mfma_f32_16x16x32_bf16 v[124:127], v[200:203], v[228:231], v[124:127]
ds_read_b64_tr_b16 v[194:195], v240 offset:36896
v_mfma_f32_16x16x32_bf16 v[8:11], v[204:207], v[232:235], v[8:11]
ds_read_b64_tr_b16 v[196:197], v248 offset:34048
v_mfma_f32_16x16x32_bf16 v[12:15], v[204:207], v[236:239], v[12:15]
ds_read_b64_tr_b16 v[198:199], v248 offset:38144
s_waitcnt lgkmcnt(6)
v_mfma_f32_16x16x32_bf16 v[16:19], v[208:211], v[232:235], v[16:19]
ds_read_b64_tr_b16 v[200:201], v250 offset:34048
v_mfma_f32_16x16x32_bf16 v[20:23], v[208:211], v[236:239], v[20:23]
ds_read_b64_tr_b16 v[202:203], v250 offset:38144
v_mfma_f32_16x16x32_bf16 v[24:27], v[212:215], v[232:235], v[24:27]
ds_read_b64_tr_b16 v[204:205], v248 offset:34112
v_mfma_f32_16x16x32_bf16 v[28:31], v[212:215], v[236:239], v[28:31]
ds_read_b64_tr_b16 v[206:207], v248 offset:38208
s_waitcnt lgkmcnt(6)
v_mfma_f32_16x16x32_bf16 v[32:35], v[216:219], v[232:235], v[32:35]
ds_read_b64_tr_b16 v[208:209], v250 offset:34112
v_mfma_f32_16x16x32_bf16 v[36:39], v[216:219], v[236:239], v[36:39]
ds_read_b64_tr_b16 v[210:211], v250 offset:38208
v_mfma_f32_16x16x32_bf16 v[40:43], v[192:195], v[232:235], v[40:43]
ds_read_b64_tr_b16 v[212:213], v248 offset:34176
v_mfma_f32_16x16x32_bf16 v[44:47], v[192:195], v[236:239], v[44:47]
ds_read_b64_tr_b16 v[214:215], v248 offset:38272
s_waitcnt lgkmcnt(6)
v_mfma_f32_16x16x32_bf16 v[48:51], v[196:199], v[232:235], v[48:51]
ds_read_b64_tr_b16 v[216:217], v250 offset:34176
v_mfma_f32_16x16x32_bf16 v[52:55], v[196:199], v[236:239], v[52:55]
ds_read_b64_tr_b16 v[218:219], v250 offset:38272
v_mfma_f32_16x16x32_bf16 v[56:59], v[200:203], v[232:235], v[56:59]
ds_read_b64_tr_b16 v[192:193], v248 offset:34240
v_mfma_f32_16x16x32_bf16 v[60:63], v[200:203], v[236:239], v[60:63]
ds_read_b64_tr_b16 v[194:195], v248 offset:38336
s_waitcnt lgkmcnt(6)
v_mfma_f32_16x16x32_bf16 v[64:67], v[204:207], v[232:235], v[64:67]
ds_read_b64_tr_b16 v[196:197], v250 offset:34240
v_mfma_f32_16x16x32_bf16 v[68:71], v[204:207], v[236:239], v[68:71]
ds_read_b64_tr_b16 v[198:199], v250 offset:38336
v_mfma_f32_16x16x32_bf16 v[72:75], v[208:211], v[232:235], v[72:75]
ds_read_b64_tr_b16 v[200:201], v248 offset:34304
v_mfma_f32_16x16x32_bf16 v[76:79], v[208:211], v[236:239], v[76:79]
ds_read_b64_tr_b16 v[202:203], v248 offset:38400
s_waitcnt lgkmcnt(6)
v_mfma_f32_16x16x32_bf16 v[80:83], v[212:215], v[232:235], v[80:83]
ds_read_b64_tr_b16 v[204:205], v250 offset:34304
v_mfma_f32_16x16x32_bf16 v[84:87], v[212:215], v[236:239], v[84:87]
ds_read_b64_tr_b16 v[206:207], v250 offset:38400
v_mfma_f32_16x16x32_bf16 v[88:91], v[216:219], v[232:235], v[88:91]
s_barrier
ds_read_b128 v[224:227], v246 offset:0
ds_read_b128 v[228:231], v246 offset:2048
v_mfma_f32_16x16x32_bf16 v[92:95], v[216:219], v[236:239], v[92:95]
ds_read_b64_tr_b16 v[208:209], v241 offset:0
ds_read_b64_tr_b16 v[210:211], v241 offset:4096
s_waitcnt lgkmcnt(8)
v_mfma_f32_16x16x32_bf16 v[96:99], v[192:195], v[232:235], v[96:99]
ds_read_b64_tr_b16 v[212:213], v241 offset:8
v_mfma_f32_16x16x32_bf16 v[100:103], v[192:195], v[236:239], v[100:103]
ds_read_b64_tr_b16 v[214:215], v241 offset:4104
v_mfma_f32_16x16x32_bf16 v[104:107], v[196:199], v[232:235], v[104:107]
ds_read_b64_tr_b16 v[216:217], v241 offset:16
v_mfma_f32_16x16x32_bf16 v[108:111], v[196:199], v[236:239], v[108:111]
ds_read_b64_tr_b16 v[218:219], v241 offset:4112
s_waitcnt lgkmcnt(8)
v_mfma_f32_16x16x32_bf16 v[112:115], v[200:203], v[232:235], v[112:115]
ds_read_b64_tr_b16 v[192:193], v241 offset:24
v_mfma_f32_16x16x32_bf16 v[116:119], v[200:203], v[236:239], v[116:119]
ds_read_b64_tr_b16 v[194:195], v241 offset:4120
v_mfma_f32_16x16x32_bf16 v[120:123], v[204:207], v[232:235], v[120:123]
ds_read_b64_tr_b16 v[196:197], v241 offset:32
v_mfma_f32_16x16x32_bf16 v[124:127], v[204:207], v[236:239], v[124:127]
ds_read_b64_tr_b16 v[198:199], v241 offset:4128
s_waitcnt lgkmcnt(6)
v_mfma_f32_16x16x32_bf16 v[8:11], v[208:211], v[224:227], v[8:11]
ds_read_b64_tr_b16 v[200:201], v249 offset:1280
v_mfma_f32_16x16x32_bf16 v[12:15], v[208:211], v[228:231], v[12:15]
ds_read_b64_tr_b16 v[202:203], v249 offset:5376
v_mfma_f32_16x16x32_bf16 v[16:19], v[212:215], v[224:227], v[16:19]
ds_read_b64_tr_b16 v[204:205], v251 offset:1280
v_mfma_f32_16x16x32_bf16 v[20:23], v[212:215], v[228:231], v[20:23]
ds_read_b64_tr_b16 v[206:207], v251 offset:5376
s_waitcnt lgkmcnt(6)
v_mfma_f32_16x16x32_bf16 v[24:27], v[216:219], v[224:227], v[24:27]
ds_read_b64_tr_b16 v[208:209], v249 offset:1344
v_mfma_f32_16x16x32_bf16 v[28:31], v[216:219], v[228:231], v[28:31]
ds_read_b64_tr_b16 v[210:211], v249 offset:5440
v_mfma_f32_16x16x32_bf16 v[32:35], v[192:195], v[224:227], v[32:35]
ds_read_b64_tr_b16 v[212:213], v251 offset:1344
v_mfma_f32_16x16x32_bf16 v[36:39], v[192:195], v[228:231], v[36:39]
ds_read_b64_tr_b16 v[214:215], v251 offset:5440
s_waitcnt lgkmcnt(6)
v_mfma_f32_16x16x32_bf16 v[40:43], v[196:199], v[224:227], v[40:43]
ds_read_b64_tr_b16 v[216:217], v249 offset:1408
v_mfma_f32_16x16x32_bf16 v[44:47], v[196:199], v[228:231], v[44:47]
ds_read_b64_tr_b16 v[218:219], v249 offset:5504
v_mfma_f32_16x16x32_bf16 v[48:51], v[200:203], v[224:227], v[48:51]
ds_read_b64_tr_b16 v[192:193], v251 offset:1408
v_mfma_f32_16x16x32_bf16 v[52:55], v[200:203], v[228:231], v[52:55]
ds_read_b64_tr_b16 v[194:195], v251 offset:5504
s_waitcnt lgkmcnt(6)
v_mfma_f32_16x16x32_bf16 v[56:59], v[204:207], v[224:227], v[56:59]
ds_read_b64_tr_b16 v[196:197], v249 offset:1472
v_mfma_f32_16x16x32_bf16 v[60:63], v[204:207], v[228:231], v[60:63]
ds_read_b64_tr_b16 v[198:199], v249 offset:5568
v_mfma_f32_16x16x32_bf16 v[64:67], v[208:211], v[224:227], v[64:67]
ds_read_b64_tr_b16 v[200:201], v251 offset:1472
v_mfma_f32_16x16x32_bf16 v[68:71], v[208:211], v[228:231], v[68:71]
ds_read_b64_tr_b16 v[202:203], v251 offset:5568
s_waitcnt lgkmcnt(6)
v_mfma_f32_16x16x32_bf16 v[72:75], v[212:215], v[224:227], v[72:75]
ds_read_b64_tr_b16 v[204:205], v249 offset:1536
v_mfma_f32_16x16x32_bf16 v[76:79], v[212:215], v[228:231], v[76:79]
ds_read_b64_tr_b16 v[206:207], v249 offset:5632
v_mfma_f32_16x16x32_bf16 v[80:83], v[216:219], v[224:227], v[80:83]
ds_read_b64_tr_b16 v[208:209], v251 offset:1536
v_mfma_f32_16x16x32_bf16 v[84:87], v[216:219], v[228:231], v[84:87]
ds_read_b64_tr_b16 v[210:211], v251 offset:5632
s_waitcnt lgkmcnt(6)
v_mfma_f32_16x16x32_bf16 v[88:91], v[192:195], v[224:227], v[88:91]
s_barrier
ds_read_b128 v[232:235], v247 offset:0
ds_read_b128 v[236:239], v247 offset:2048
v_mfma_f32_16x16x32_bf16 v[92:95], v[192:195], v[228:231], v[92:95]
ds_read_b64_tr_b16 v[212:213], v241 offset:16384
ds_read_b64_tr_b16 v[214:215], v241 offset:20480
v_mfma_f32_16x16x32_bf16 v[96:99], v[196:199], v[224:227], v[96:99]
ds_read_b64_tr_b16 v[216:217], v241 offset:16392
v_mfma_f32_16x16x32_bf16 v[100:103], v[196:199], v[228:231], v[100:103]
ds_read_b64_tr_b16 v[218:219], v241 offset:20488
s_waitcnt lgkmcnt(8)
v_mfma_f32_16x16x32_bf16 v[104:107], v[200:203], v[224:227], v[104:107]
ds_read_b64_tr_b16 v[192:193], v241 offset:16400
v_mfma_f32_16x16x32_bf16 v[108:111], v[200:203], v[228:231], v[108:111]
ds_read_b64_tr_b16 v[194:195], v241 offset:20496
v_mfma_f32_16x16x32_bf16 v[112:115], v[204:207], v[224:227], v[112:115]
ds_read_b64_tr_b16 v[196:197], v241 offset:16408
v_mfma_f32_16x16x32_bf16 v[116:119], v[204:207], v[228:231], v[116:119]
ds_read_b64_tr_b16 v[198:199], v241 offset:20504
s_waitcnt lgkmcnt(6)
v_mfma_f32_16x16x32_bf16 v[120:123], v[208:211], v[224:227], v[120:123]
ds_read_b64_tr_b16 v[200:201], v241 offset:16416
v_mfma_f32_16x16x32_bf16 v[124:127], v[208:211], v[228:231], v[124:127]
ds_read_b64_tr_b16 v[202:203], v241 offset:20512
v_mfma_f32_16x16x32_bf16 v[8:11], v[212:215], v[232:235], v[8:11]
ds_read_b64_tr_b16 v[204:205], v249 offset:17664
v_mfma_f32_16x16x32_bf16 v[12:15], v[212:215], v[236:239], v[12:15]
ds_read_b64_tr_b16 v[206:207], v249 offset:21760
s_waitcnt lgkmcnt(6)
v_mfma_f32_16x16x32_bf16 v[16:19], v[216:219], v[232:235], v[16:19]
ds_read_b64_tr_b16 v[208:209], v251 offset:17664
v_mfma_f32_16x16x32_bf16 v[20:23], v[216:219], v[236:239], v[20:23]
ds_read_b64_tr_b16 v[210:211], v251 offset:21760
v_mfma_f32_16x16x32_bf16 v[24:27], v[192:195], v[232:235], v[24:27]
ds_read_b64_tr_b16 v[212:213], v249 offset:17728
v_mfma_f32_16x16x32_bf16 v[28:31], v[192:195], v[236:239], v[28:31]
ds_read_b64_tr_b16 v[214:215], v249 offset:21824
s_waitcnt lgkmcnt(6)
v_mfma_f32_16x16x32_bf16 v[32:35], v[196:199], v[232:235], v[32:35]
ds_read_b64_tr_b16 v[216:217], v251 offset:17728
v_mfma_f32_16x16x32_bf16 v[36:39], v[196:199], v[236:239], v[36:39]
ds_read_b64_tr_b16 v[218:219], v251 offset:21824
v_mfma_f32_16x16x32_bf16 v[40:43], v[200:203], v[232:235], v[40:43]
ds_read_b64_tr_b16 v[192:193], v249 offset:17792
v_mfma_f32_16x16x32_bf16 v[44:47], v[200:203], v[236:239], v[44:47]
ds_read_b64_tr_b16 v[194:195], v249 offset:21888
s_waitcnt lgkmcnt(6)
v_mfma_f32_16x16x32_bf16 v[48:51], v[204:207], v[232:235], v[48:51]
ds_read_b64_tr_b16 v[196:197], v251 offset:17792
v_mfma_f32_16x16x32_bf16 v[52:55], v[204:207], v[236:239], v[52:55]
ds_read_b64_tr_b16 v[198:199], v251 offset:21888
v_mfma_f32_16x16x32_bf16 v[56:59], v[208:211], v[232:235], v[56:59]
ds_read_b64_tr_b16 v[200:201], v249 offset:17856
v_mfma_f32_16x16x32_bf16 v[60:63], v[208:211], v[236:239], v[60:63]
ds_read_b64_tr_b16 v[202:203], v249 offset:21952
s_waitcnt lgkmcnt(6)
v_mfma_f32_16x16x32_bf16 v[64:67], v[212:215], v[232:235], v[64:67]
ds_read_b64_tr_b16 v[204:205], v251 offset:17856
v_mfma_f32_16x16x32_bf16 v[68:71], v[212:215], v[236:239], v[68:71]
ds_read_b64_tr_b16 v[206:207], v251 offset:21952
v_mfma_f32_16x16x32_bf16 v[72:75], v[216:219], v[232:235], v[72:75]
ds_read_b64_tr_b16 v[208:209], v249 offset:17920
v_mfma_f32_16x16x32_bf16 v[76:79], v[216:219], v[236:239], v[76:79]
ds_read_b64_tr_b16 v[210:211], v249 offset:22016
s_waitcnt lgkmcnt(6)
v_mfma_f32_16x16x32_bf16 v[80:83], v[192:195], v[232:235], v[80:83]
ds_read_b64_tr_b16 v[212:213], v251 offset:17920
v_mfma_f32_16x16x32_bf16 v[84:87], v[192:195], v[236:239], v[84:87]
ds_read_b64_tr_b16 v[214:215], v251 offset:22016
v_mfma_f32_16x16x32_bf16 v[88:91], v[196:199], v[232:235], v[88:91]
ds_read_b64_tr_b16 v[140:141], v244 offset:0
ds_read_b64_tr_b16 v[142:143], v244 offset:160
ds_read_b64_tr_b16 v[144:145], v244 offset:320
v_mfma_f32_16x16x32_bf16 v[92:95], v[196:199], v[236:239], v[92:95]
ds_read_b64_tr_b16 v[146:147], v244 offset:480
ds_read_b64_tr_b16 v[148:149], v244 offset:640
s_waitcnt lgkmcnt(9)
v_mfma_f32_16x16x32_bf16 v[96:99], v[200:203], v[232:235], v[96:99]
ds_read_b64_tr_b16 v[150:151], v244 offset:8
ds_read_b64_tr_b16 v[152:153], v244 offset:168
ds_read_b64_tr_b16 v[154:155], v244 offset:328
v_mfma_f32_16x16x32_bf16 v[100:103], v[200:203], v[236:239], v[100:103]
ds_read_b64_tr_b16 v[156:157], v244 offset:488
ds_read_b64_tr_b16 v[158:159], v244 offset:648
v_mfma_f32_16x16x32_bf16 v[104:107], v[204:207], v[232:235], v[104:107]
ds_read_b64_tr_b16 v[160:161], v244 offset:16
s_waitcnt lgkmcnt(10)
ds_read_b64_tr_b16 v[162:163], v244 offset:176
v_mfma_f32_16x16x32_bf16 v[108:111], v[204:207], v[236:239], v[108:111]
ds_read_b64_tr_b16 v[164:165], v244 offset:336
ds_read_b64_tr_b16 v[166:167], v244 offset:496
ds_read_b64_tr_b16 v[168:169], v244 offset:656
v_mfma_f32_16x16x32_bf16 v[112:115], v[208:211], v[232:235], v[112:115]
ds_read_b64_tr_b16 v[170:171], v244 offset:24
s_waitcnt lgkmcnt(10)
ds_read_b64_tr_b16 v[172:173], v244 offset:184
v_mfma_f32_16x16x32_bf16 v[116:119], v[208:211], v[236:239], v[116:119]
ds_read_b64_tr_b16 v[174:175], v244 offset:344
ds_read_b64_tr_b16 v[176:177], v244 offset:504
ds_read_b64_tr_b16 v[178:179], v244 offset:664
v_mfma_f32_16x16x32_bf16 v[120:123], v[212:215], v[232:235], v[120:123]
ds_read_b64_tr_b16 v[180:181], v244 offset:32
s_waitcnt lgkmcnt(10)
ds_read_b64_tr_b16 v[182:183], v244 offset:192
v_mfma_f32_16x16x32_bf16 v[124:127], v[212:215], v[236:239], v[124:127]
ds_read_b64_tr_b16 v[184:185], v244 offset:352
ds_read_b64_tr_b16 v[186:187], v244 offset:512
ds_read_b64_tr_b16 v[188:189], v244 offset:672
s_setprio 2
s_mov_b64 exec, 1
v_mov_b32 v136, 133152
v_mov_b32 v137, 1
ds_add_u32 v136, v137
s_mov_b64 exec, -1
s_mov_b64 exec, 1
v_mov_b32 v136, 133168
v_mov_b32 v137, 1
ds_add_u32 v136, v137
s_mov_b64 exec, -1
v_mov_b32 v128, 3222493025
v_mov_b32 v129, 3222493025
v_pk_mul_f32 v[130:131], v[48:49], v[48:49]
v_pk_mul_f32 v[132:133], v[50:51], v[50:51]
v_pk_mul_f32 v[134:135], v[56:57], v[56:57]
v_pk_mul_f32 v[136:137], v[58:59], v[58:59]
v_pk_fma_f32 v[130:131], v[130:131], s[8:9], v[128:129]
v_pk_fma_f32 v[132:133], v[132:133], s[8:9], v[128:129]
v_pk_fma_f32 v[134:135], v[134:135], s[8:9], v[128:129]
v_pk_fma_f32 v[136:137], v[136:137], s[8:9], v[128:129]
v_pk_mul_f32 v[130:131], v[130:131], v[48:49]
v_pk_mul_f32 v[132:133], v[132:133], v[50:51]
v_pk_mul_f32 v[134:135], v[134:135], v[56:57]
v_pk_mul_f32 v[136:137], v[136:137], v[58:59]
v_exp_f32 v130, v130
v_exp_f32 v131, v131
v_exp_f32 v132, v132
v_exp_f32 v133, v133
v_exp_f32 v134, v134
v_exp_f32 v135, v135
v_exp_f32 v136, v136
v_exp_f32 v137, v137
v_pk_add_f32 v[130:131], v[130:131], 1.0 op_sel_hi:[1,0]
v_pk_add_f32 v[132:133], v[132:133], 1.0 op_sel_hi:[1,0]
v_pk_add_f32 v[134:135], v[134:135], 1.0 op_sel_hi:[1,0]
v_pk_add_f32 v[136:137], v[136:137], 1.0 op_sel_hi:[1,0]
v_rcp_f32 v130, v130
v_rcp_f32 v131, v131
v_rcp_f32 v132, v132
v_rcp_f32 v133, v133
v_rcp_f32 v134, v134
v_rcp_f32 v135, v135
v_rcp_f32 v136, v136
v_rcp_f32 v137, v137
v_pk_mul_f32 v[130:131], v[130:131], v[48:49]
v_pk_mul_f32 v[132:133], v[132:133], v[50:51]
v_pk_mul_f32 v[134:135], v[134:135], v[56:57]
v_pk_mul_f32 v[136:137], v[136:137], v[58:59]
v_cvt_pk_bf16_f32 v212, v130, v131
v_cvt_pk_bf16_f32 v213, v132, v133
v_cvt_pk_bf16_f32 v214, v134, v135
v_cvt_pk_bf16_f32 v215, v136, v137
buffer_store_dwordx4 v[212:215], v243, s[48:51], s12 offen offset:0 sc1
v_pk_mul_f32 v[130:131], v[52:53], v[52:53]
v_pk_mul_f32 v[132:133], v[54:55], v[54:55]
v_pk_mul_f32 v[134:135], v[60:61], v[60:61]
v_pk_mul_f32 v[136:137], v[62:63], v[62:63]
v_pk_fma_f32 v[130:131], v[130:131], s[8:9], v[128:129]
v_pk_fma_f32 v[132:133], v[132:133], s[8:9], v[128:129]
v_pk_fma_f32 v[134:135], v[134:135], s[8:9], v[128:129]
v_pk_fma_f32 v[136:137], v[136:137], s[8:9], v[128:129]
v_pk_mul_f32 v[130:131], v[130:131], v[52:53]
v_pk_mul_f32 v[132:133], v[132:133], v[54:55]
v_pk_mul_f32 v[134:135], v[134:135], v[60:61]
v_pk_mul_f32 v[136:137], v[136:137], v[62:63]
v_exp_f32 v130, v130
v_exp_f32 v131, v131
v_exp_f32 v132, v132
v_exp_f32 v133, v133
v_exp_f32 v134, v134
v_exp_f32 v135, v135
v_exp_f32 v136, v136
v_exp_f32 v137, v137
v_pk_add_f32 v[130:131], v[130:131], 1.0 op_sel_hi:[1,0]
v_pk_add_f32 v[132:133], v[132:133], 1.0 op_sel_hi:[1,0]
v_pk_add_f32 v[134:135], v[134:135], 1.0 op_sel_hi:[1,0]
v_pk_add_f32 v[136:137], v[136:137], 1.0 op_sel_hi:[1,0]
v_rcp_f32 v130, v130
v_rcp_f32 v131, v131
v_rcp_f32 v132, v132
v_rcp_f32 v133, v133
v_rcp_f32 v134, v134
v_rcp_f32 v135, v135
v_rcp_f32 v136, v136
v_rcp_f32 v137, v137
v_pk_mul_f32 v[130:131], v[130:131], v[52:53]
v_pk_mul_f32 v[132:133], v[132:133], v[54:55]
v_pk_mul_f32 v[134:135], v[134:135], v[60:61]
v_pk_mul_f32 v[136:137], v[136:137], v[62:63]
v_cvt_pk_bf16_f32 v216, v130, v131
v_cvt_pk_bf16_f32 v217, v132, v133
v_cvt_pk_bf16_f32 v218, v134, v135
v_cvt_pk_bf16_f32 v219, v136, v137
buffer_store_dwordx4 v[216:219], v243, s[48:51], s12 offen offset:1024 sc1
s_add_u32 s12, s12, 4096
v_pk_mul_f32 v[130:131], v[64:65], v[64:65]
v_pk_mul_f32 v[132:133], v[66:67], v[66:67]
v_pk_mul_f32 v[134:135], v[72:73], v[72:73]
v_pk_mul_f32 v[136:137], v[74:75], v[74:75]
v_pk_fma_f32 v[130:131], v[130:131], s[8:9], v[128:129]
v_pk_fma_f32 v[132:133], v[132:133], s[8:9], v[128:129]
v_pk_fma_f32 v[134:135], v[134:135], s[8:9], v[128:129]
v_pk_fma_f32 v[136:137], v[136:137], s[8:9], v[128:129]
v_pk_mul_f32 v[130:131], v[130:131], v[64:65]
v_pk_mul_f32 v[132:133], v[132:133], v[66:67]
v_pk_mul_f32 v[134:135], v[134:135], v[72:73]
v_pk_mul_f32 v[136:137], v[136:137], v[74:75]
v_exp_f32 v130, v130
v_exp_f32 v131, v131
v_exp_f32 v132, v132
v_exp_f32 v133, v133
v_exp_f32 v134, v134
v_exp_f32 v135, v135
v_exp_f32 v136, v136
v_exp_f32 v137, v137
v_pk_add_f32 v[130:131], v[130:131], 1.0 op_sel_hi:[1,0]
v_pk_add_f32 v[132:133], v[132:133], 1.0 op_sel_hi:[1,0]
v_pk_add_f32 v[134:135], v[134:135], 1.0 op_sel_hi:[1,0]
v_pk_add_f32 v[136:137], v[136:137], 1.0 op_sel_hi:[1,0]
v_rcp_f32 v130, v130
v_rcp_f32 v131, v131
v_rcp_f32 v132, v132
v_rcp_f32 v133, v133
v_rcp_f32 v134, v134
v_rcp_f32 v135, v135
v_rcp_f32 v136, v136
v_rcp_f32 v137, v137
v_pk_mul_f32 v[130:131], v[130:131], v[64:65]
v_pk_mul_f32 v[132:133], v[132:133], v[66:67]
v_pk_mul_f32 v[134:135], v[134:135], v[72:73]
v_pk_mul_f32 v[136:137], v[136:137], v[74:75]
v_cvt_pk_bf16_f32 v220, v130, v131
v_cvt_pk_bf16_f32 v221, v132, v133
v_cvt_pk_bf16_f32 v222, v134, v135
v_cvt_pk_bf16_f32 v223, v136, v137
buffer_store_dwordx4 v[220:223], v243, s[48:51], s12 offen offset:0 sc1
v_pk_mul_f32 v[130:131], v[68:69], v[68:69]
v_pk_mul_f32 v[132:133], v[70:71], v[70:71]
v_pk_mul_f32 v[134:135], v[76:77], v[76:77]
v_pk_mul_f32 v[136:137], v[78:79], v[78:79]
v_pk_fma_f32 v[130:131], v[130:131], s[8:9], v[128:129]
v_pk_fma_f32 v[132:133], v[132:133], s[8:9], v[128:129]
v_pk_fma_f32 v[134:135], v[134:135], s[8:9], v[128:129]
v_pk_fma_f32 v[136:137], v[136:137], s[8:9], v[128:129]
v_pk_mul_f32 v[130:131], v[130:131], v[68:69]
v_pk_mul_f32 v[132:133], v[132:133], v[70:71]
v_pk_mul_f32 v[134:135], v[134:135], v[76:77]
v_pk_mul_f32 v[136:137], v[136:137], v[78:79]
v_exp_f32 v130, v130
v_exp_f32 v131, v131
v_exp_f32 v132, v132
v_exp_f32 v133, v133
v_exp_f32 v134, v134
v_exp_f32 v135, v135
v_exp_f32 v136, v136
v_exp_f32 v137, v137
v_pk_add_f32 v[130:131], v[130:131], 1.0 op_sel_hi:[1,0]
v_pk_add_f32 v[132:133], v[132:133], 1.0 op_sel_hi:[1,0]
v_pk_add_f32 v[134:135], v[134:135], 1.0 op_sel_hi:[1,0]
v_pk_add_f32 v[136:137], v[136:137], 1.0 op_sel_hi:[1,0]
v_rcp_f32 v130, v130
v_rcp_f32 v131, v131
v_rcp_f32 v132, v132
v_rcp_f32 v133, v133
v_rcp_f32 v134, v134
v_rcp_f32 v135, v135
v_rcp_f32 v136, v136
v_rcp_f32 v137, v137
v_pk_mul_f32 v[130:131], v[130:131], v[68:69]
v_pk_mul_f32 v[132:133], v[132:133], v[70:71]
v_pk_mul_f32 v[134:135], v[134:135], v[76:77]
v_pk_mul_f32 v[136:137], v[136:137], v[78:79]
v_cvt_pk_bf16_f32 v224, v130, v131
v_cvt_pk_bf16_f32 v225, v132, v133
v_cvt_pk_bf16_f32 v226, v134, v135
v_cvt_pk_bf16_f32 v227, v136, v137
buffer_store_dwordx4 v[224:227], v243, s[48:51], s12 offen offset:1024 sc1
s_add_u32 s12, s12, 4096
v_pk_mul_f32 v[130:131], v[80:81], v[80:81]
v_pk_mul_f32 v[132:133], v[82:83], v[82:83]
v_pk_mul_f32 v[134:135], v[88:89], v[88:89]
v_pk_mul_f32 v[136:137], v[90:91], v[90:91]
v_pk_fma_f32 v[130:131], v[130:131], s[8:9], v[128:129]
v_pk_fma_f32 v[132:133], v[132:133], s[8:9], v[128:129]
v_pk_fma_f32 v[134:135], v[134:135], s[8:9], v[128:129]
v_pk_fma_f32 v[136:137], v[136:137], s[8:9], v[128:129]
v_pk_mul_f32 v[130:131], v[130:131], v[80:81]
v_pk_mul_f32 v[132:133], v[132:133], v[82:83]
v_pk_mul_f32 v[134:135], v[134:135], v[88:89]
v_pk_mul_f32 v[136:137], v[136:137], v[90:91]
v_exp_f32 v130, v130
v_exp_f32 v131, v131
v_exp_f32 v132, v132
v_exp_f32 v133, v133
v_exp_f32 v134, v134
v_exp_f32 v135, v135
v_exp_f32 v136, v136
v_exp_f32 v137, v137
v_pk_add_f32 v[130:131], v[130:131], 1.0 op_sel_hi:[1,0]
v_pk_add_f32 v[132:133], v[132:133], 1.0 op_sel_hi:[1,0]
v_pk_add_f32 v[134:135], v[134:135], 1.0 op_sel_hi:[1,0]
v_pk_add_f32 v[136:137], v[136:137], 1.0 op_sel_hi:[1,0]
v_rcp_f32 v130, v130
v_rcp_f32 v131, v131
v_rcp_f32 v132, v132
v_rcp_f32 v133, v133
v_rcp_f32 v134, v134
v_rcp_f32 v135, v135
v_rcp_f32 v136, v136
v_rcp_f32 v137, v137
v_pk_mul_f32 v[130:131], v[130:131], v[80:81]
v_pk_mul_f32 v[132:133], v[132:133], v[82:83]
v_pk_mul_f32 v[134:135], v[134:135], v[88:89]
v_pk_mul_f32 v[136:137], v[136:137], v[90:91]
v_cvt_pk_bf16_f32 v212, v130, v131
v_cvt_pk_bf16_f32 v213, v132, v133
v_cvt_pk_bf16_f32 v214, v134, v135
v_cvt_pk_bf16_f32 v215, v136, v137
buffer_store_dwordx4 v[212:215], v243, s[48:51], s12 offen offset:0 sc1
v_pk_mul_f32 v[130:131], v[84:85], v[84:85]
v_pk_mul_f32 v[132:133], v[86:87], v[86:87]
v_pk_mul_f32 v[134:135], v[92:93], v[92:93]
v_pk_mul_f32 v[136:137], v[94:95], v[94:95]
v_pk_fma_f32 v[130:131], v[130:131], s[8:9], v[128:129]
v_pk_fma_f32 v[132:133], v[132:133], s[8:9], v[128:129]
v_pk_fma_f32 v[134:135], v[134:135], s[8:9], v[128:129]
v_pk_fma_f32 v[136:137], v[136:137], s[8:9], v[128:129]
v_pk_mul_f32 v[130:131], v[130:131], v[84:85]
v_pk_mul_f32 v[132:133], v[132:133], v[86:87]
v_pk_mul_f32 v[134:135], v[134:135], v[92:93]
v_pk_mul_f32 v[136:137], v[136:137], v[94:95]
v_exp_f32 v130, v130
v_exp_f32 v131, v131
v_exp_f32 v132, v132
v_exp_f32 v133, v133
v_exp_f32 v134, v134
v_exp_f32 v135, v135
v_exp_f32 v136, v136
v_exp_f32 v137, v137
v_pk_add_f32 v[130:131], v[130:131], 1.0 op_sel_hi:[1,0]
v_pk_add_f32 v[132:133], v[132:133], 1.0 op_sel_hi:[1,0]
v_pk_add_f32 v[134:135], v[134:135], 1.0 op_sel_hi:[1,0]
v_pk_add_f32 v[136:137], v[136:137], 1.0 op_sel_hi:[1,0]
v_rcp_f32 v130, v130
v_rcp_f32 v131, v131
v_rcp_f32 v132, v132
v_rcp_f32 v133, v133
v_rcp_f32 v134, v134
v_rcp_f32 v135, v135
v_rcp_f32 v136, v136
v_rcp_f32 v137, v137
v_pk_mul_f32 v[130:131], v[130:131], v[84:85]
v_pk_mul_f32 v[132:133], v[132:133], v[86:87]
v_pk_mul_f32 v[134:135], v[134:135], v[92:93]
v_pk_mul_f32 v[136:137], v[136:137], v[94:95]
v_cvt_pk_bf16_f32 v216, v130, v131
v_cvt_pk_bf16_f32 v217, v132, v133
v_cvt_pk_bf16_f32 v218, v134, v135
v_cvt_pk_bf16_f32 v219, v136, v137
buffer_store_dwordx4 v[216:219], v243, s[48:51], s12 offen offset:1024 sc1
s_add_u32 s12, s12, 4096
s_cmp_eq_u32 s61, 7
s_cbranch_scc1 L_hskip_36
v_pk_mul_f32 v[130:131], v[96:97], v[96:97]
v_pk_mul_f32 v[132:133], v[98:99], v[98:99]
v_pk_mul_f32 v[134:135], v[104:105], v[104:105]
v_pk_mul_f32 v[136:137], v[106:107], v[106:107]
v_pk_fma_f32 v[130:131], v[130:131], s[8:9], v[128:129]
v_pk_fma_f32 v[132:133], v[132:133], s[8:9], v[128:129]
v_pk_fma_f32 v[134:135], v[134:135], s[8:9], v[128:129]
v_pk_fma_f32 v[136:137], v[136:137], s[8:9], v[128:129]
v_pk_mul_f32 v[130:131], v[130:131], v[96:97]
v_pk_mul_f32 v[132:133], v[132:133], v[98:99]
v_pk_mul_f32 v[134:135], v[134:135], v[104:105]
v_pk_mul_f32 v[136:137], v[136:137], v[106:107]
v_exp_f32 v130, v130
v_exp_f32 v131, v131
v_exp_f32 v132, v132
v_exp_f32 v133, v133
v_exp_f32 v134, v134
v_exp_f32 v135, v135
v_exp_f32 v136, v136
v_exp_f32 v137, v137
v_pk_add_f32 v[130:131], v[130:131], 1.0 op_sel_hi:[1,0]
v_pk_add_f32 v[132:133], v[132:133], 1.0 op_sel_hi:[1,0]
v_pk_add_f32 v[134:135], v[134:135], 1.0 op_sel_hi:[1,0]
v_pk_add_f32 v[136:137], v[136:137], 1.0 op_sel_hi:[1,0]
v_rcp_f32 v130, v130
v_rcp_f32 v131, v131
v_rcp_f32 v132, v132
v_rcp_f32 v133, v133
v_rcp_f32 v134, v134
v_rcp_f32 v135, v135
v_rcp_f32 v136, v136
v_rcp_f32 v137, v137
v_pk_mul_f32 v[130:131], v[130:131], v[96:97]
v_pk_mul_f32 v[132:133], v[132:133], v[98:99]
v_pk_mul_f32 v[134:135], v[134:135], v[104:105]
v_pk_mul_f32 v[136:137], v[136:137], v[106:107]
v_cvt_pk_bf16_f32 v220, v130, v131
v_cvt_pk_bf16_f32 v221, v132, v133
v_cvt_pk_bf16_f32 v222, v134, v135
v_cvt_pk_bf16_f32 v223, v136, v137
buffer_store_dwordx4 v[220:223], v243, s[48:51], s12 offen offset:0 sc1
v_pk_mul_f32 v[130:131], v[100:101], v[100:101]
v_pk_mul_f32 v[132:133], v[102:103], v[102:103]
v_pk_mul_f32 v[134:135], v[108:109], v[108:109]
v_pk_mul_f32 v[136:137], v[110:111], v[110:111]
v_pk_fma_f32 v[130:131], v[130:131], s[8:9], v[128:129]
v_pk_fma_f32 v[132:133], v[132:133], s[8:9], v[128:129]
v_pk_fma_f32 v[134:135], v[134:135], s[8:9], v[128:129]
v_pk_fma_f32 v[136:137], v[136:137], s[8:9], v[128:129]
v_pk_mul_f32 v[130:131], v[130:131], v[100:101]
v_pk_mul_f32 v[132:133], v[132:133], v[102:103]
v_pk_mul_f32 v[134:135], v[134:135], v[108:109]
v_pk_mul_f32 v[136:137], v[136:137], v[110:111]
v_exp_f32 v130, v130
v_exp_f32 v131, v131
v_exp_f32 v132, v132
v_exp_f32 v133, v133
v_exp_f32 v134, v134
v_exp_f32 v135, v135
v_exp_f32 v136, v136
v_exp_f32 v137, v137
v_pk_add_f32 v[130:131], v[130:131], 1.0 op_sel_hi:[1,0]
v_pk_add_f32 v[132:133], v[132:133], 1.0 op_sel_hi:[1,0]
v_pk_add_f32 v[134:135], v[134:135], 1.0 op_sel_hi:[1,0]
v_pk_add_f32 v[136:137], v[136:137], 1.0 op_sel_hi:[1,0]
v_rcp_f32 v130, v130
v_rcp_f32 v131, v131
v_rcp_f32 v132, v132
v_rcp_f32 v133, v133
v_rcp_f32 v134, v134
v_rcp_f32 v135, v135
v_rcp_f32 v136, v136
v_rcp_f32 v137, v137
v_pk_mul_f32 v[130:131], v[130:131], v[100:101]
v_pk_mul_f32 v[132:133], v[132:133], v[102:103]
v_pk_mul_f32 v[134:135], v[134:135], v[108:109]
v_pk_mul_f32 v[136:137], v[136:137], v[110:111]
v_cvt_pk_bf16_f32 v224, v130, v131
v_cvt_pk_bf16_f32 v225, v132, v133
v_cvt_pk_bf16_f32 v226, v134, v135
v_cvt_pk_bf16_f32 v227, v136, v137
buffer_store_dwordx4 v[224:227], v243, s[48:51], s12 offen offset:1024 sc1
s_add_u32 s12, s12, 4096
v_pk_mul_f32 v[130:131], v[112:113], v[112:113]
v_pk_mul_f32 v[132:133], v[114:115], v[114:115]
v_pk_mul_f32 v[134:135], v[120:121], v[120:121]
v_pk_mul_f32 v[136:137], v[122:123], v[122:123]
v_pk_fma_f32 v[130:131], v[130:131], s[8:9], v[128:129]
v_pk_fma_f32 v[132:133], v[132:133], s[8:9], v[128:129]
v_pk_fma_f32 v[134:135], v[134:135], s[8:9], v[128:129]
v_pk_fma_f32 v[136:137], v[136:137], s[8:9], v[128:129]
v_pk_mul_f32 v[130:131], v[130:131], v[112:113]
v_pk_mul_f32 v[132:133], v[132:133], v[114:115]
v_pk_mul_f32 v[134:135], v[134:135], v[120:121]
v_pk_mul_f32 v[136:137], v[136:137], v[122:123]
v_exp_f32 v130, v130
v_exp_f32 v131, v131
v_exp_f32 v132, v132
v_exp_f32 v133, v133
v_exp_f32 v134, v134
v_exp_f32 v135, v135
v_exp_f32 v136, v136
v_exp_f32 v137, v137
v_pk_add_f32 v[130:131], v[130:131], 1.0 op_sel_hi:[1,0]
v_pk_add_f32 v[132:133], v[132:133], 1.0 op_sel_hi:[1,0]
v_pk_add_f32 v[134:135], v[134:135], 1.0 op_sel_hi:[1,0]
v_pk_add_f32 v[136:137], v[136:137], 1.0 op_sel_hi:[1,0]
v_rcp_f32 v130, v130
v_rcp_f32 v131, v131
v_rcp_f32 v132, v132
v_rcp_f32 v133, v133
v_rcp_f32 v134, v134
v_rcp_f32 v135, v135
v_rcp_f32 v136, v136
v_rcp_f32 v137, v137
v_pk_mul_f32 v[130:131], v[130:131], v[112:113]
v_pk_mul_f32 v[132:133], v[132:133], v[114:115]
v_pk_mul_f32 v[134:135], v[134:135], v[120:121]
v_pk_mul_f32 v[136:137], v[136:137], v[122:123]
v_cvt_pk_bf16_f32 v212, v130, v131
v_cvt_pk_bf16_f32 v213, v132, v133
v_cvt_pk_bf16_f32 v214, v134, v135
v_cvt_pk_bf16_f32 v215, v136, v137
buffer_store_dwordx4 v[212:215], v243, s[48:51], s12 offen offset:0 sc1
v_pk_mul_f32 v[130:131], v[116:117], v[116:117]
v_pk_mul_f32 v[132:133], v[118:119], v[118:119]
v_pk_mul_f32 v[134:135], v[124:125], v[124:125]
v_pk_mul_f32 v[136:137], v[126:127], v[126:127]
v_pk_fma_f32 v[130:131], v[130:131], s[8:9], v[128:129]
v_pk_fma_f32 v[132:133], v[132:133], s[8:9], v[128:129]
v_pk_fma_f32 v[134:135], v[134:135], s[8:9], v[128:129]
v_pk_fma_f32 v[136:137], v[136:137], s[8:9], v[128:129]
v_pk_mul_f32 v[130:131], v[130:131], v[116:117]
v_pk_mul_f32 v[132:133], v[132:133], v[118:119]
v_pk_mul_f32 v[134:135], v[134:135], v[124:125]
v_pk_mul_f32 v[136:137], v[136:137], v[126:127]
v_exp_f32 v130, v130
v_exp_f32 v131, v131
v_exp_f32 v132, v132
v_exp_f32 v133, v133
v_exp_f32 v134, v134
v_exp_f32 v135, v135
v_exp_f32 v136, v136
v_exp_f32 v137, v137
v_pk_add_f32 v[130:131], v[130:131], 1.0 op_sel_hi:[1,0]
v_pk_add_f32 v[132:133], v[132:133], 1.0 op_sel_hi:[1,0]
v_pk_add_f32 v[134:135], v[134:135], 1.0 op_sel_hi:[1,0]
v_pk_add_f32 v[136:137], v[136:137], 1.0 op_sel_hi:[1,0]
v_rcp_f32 v130, v130
v_rcp_f32 v131, v131
v_rcp_f32 v132, v132
v_rcp_f32 v133, v133
v_rcp_f32 v134, v134
v_rcp_f32 v135, v135
v_rcp_f32 v136, v136
v_rcp_f32 v137, v137
v_pk_mul_f32 v[130:131], v[130:131], v[116:117]
v_pk_mul_f32 v[132:133], v[132:133], v[118:119]
v_pk_mul_f32 v[134:135], v[134:135], v[124:125]
v_pk_mul_f32 v[136:137], v[136:137], v[126:127]
v_cvt_pk_bf16_f32 v216, v130, v131
v_cvt_pk_bf16_f32 v217, v132, v133
v_cvt_pk_bf16_f32 v218, v134, v135
v_cvt_pk_bf16_f32 v219, v136, v137
buffer_store_dwordx4 v[216:219], v243, s[48:51], s12 offen offset:1024 sc1
s_add_u32 s12, s12, 4096
L_hskip_36:
v_cvt_pk_bf16_f32 v192, v8, v9
v_cvt_pk_bf16_f32 v193, v10, v11
v_cvt_pk_bf16_f32 v194, v16, v17
v_cvt_pk_bf16_f32 v195, v18, v19
v_cvt_pk_bf16_f32 v196, v24, v25
v_cvt_pk_bf16_f32 v197, v26, v27
v_cvt_pk_bf16_f32 v198, v32, v33
v_cvt_pk_bf16_f32 v199, v34, v35
v_cvt_pk_bf16_f32 v200, v40, v41
v_cvt_pk_bf16_f32 v201, v42, v43
v_cvt_pk_bf16_f32 v202, v12, v13
v_cvt_pk_bf16_f32 v203, v14, v15
v_cvt_pk_bf16_f32 v204, v20, v21
v_cvt_pk_bf16_f32 v205, v22, v23
v_cvt_pk_bf16_f32 v206, v28, v29
v_cvt_pk_bf16_f32 v207, v30, v31
v_cvt_pk_bf16_f32 v208, v36, v37
v_cvt_pk_bf16_f32 v209, v38, v39
v_cvt_pk_bf16_f32 v210, v44, v45
v_cvt_pk_bf16_f32 v211, v46, v47
s_waitcnt lgkmcnt(0)
v_mfma_f32_16x16x32_bf16 v[88:91], v[140:143], v[192:195], 0
v_mul_u32_u24 v68, 2080, v1
v_add_u32 v68, 133440, v68
v_mfma_f32_16x16x32_bf16 v[92:95], v[150:153], v[192:195], 0
v_cmp_eq_u32 vcc, v1, v2
v_lshl_add_u32 v69, v3, 3, v68
v_mfma_f32_16x16x32_bf16 v[96:99], v[160:163], v[192:195], 0
v_mov_b32 v70, 131072
v_cndmask_b32 v240, v70, v69, vcc
v_mfma_f32_16x16x32_bf16 v[100:103], v[170:173], v[192:195], 0
v_cndmask_b32 v239, v70, v68, vcc
v_and_b32 v241, 15, v0
v_mfma_f32_16x16x32_bf16 v[104:107], v[180:183], v[192:195], 0
v_lshlrev_b32 v241, 2, v241
v_mfma_f32_16x16x32_bf16 v[108:111], v[140:143], v[202:205], 0
v_mfma_f32_16x16x32_bf16 v[112:115], v[150:153], v[202:205], 0
v_mfma_f32_16x16x32_bf16 v[116:119], v[160:163], v[202:205], 0
v_mfma_f32_16x16x32_bf16 v[120:123], v[170:173], v[202:205], 0
v_mfma_f32_16x16x32_bf16 v[124:127], v[180:183], v[202:205], 0
v_mfma_f32_16x16x32_bf16 v[88:91], v[144:147], v[196:199], v[88:91]
v_mfma_f32_16x16x32_bf16 v[92:95], v[154:157], v[196:199], v[92:95]
v_mfma_f32_16x16x32_bf16 v[96:99], v[164:167], v[196:199], v[96:99]
v_mfma_f32_16x16x32_bf16 v[100:103], v[174:177], v[196:199], v[100:103]
v_mfma_f32_16x16x32_bf16 v[104:107], v[184:187], v[196:199], v[104:107]
v_mfma_f32_16x16x32_bf16 v[108:111], v[144:147], v[206:209], v[108:111]
v_mfma_f32_16x16x32_bf16 v[112:115], v[154:157], v[206:209], v[112:115]
v_mfma_f32_16x16x32_bf16 v[116:119], v[164:167], v[206:209], v[116:119]
v_mfma_f32_16x16x32_bf16 v[120:123], v[174:177], v[206:209], v[120:123]
v_mfma_f32_16x16x32_bf16 v[124:127], v[184:187], v[206:209], v[124:127]
v_mfma_f32_16x16x16_bf16 v[88:91], v[148:149], v[200:201], v[88:91]
v_mfma_f32_16x16x16_bf16 v[92:95], v[158:159], v[200:201], v[92:95]
v_mfma_f32_16x16x16_bf16 v[96:99], v[168:169], v[200:201], v[96:99]
v_mfma_f32_16x16x16_bf16 v[100:103], v[178:179], v[200:201], v[100:103]
v_mfma_f32_16x16x16_bf16 v[104:107], v[188:189], v[200:201], v[104:107]
v_mfma_f32_16x16x16_bf16 v[108:111], v[148:149], v[210:211], v[108:111]
v_mfma_f32_16x16x16_bf16 v[112:115], v[158:159], v[210:211], v[112:115]
v_mfma_f32_16x16x16_bf16 v[116:119], v[168:169], v[210:211], v[116:119]
v_mfma_f32_16x16x16_bf16 v[120:123], v[178:179], v[210:211], v[120:123]
v_mfma_f32_16x16x16_bf16 v[124:127], v[188:189], v[210:211], v[124:127]
s_waitcnt lgkmcnt(0)
s_mul_i32 s20, s65, 2048
s_add_u32 s20, s20, s72
s_addc_u32 s21, s73, 0
s_mov_b32 s16, 1
s_mov_b32 s17, 1
s_mov_b32 s18, 1
s_mov_b32 s19, 1
s_waitcnt vmcnt(0)
s_waitcnt lgkmcnt(0)
s_mov_b64 exec, 1
v_mov_b32 v136, 133120
v_mov_b32 v137, 1
ds_add_u32 v136, v137
s_mov_b32 s79, 0
L_ls_37:
ds_read_b32 v137, v136
s_waitcnt lgkmcnt(0)
v_readfirstlane_b32 s78, v137
s_add_u32 s79, s79, 1
s_cmp_ge_u32 s79, 0x1000000
s_cbranch_scc1 L_end
s_cmp_lt_u32 s78, 4
s_cbranch_scc1 L_ls_37
s_mov_b64 exec, -1
s_atomic_add s16, s[20:21], 0 glc
s_atomic_add s17, s[20:21], 512 glc
s_atomic_add s18, s[20:21], 1024 glc
s_atomic_add s19, s[20:21], 1536 glc
v_max3_f32 v128, v88, v89, v90
v_min3_f32 v130, v88, v89, v90
v_max3_f32 v128, v128, v91, v92
v_min3_f32 v130, v130, v91, v92
v_max3_f32 v128, v128, v93, v94
v_min3_f32 v130, v130, v93, v94
v_max3_f32 v128, v128, v95, v96
v_min3_f32 v130, v130, v95, v96
v_max3_f32 v128, v128, v97, v98
v_min3_f32 v130, v130, v97, v98
v_max3_f32 v128, v128, v99, v100
v_min3_f32 v130, v130, v99, v100
v_max3_f32 v128, v128, v101, v102
v_min3_f32 v130, v130, v101, v102
v_max3_f32 v128, v128, v103, v104
v_min3_f32 v130, v130, v103, v104
v_max3_f32 v128, v128, v105, v106
v_min3_f32 v130, v130, v105, v106
v_max_f32 v128, v128, v107
v_min_f32 v130, v130, v107
v_mul_f32 v128, s10, v128
v_mul_f32 v130, s10, v130
v_pk_fma_f32 v[48:49], v[88:89], s[10:11], v[128:129] op_sel_hi:[1,1,0] neg_lo:[0,0,1] neg_hi:[0,0,1]
v_pk_fma_f32 v[88:89], v[88:89], s[10:11], v[130:131] op_sel_hi:[1,1,0] neg_lo:[1,0,0] neg_hi:[1,0,0]
v_pk_fma_f32 v[50:51], v[90:91], s[10:11], v[128:129] op_sel_hi:[1,1,0] neg_lo:[0,0,1] neg_hi:[0,0,1]
v_pk_fma_f32 v[90:91], v[90:91], s[10:11], v[130:131] op_sel_hi:[1,1,0] neg_lo:[1,0,0] neg_hi:[1,0,0]
v_pk_fma_f32 v[52:53], v[92:93], s[10:11], v[128:129] op_sel_hi:[1,1,0] neg_lo:[0,0,1] neg_hi:[0,0,1]
v_pk_fma_f32 v[92:93], v[92:93], s[10:11], v[130:131] op_sel_hi:[1,1,0] neg_lo:[1,0,0] neg_hi:[1,0,0]
v_pk_fma_f32 v[54:55], v[94:95], s[10:11], v[128:129] op_sel_hi:[1,1,0] neg_lo:[0,0,1] neg_hi:[0,0,1]
v_pk_fma_f32 v[94:95], v[94:95], s[10:11], v[130:131] op_sel_hi:[1,1,0] neg_lo:[1,0,0] neg_hi:[1,0,0]
v_pk_fma_f32 v[56:57], v[96:97], s[10:11], v[128:129] op_sel_hi:[1,1,0] neg_lo:[0,0,1] neg_hi:[0,0,1]
v_pk_fma_f32 v[96:97], v[96:97], s[10:11], v[130:131] op_sel_hi:[1,1,0] neg_lo:[1,0,0] neg_hi:[1,0,0]
v_pk_fma_f32 v[58:59], v[98:99], s[10:11], v[128:129] op_sel_hi:[1,1,0] neg_lo:[0,0,1] neg_hi:[0,0,1]
v_pk_fma_f32 v[98:99], v[98:99], s[10:11], v[130:131] op_sel_hi:[1,1,0] neg_lo:[1,0,0] neg_hi:[1,0,0]
v_pk_fma_f32 v[60:61], v[100:101], s[10:11], v[128:129] op_sel_hi:[1,1,0] neg_lo:[0,0,1] neg_hi:[0,0,1]
v_pk_fma_f32 v[100:101], v[100:101], s[10:11], v[130:131] op_sel_hi:[1,1,0] neg_lo:[1,0,0] neg_hi:[1,0,0]
v_pk_fma_f32 v[62:63], v[102:103], s[10:11], v[128:129] op_sel_hi:[1,1,0] neg_lo:[0,0,1] neg_hi:[0,0,1]
v_pk_fma_f32 v[102:103], v[102:103], s[10:11], v[130:131] op_sel_hi:[1,1,0] neg_lo:[1,0,0] neg_hi:[1,0,0]
v_pk_fma_f32 v[64:65], v[104:105], s[10:11], v[128:129] op_sel_hi:[1,1,0] neg_lo:[0,0,1] neg_hi:[0,0,1]
v_pk_fma_f32 v[104:105], v[104:105], s[10:11], v[130:131] op_sel_hi:[1,1,0] neg_lo:[1,0,0] neg_hi:[1,0,0]
v_pk_fma_f32 v[66:67], v[106:107], s[10:11], v[128:129] op_sel_hi:[1,1,0] neg_lo:[0,0,1] neg_hi:[0,0,1]
v_pk_fma_f32 v[106:107], v[106:107], s[10:11], v[130:131] op_sel_hi:[1,1,0] neg_lo:[1,0,0] neg_hi:[1,0,0]
v_exp_f32 v48, v48
v_exp_f32 v88, v88
v_exp_f32 v49, v49
v_exp_f32 v89, v89
v_exp_f32 v50, v50
v_exp_f32 v90, v90
v_exp_f32 v51, v51
v_exp_f32 v91, v91
v_exp_f32 v52, v52
v_exp_f32 v92, v92
v_exp_f32 v53, v53
v_exp_f32 v93, v93
v_exp_f32 v54, v54
v_exp_f32 v94, v94
v_exp_f32 v55, v55
v_exp_f32 v95, v95
v_exp_f32 v56, v56
v_exp_f32 v96, v96
v_exp_f32 v57, v57
v_exp_f32 v97, v97
v_exp_f32 v58, v58
v_exp_f32 v98, v98
v_exp_f32 v59, v59
v_exp_f32 v99, v99
v_exp_f32 v60, v60
v_exp_f32 v100, v100
v_exp_f32 v61, v61
v_exp_f32 v101, v101
v_exp_f32 v62, v62
v_exp_f32 v102, v102
v_exp_f32 v63, v63
v_exp_f32 v103, v103
v_exp_f32 v64, v64
v_exp_f32 v104, v104
v_exp_f32 v65, v65
v_exp_f32 v105, v105
v_exp_f32 v66, v66
v_exp_f32 v106, v106
v_exp_f32 v67, v67
v_exp_f32 v107, v107
v_pk_add_f32 v[132:133], v[48:49], v[50:51]
v_pk_add_f32 v[134:135], v[88:89], v[90:91]
v_pk_add_f32 v[132:133], v[132:133], v[52:53]
v_pk_add_f32 v[134:135], v[134:135], v[92:93]
v_pk_add_f32 v[132:133], v[132:133], v[54:55]
v_pk_add_f32 v[134:135], v[134:135], v[94:95]
v_pk_add_f32 v[132:133], v[132:133], v[56:57]
v_pk_add_f32 v[134:135], v[134:135], v[96:97]
v_pk_add_f32 v[132:133], v[132:133], v[58:59]
v_pk_add_f32 v[134:135], v[134:135], v[98:99]
v_pk_add_f32 v[132:133], v[132:133], v[60:61]
v_pk_add_f32 v[134:135], v[134:135], v[100:101]
v_pk_add_f32 v[132:133], v[132:133], v[62:63]
v_pk_add_f32 v[134:135], v[134:135], v[102:103]
v_pk_add_f32 v[132:133], v[132:133], v[64:65]
v_pk_add_f32 v[134:135], v[134:135], v[104:105]
v_pk_add_f32 v[132:133], v[132:133], v[66:67]
v_pk_add_f32 v[134:135], v[134:135], v[106:107]
v_add_f32 v132, v132, v133
v_add_f32 v134, v134, v135
v_rcp_f32 v132, v132
v_rcp_f32 v134, v134
v_pk_mul_f32 v[48:49], v[48:49], v[132:133] op_sel_hi:[1,0]
v_pk_mul_f32 v[50:51], v[50:51], v[132:133] op_sel_hi:[1,0]
v_cvt_pk_bf16_f32 v192, v48, v49
v_pk_mul_f32 v[52:53], v[52:53], v[132:133] op_sel_hi:[1,0]
v_cvt_pk_bf16_f32 v193, v50, v51
v_pk_mul_f32 v[54:55], v[54:55], v[132:133] op_sel_hi:[1,0]
v_cvt_pk_bf16_f32 v194, v52, v53
v_pk_mul_f32 v[56:57], v[56:57], v[132:133] op_sel_hi:[1,0]
v_cvt_pk_bf16_f32 v195, v54, v55
v_pk_mul_f32 v[58:59], v[58:59], v[132:133] op_sel_hi:[1,0]
v_cvt_pk_bf16_f32 v196, v56, v57
v_pk_mul_f32 v[60:61], v[60:61], v[132:133] op_sel_hi:[1,0]
v_cvt_pk_bf16_f32 v197, v58, v59
v_pk_mul_f32 v[62:63], v[62:63], v[132:133] op_sel_hi:[1,0]
v_cvt_pk_bf16_f32 v198, v60, v61
v_pk_mul_f32 v[64:65], v[64:65], v[132:133] op_sel_hi:[1,0]
v_cvt_pk_bf16_f32 v199, v62, v63
v_pk_mul_f32 v[66:67], v[66:67], v[132:133] op_sel_hi:[1,0]
v_cvt_pk_bf16_f32 v200, v64, v65
v_cvt_pk_bf16_f32 v201, v66, v67
v_pk_mul_f32 v[88:89], v[88:89], v[134:135] op_sel_hi:[1,0]
v_pk_mul_f32 v[90:91], v[90:91], v[134:135] op_sel_hi:[1,0]
v_cvt_pk_bf16_f32 v202, v88, v89
v_pk_mul_f32 v[92:93], v[92:93], v[134:135] op_sel_hi:[1,0]
v_cvt_pk_bf16_f32 v203, v90, v91
v_pk_mul_f32 v[94:95], v[94:95], v[134:135] op_sel_hi:[1,0]
v_cvt_pk_bf16_f32 v204, v92, v93
v_pk_mul_f32 v[96:97], v[96:97], v[134:135] op_sel_hi:[1,0]
v_cvt_pk_bf16_f32 v205, v94, v95
v_pk_mul_f32 v[98:99], v[98:99], v[134:135] op_sel_hi:[1,0]
v_cvt_pk_bf16_f32 v206, v96, v97
v_pk_mul_f32 v[100:101], v[100:101], v[134:135] op_sel_hi:[1,0]
v_cvt_pk_bf16_f32 v207, v98, v99
v_pk_mul_f32 v[102:103], v[102:103], v[134:135] op_sel_hi:[1,0]
v_cvt_pk_bf16_f32 v208, v100, v101
v_pk_mul_f32 v[104:105], v[104:105], v[134:135] op_sel_hi:[1,0]
v_cvt_pk_bf16_f32 v209, v102, v103
v_pk_mul_f32 v[106:107], v[106:107], v[134:135] op_sel_hi:[1,0]
v_cvt_pk_bf16_f32 v210, v104, v105
v_cvt_pk_bf16_f32 v211, v106, v107
v_max3_f32 v128, v108, v109, v110
v_min3_f32 v130, v108, v109, v110
v_max3_f32 v128, v128, v111, v112
v_min3_f32 v130, v130, v111, v112
v_max3_f32 v128, v128, v113, v114
v_min3_f32 v130, v130, v113, v114
v_max3_f32 v128, v128, v115, v116
v_min3_f32 v130, v130, v115, v116
v_max3_f32 v128, v128, v117, v118
v_min3_f32 v130, v130, v117, v118
v_max3_f32 v128, v128, v119, v120
v_min3_f32 v130, v130, v119, v120
v_max3_f32 v128, v128, v121, v122
v_min3_f32 v130, v130, v121, v122
v_max3_f32 v128, v128, v123, v124
v_min3_f32 v130, v130, v123, v124
v_max3_f32 v128, v128, v125, v126
v_min3_f32 v130, v130, v125, v126
v_max_f32 v128, v128, v127
v_min_f32 v130, v130, v127
v_mul_f32 v128, s10, v128
v_mul_f32 v130, s10, v130
v_pk_fma_f32 v[48:49], v[108:109], s[10:11], v[128:129] op_sel_hi:[1,1,0] neg_lo:[0,0,1] neg_hi:[0,0,1]
v_pk_fma_f32 v[108:109], v[108:109], s[10:11], v[130:131] op_sel_hi:[1,1,0] neg_lo:[1,0,0] neg_hi:[1,0,0]
v_pk_fma_f32 v[50:51], v[110:111], s[10:11], v[128:129] op_sel_hi:[1,1,0] neg_lo:[0,0,1] neg_hi:[0,0,1]
v_pk_fma_f32 v[110:111], v[110:111], s[10:11], v[130:131] op_sel_hi:[1,1,0] neg_lo:[1,0,0] neg_hi:[1,0,0]
v_pk_fma_f32 v[52:53], v[112:113], s[10:11], v[128:129] op_sel_hi:[1,1,0] neg_lo:[0,0,1] neg_hi:[0,0,1]
v_pk_fma_f32 v[112:113], v[112:113], s[10:11], v[130:131] op_sel_hi:[1,1,0] neg_lo:[1,0,0] neg_hi:[1,0,0]
v_pk_fma_f32 v[54:55], v[114:115], s[10:11], v[128:129] op_sel_hi:[1,1,0] neg_lo:[0,0,1] neg_hi:[0,0,1]
v_pk_fma_f32 v[114:115], v[114:115], s[10:11], v[130:131] op_sel_hi:[1,1,0] neg_lo:[1,0,0] neg_hi:[1,0,0]
v_pk_fma_f32 v[56:57], v[116:117], s[10:11], v[128:129] op_sel_hi:[1,1,0] neg_lo:[0,0,1] neg_hi:[0,0,1]
v_pk_fma_f32 v[116:117], v[116:117], s[10:11], v[130:131] op_sel_hi:[1,1,0] neg_lo:[1,0,0] neg_hi:[1,0,0]
v_pk_fma_f32 v[58:59], v[118:119], s[10:11], v[128:129] op_sel_hi:[1,1,0] neg_lo:[0,0,1] neg_hi:[0,0,1]
v_pk_fma_f32 v[118:119], v[118:119], s[10:11], v[130:131] op_sel_hi:[1,1,0] neg_lo:[1,0,0] neg_hi:[1,0,0]
v_pk_fma_f32 v[60:61], v[120:121], s[10:11], v[128:129] op_sel_hi:[1,1,0] neg_lo:[0,0,1] neg_hi:[0,0,1]
v_pk_fma_f32 v[120:121], v[120:121], s[10:11], v[130:131] op_sel_hi:[1,1,0] neg_lo:[1,0,0] neg_hi:[1,0,0]
v_pk_fma_f32 v[62:63], v[122:123], s[10:11], v[128:129] op_sel_hi:[1,1,0] neg_lo:[0,0,1] neg_hi:[0,0,1]
v_pk_fma_f32 v[122:123], v[122:123], s[10:11], v[130:131] op_sel_hi:[1,1,0] neg_lo:[1,0,0] neg_hi:[1,0,0]
v_pk_fma_f32 v[64:65], v[124:125], s[10:11], v[128:129] op_sel_hi:[1,1,0] neg_lo:[0,0,1] neg_hi:[0,0,1]
v_pk_fma_f32 v[124:125], v[124:125], s[10:11], v[130:131] op_sel_hi:[1,1,0] neg_lo:[1,0,0] neg_hi:[1,0,0]
v_pk_fma_f32 v[66:67], v[126:127], s[10:11], v[128:129] op_sel_hi:[1,1,0] neg_lo:[0,0,1] neg_hi:[0,0,1]
v_pk_fma_f32 v[126:127], v[126:127], s[10:11], v[130:131] op_sel_hi:[1,1,0] neg_lo:[1,0,0] neg_hi:[1,0,0]
v_exp_f32 v48, v48
v_exp_f32 v108, v108
v_exp_f32 v49, v49
v_exp_f32 v109, v109
v_exp_f32 v50, v50
v_exp_f32 v110, v110
v_exp_f32 v51, v51
v_exp_f32 v111, v111
v_exp_f32 v52, v52
v_exp_f32 v112, v112
v_exp_f32 v53, v53
v_exp_f32 v113, v113
v_exp_f32 v54, v54
v_exp_f32 v114, v114
v_exp_f32 v55, v55
v_exp_f32 v115, v115
v_exp_f32 v56, v56
v_exp_f32 v116, v116
v_exp_f32 v57, v57
v_exp_f32 v117, v117
v_exp_f32 v58, v58
v_exp_f32 v118, v118
v_exp_f32 v59, v59
v_exp_f32 v119, v119
v_exp_f32 v60, v60
v_exp_f32 v120, v120
v_exp_f32 v61, v61
v_exp_f32 v121, v121
v_exp_f32 v62, v62
v_exp_f32 v122, v122
v_exp_f32 v63, v63
v_exp_f32 v123, v123
v_exp_f32 v64, v64
v_exp_f32 v124, v124
v_exp_f32 v65, v65
v_exp_f32 v125, v125
v_exp_f32 v66, v66
v_exp_f32 v126, v126
v_exp_f32 v67, v67
v_exp_f32 v127, v127
v_pk_add_f32 v[132:133], v[48:49], v[50:51]
v_pk_add_f32 v[134:135], v[108:109], v[110:111]
v_pk_add_f32 v[132:133], v[132:133], v[52:53]
v_pk_add_f32 v[134:135], v[134:135], v[112:113]
v_pk_add_f32 v[132:133], v[132:133], v[54:55]
v_pk_add_f32 v[134:135], v[134:135], v[114:115]
v_pk_add_f32 v[132:133], v[132:133], v[56:57]
v_pk_add_f32 v[134:135], v[134:135], v[116:117]
v_pk_add_f32 v[132:133], v[132:133], v[58:59]
v_pk_add_f32 v[134:135], v[134:135], v[118:119]
v_pk_add_f32 v[132:133], v[132:133], v[60:61]
v_pk_add_f32 v[134:135], v[134:135], v[120:121]
v_pk_add_f32 v[132:133], v[132:133], v[62:63]
v_pk_add_f32 v[134:135], v[134:135], v[122:123]
v_pk_add_f32 v[132:133], v[132:133], v[64:65]
v_pk_add_f32 v[134:135], v[134:135], v[124:125]
v_pk_add_f32 v[132:133], v[132:133], v[66:67]
v_pk_add_f32 v[134:135], v[134:135], v[126:127]
v_add_f32 v132, v132, v133
v_add_f32 v134, v134, v135
v_rcp_f32 v132, v132
v_rcp_f32 v134, v134
v_pk_mul_f32 v[48:49], v[48:49], v[132:133] op_sel_hi:[1,0]
v_pk_mul_f32 v[50:51], v[50:51], v[132:133] op_sel_hi:[1,0]
v_cvt_pk_bf16_f32 v212, v48, v49
v_pk_mul_f32 v[52:53], v[52:53], v[132:133] op_sel_hi:[1,0]
v_cvt_pk_bf16_f32 v213, v50, v51
v_pk_mul_f32 v[54:55], v[54:55], v[132:133] op_sel_hi:[1,0]
v_cvt_pk_bf16_f32 v214, v52, v53
v_pk_mul_f32 v[56:57], v[56:57], v[132:133] op_sel_hi:[1,0]
v_cvt_pk_bf16_f32 v215, v54, v55
v_pk_mul_f32 v[58:59], v[58:59], v[132:133] op_sel_hi:[1,0]
v_cvt_pk_bf16_f32 v216, v56, v57
v_pk_mul_f32 v[60:61], v[60:61], v[132:133] op_sel_hi:[1,0]
v_cvt_pk_bf16_f32 v217, v58, v59
v_pk_mul_f32 v[62:63], v[62:63], v[132:133] op_sel_hi:[1,0]
v_cvt_pk_bf16_f32 v218, v60, v61
v_pk_mul_f32 v[64:65], v[64:65], v[132:133] op_sel_hi:[1,0]
v_cvt_pk_bf16_f32 v219, v62, v63
v_pk_mul_f32 v[66:67], v[66:67], v[132:133] op_sel_hi:[1,0]
v_cvt_pk_bf16_f32 v220, v64, v65
v_cvt_pk_bf16_f32 v221, v66, v67
v_pk_mul_f32 v[108:109], v[108:109], v[134:135] op_sel_hi:[1,0]
v_pk_mul_f32 v[110:111], v[110:111], v[134:135] op_sel_hi:[1,0]
v_cvt_pk_bf16_f32 v222, v108, v109
v_pk_mul_f32 v[112:113], v[112:113], v[134:135] op_sel_hi:[1,0]
v_cvt_pk_bf16_f32 v223, v110, v111
v_pk_mul_f32 v[114:115], v[114:115], v[134:135] op_sel_hi:[1,0]
v_cvt_pk_bf16_f32 v224, v112, v113
v_pk_mul_f32 v[116:117], v[116:117], v[134:135] op_sel_hi:[1,0]
v_cvt_pk_bf16_f32 v225, v114, v115
v_pk_mul_f32 v[118:119], v[118:119], v[134:135] op_sel_hi:[1,0]
v_cvt_pk_bf16_f32 v226, v116, v117
v_pk_mul_f32 v[120:121], v[120:121], v[134:135] op_sel_hi:[1,0]
v_cvt_pk_bf16_f32 v227, v118, v119
v_pk_mul_f32 v[122:123], v[122:123], v[134:135] op_sel_hi:[1,0]
v_cvt_pk_bf16_f32 v228, v120, v121
v_pk_mul_f32 v[124:125], v[124:125], v[134:135] op_sel_hi:[1,0]
v_cvt_pk_bf16_f32 v229, v122, v123
v_pk_mul_f32 v[126:127], v[126:127], v[134:135] op_sel_hi:[1,0]
v_cvt_pk_bf16_f32 v230, v124, v125
v_cvt_pk_bf16_f32 v231, v126, v127
s_lshl_b32 s76, s61, 2
s_add_u32 s76, s76, s65
s_lshl_b32 s76, s76, 11
s_add_u32 s4, s76, 14680064
s_mul_i32 s76, s65, 2080
s_add_u32 m0, s76, 133440
s_lshl_b32 s76, s15, 3
s_add_u32 s76, s76, s61
s_mul_i32 s76, s76, 10240
s_add_u32 s76, s76, 7340032
s_and_b32 s77, s65, 1
s_lshl_b32 s5, s77, 11
s_add_u32 s5, s5, s76
s_lshl_b32 s6, s77, 10
s_add_u32 s6, s6, s76
s_add_u32 s6, s6, 8192
s_add_u32 s7, s5, 4096
s_lshl_b32 s76, s60, 7
s_add_u32 s74, s74, s76
s_addc_u32 s75, s75, 0
s_mov_b32 s79, 0
L_sp_38:
s_load_dword s34, s[74:75], 0 glc
s_waitcnt lgkmcnt(0)
s_cmp_ge_u32 s34, 16
s_cbranch_scc1 L_spd_40
s_add_u32 s79, s79, 1
s_cmp_ge_u32 s79, 0x200000
s_cbranch_scc1 L_end
s_branch L_sp_38
L_spd_40:
s_setprio 3
buffer_load_dwordx4 v243, s[48:51], s4 offen offset:0 sc1 lds
buffer_load_dwordx4 v243, s[48:51], s4 offen offset:1024 sc1 lds
buffer_load_dword v62, v241, s[48:51], s3 offen offset:0 sc1
buffer_load_dword v63, v241, s[48:51], s3 offen offset:64 sc1
s_waitcnt vmcnt(2)
s_waitcnt lgkmcnt(0)
s_mov_b64 exec, 1
v_mov_b32 v136, 133124
v_mov_b32 v137, 1
ds_add_u32 v136, v137
s_mov_b32 s79, 0
L_ls_41:
ds_read_b32 v137, v136
s_waitcnt lgkmcnt(0)
v_readfirstlane_b32 s78, v137
s_add_u32 s79, s79, 1
s_cmp_ge_u32 s79, 0x1000000
s_cbranch_scc1 L_end
s_cmp_lt_u32 s78, 4
s_cbranch_scc1 L_ls_41
s_mov_b64 exec, -1
ds_read_b64 v[64:65], v239 offset:160
ds_read_b64 v[66:67], v239 offset:352
ds_read_b64 v[68:69], v239 offset:544
ds_read_b64 v[70:71], v239 offset:736
ds_read_b64 v[72:73], v239 offset:928
ds_read_b64 v[74:75], v239 offset:1120
ds_read_b64 v[76:77], v239 offset:1312
ds_read_b64 v[78:79], v239 offset:1504
ds_read_b64 v[80:81], v239 offset:1696
ds_read_b64 v[82:83], v239 offset:1888
ds_read_b64 v[84:85], v240 offset:0
ds_read_b64 v[86:87], v240 offset:192
ds_read_b64 v[88:89], v240 offset:384
ds_read_b64 v[90:91], v240 offset:576
s_waitcnt lgkmcnt(4)
v_mfma_f32_16x16x32_bf16 v[48:51], v[64:67], v[192:195], 0
ds_read_b64 v[92:93], v240 offset:768
ds_read_b64 v[94:95], v240 offset:960
v_mfma_f32_16x16x32_bf16 v[52:55], v[64:67], v[212:215], 0
ds_read_b64 v[96:97], v240 offset:1152
ds_read_b64 v[98:99], v240 offset:1344
v_mfma_f32_16x16x32_bf16 v[48:51], v[68:71], v[196:199], v[48:51]
ds_read_b64 v[100:101], v240 offset:1536
ds_read_b64 v[102:103], v240 offset:1728
v_mfma_f32_16x16x32_bf16 v[52:55], v[68:71], v[216:219], v[52:55]
ds_read_b64 v[104:105], v240 offset:32
ds_read_b64 v[106:107], v240 offset:224
v_mfma_f32_16x16x32_bf16 v[48:51], v[72:75], v[200:203], v[48:51]
ds_read_b64 v[108:109], v240 offset:416
ds_read_b64 v[110:111], v240 offset:608
v_mfma_f32_16x16x32_bf16 v[52:55], v[72:75], v[220:223], v[52:55]
v_mfma_f32_16x16x32_bf16 v[48:51], v[76:79], v[204:207], v[48:51]
v_mfma_f32_16x16x32_bf16 v[52:55], v[76:79], v[224:227], v[52:55]
v_mfma_f32_16x16x32_bf16 v[48:51], v[80:83], v[208:211], v[48:51]
v_mfma_f32_16x16x32_bf16 v[52:55], v[80:83], v[228:231], v[52:55]
s_waitcnt lgkmcnt(4)
v_mfma_f32_16x16x32_bf16 v[8:11], v[84:87], v[192:195], 0
ds_read_b64 v[112:113], v240 offset:800
ds_read_b64 v[114:115], v240 offset:992
v_mfma_f32_16x16x32_bf16 v[12:15], v[84:87], v[212:215], 0
ds_read_b64 v[116:117], v240 offset:1184
ds_read_b64 v[118:119], v240 offset:1376
v_mfma_f32_16x16x32_bf16 v[8:11], v[88:91], v[196:199], v[8:11]
ds_read_b64 v[120:121], v240 offset:1568
ds_read_b64 v[122:123], v240 offset:1760
v_mfma_f32_16x16x32_bf16 v[12:15], v[88:91], v[216:219], v[12:15]
ds_read_b64 v[124:125], v240 offset:64
ds_read_b64 v[126:127], v240 offset:256
v_mfma_f32_16x16x32_bf16 v[8:11], v[92:95], v[200:203], v[8:11]
ds_read_b64 v[128:129], v240 offset:448
ds_read_b64 v[130:131], v240 offset:640
v_mfma_f32_16x16x32_bf16 v[12:15], v[92:95], v[220:223], v[12:15]
v_mfma_f32_16x16x32_bf16 v[8:11], v[96:99], v[204:207], v[8:11]
v_mfma_f32_16x16x32_bf16 v[12:15], v[96:99], v[224:227], v[12:15]
v_mfma_f32_16x16x32_bf16 v[8:11], v[100:103], v[208:211], v[8:11]
v_mfma_f32_16x16x32_bf16 v[12:15], v[100:103], v[228:231], v[12:15]
s_waitcnt lgkmcnt(4)
v_mfma_f32_16x16x32_bf16 v[16:19], v[104:107], v[192:195], 0
ds_read_b64 v[132:133], v240 offset:832
ds_read_b64 v[134:135], v240 offset:1024
v_mfma_f32_16x16x32_bf16 v[20:23], v[104:107], v[212:215], 0
ds_read_b64 v[136:137], v240 offset:1216
ds_read_b64 v[138:139], v240 offset:1408
v_mfma_f32_16x16x32_bf16 v[16:19], v[108:111], v[196:199], v[16:19]
ds_read_b64 v[140:141], v240 offset:1600
ds_read_b64 v[142:143], v240 offset:1792
v_mfma_f32_16x16x32_bf16 v[20:23], v[108:111], v[216:219], v[20:23]
ds_read_b64 v[144:145], v240 offset:96
ds_read_b64 v[146:147], v240 offset:288
v_mfma_f32_16x16x32_bf16 v[16:19], v[112:115], v[200:203], v[16:19]
ds_read_b64 v[148:149], v240 offset:480
ds_read_b64 v[150:151], v240 offset:672
v_mfma_f32_16x16x32_bf16 v[20:23], v[112:115], v[220:223], v[20:23]
s_waitcnt vmcnt(0)
v_add_f32 v56, 897988541, v48
v_mfma_f32_16x16x32_bf16 v[16:19], v[116:119], v[204:207], v[16:19]
v_add_f32 v58, 897988541, v52
v_rcp_f32 v56, v56
v_mfma_f32_16x16x32_bf16 v[20:23], v[116:119], v[224:227], v[20:23]
v_rcp_f32 v58, v58
v_mul_f32 v56, v56, v62
v_mfma_f32_16x16x32_bf16 v[16:19], v[120:123], v[208:211], v[16:19]
v_mul_f32 v58, v58, v63
v_mfma_f32_16x16x32_bf16 v[20:23], v[120:123], v[228:231], v[20:23]
s_waitcnt lgkmcnt(4)
v_mfma_f32_16x16x32_bf16 v[24:27], v[124:127], v[192:195], 0
ds_read_b64 v[152:153], v240 offset:864
ds_read_b64 v[154:155], v240 offset:1056
v_mfma_f32_16x16x32_bf16 v[28:31], v[124:127], v[212:215], 0
ds_read_b64 v[156:157], v240 offset:1248
ds_read_b64 v[158:159], v240 offset:1440
v_mfma_f32_16x16x32_bf16 v[24:27], v[128:131], v[196:199], v[24:27]
ds_read_b64 v[160:161], v240 offset:1632
ds_read_b64 v[162:163], v240 offset:1824
v_mfma_f32_16x16x32_bf16 v[28:31], v[128:131], v[216:219], v[28:31]
ds_read_b64 v[164:165], v240 offset:128
ds_read_b64 v[166:167], v240 offset:320
v_mfma_f32_16x16x32_bf16 v[24:27], v[132:135], v[200:203], v[24:27]
ds_read_b64 v[168:169], v240 offset:512
ds_read_b64 v[170:171], v240 offset:704
v_mfma_f32_16x16x32_bf16 v[28:31], v[132:135], v[220:223], v[28:31]
v_mfma_f32_16x16x32_bf16 v[24:27], v[136:139], v[204:207], v[24:27]
v_mfma_f32_16x16x32_bf16 v[28:31], v[136:139], v[224:227], v[28:31]
v_mfma_f32_16x16x32_bf16 v[24:27], v[140:143], v[208:211], v[24:27]
v_mfma_f32_16x16x32_bf16 v[28:31], v[140:143], v[228:231], v[28:31]
s_waitcnt lgkmcnt(4)
v_mfma_f32_16x16x32_bf16 v[32:35], v[144:147], v[192:195], 0
ds_read_b64 v[172:173], v240 offset:896
ds_read_b64 v[174:175], v240 offset:1088
v_mfma_f32_16x16x32_bf16 v[36:39], v[144:147], v[212:215], 0
ds_read_b64 v[176:177], v240 offset:1280
ds_read_b64 v[178:179], v240 offset:1472
v_mfma_f32_16x16x32_bf16 v[32:35], v[148:151], v[196:199], v[32:35]
ds_read_b64 v[180:181], v240 offset:1664
ds_read_b64 v[182:183], v240 offset:1856
v_mfma_f32_16x16x32_bf16 v[36:39], v[148:151], v[216:219], v[36:39]
v_mul_f32 v8, v56, v8
v_mul_f32 v9, v56, v9
v_mfma_f32_16x16x32_bf16 v[32:35], v[152:155], v[200:203], v[32:35]
v_mul_f32 v10, v56, v10
v_mul_f32 v11, v56, v11
v_mfma_f32_16x16x32_bf16 v[36:39], v[152:155], v[220:223], v[36:39]
v_cvt_pk_bf16_f32 v184, v8, v9
v_cvt_pk_bf16_f32 v185, v10, v11
v_mfma_f32_16x16x32_bf16 v[32:35], v[156:159], v[204:207], v[32:35]
v_mul_f32 v12, v58, v12
v_mul_f32 v13, v58, v13
v_mfma_f32_16x16x32_bf16 v[36:39], v[156:159], v[224:227], v[36:39]
v_mul_f32 v14, v58, v14
v_mul_f32 v15, v58, v15
v_mfma_f32_16x16x32_bf16 v[32:35], v[160:163], v[208:211], v[32:35]
v_cvt_pk_bf16_f32 v188, v12, v13
v_cvt_pk_bf16_f32 v189, v14, v15
v_mfma_f32_16x16x32_bf16 v[36:39], v[160:163], v[228:231], v[36:39]
v_mul_f32 v16, v56, v16
v_mul_f32 v17, v56, v17
v_mul_f32 v18, v56, v18
v_mul_f32 v19, v56, v19
v_cvt_pk_bf16_f32 v186, v16, v17
v_cvt_pk_bf16_f32 v187, v18, v19
v_mul_f32 v20, v58, v20
v_mul_f32 v21, v58, v21
v_mul_f32 v22, v58, v22
v_mul_f32 v23, v58, v23
v_cvt_pk_bf16_f32 v190, v20, v21
v_cvt_pk_bf16_f32 v191, v22, v23
buffer_store_dwordx4 v[184:187], v243, s[48:51], s5 offen offset:0 sc1
buffer_store_dwordx4 v[188:191], v243, s[48:51], s5 offen offset:1024 sc1
s_waitcnt lgkmcnt(0)
v_mfma_f32_16x16x32_bf16 v[40:43], v[164:167], v[192:195], 0
v_mul_f32 v24, v56, v24
v_mul_f32 v25, v56, v25
v_mfma_f32_16x16x32_bf16 v[44:47], v[164:167], v[212:215], 0
v_mul_f32 v26, v56, v26
v_mul_f32 v27, v56, v27
v_mfma_f32_16x16x32_bf16 v[40:43], v[168:171], v[196:199], v[40:43]
v_cvt_pk_bf16_f32 v244, v24, v25
v_cvt_pk_bf16_f32 v245, v26, v27
v_mfma_f32_16x16x32_bf16 v[44:47], v[168:171], v[216:219], v[44:47]
v_mul_f32 v28, v58, v28
v_mul_f32 v29, v58, v29
v_mfma_f32_16x16x32_bf16 v[40:43], v[172:175], v[200:203], v[40:43]
v_mul_f32 v30, v58, v30
v_mul_f32 v31, v58, v31
v_mfma_f32_16x16x32_bf16 v[44:47], v[172:175], v[220:223], v[44:47]
v_cvt_pk_bf16_f32 v248, v28, v29
v_cvt_pk_bf16_f32 v249, v30, v31
v_mfma_f32_16x16x32_bf16 v[40:43], v[176:179], v[204:207], v[40:43]
v_mfma_f32_16x16x32_bf16 v[44:47], v[176:179], v[224:227], v[44:47]
v_mfma_f32_16x16x32_bf16 v[40:43], v[180:183], v[208:211], v[40:43]
v_mfma_f32_16x16x32_bf16 v[44:47], v[180:183], v[228:231], v[44:47]
v_pk_mul_f32 v[32:33], v[32:33], v[56:57] op_sel_hi:[1,0]
v_pk_mul_f32 v[34:35], v[34:35], v[56:57] op_sel_hi:[1,0]
v_cvt_pk_bf16_f32 v246, v32, v33
v_cvt_pk_bf16_f32 v247, v34, v35
v_pk_mul_f32 v[36:37], v[36:37], v[58:59] op_sel_hi:[1,0]
v_pk_mul_f32 v[38:39], v[38:39], v[58:59] op_sel_hi:[1,0]
v_cvt_pk_bf16_f32 v250, v36, v37
v_cvt_pk_bf16_f32 v251, v38, v39
buffer_store_dwordx4 v[244:247], v243, s[48:51], s7 offen offset:0 sc1
buffer_store_dwordx4 v[248:251], v243, s[48:51], s7 offen offset:1024 sc1
v_pk_mul_f32 v[40:41], v[40:41], v[56:57] op_sel_hi:[1,0]
v_pk_mul_f32 v[42:43], v[42:43], v[56:57] op_sel_hi:[1,0]
v_cvt_pk_bf16_f32 v252, v40, v41
v_cvt_pk_bf16_f32 v253, v42, v43
v_pk_mul_f32 v[44:45], v[44:45], v[58:59] op_sel_hi:[1,0]
v_pk_mul_f32 v[46:47], v[46:47], v[58:59] op_sel_hi:[1,0]
v_cvt_pk_bf16_f32 v254, v44, v45
v_cvt_pk_bf16_f32 v255, v46, v47
buffer_store_dwordx4 v[252:255], v243, s[48:51], s6 offen sc1
s_waitcnt lgkmcnt(0)
s_mul_i32 s20, s65, 2048
s_add_u32 s20, s20, s72
s_addc_u32 s21, s73, 0
s_mov_b32 s16, 1
s_mov_b32 s17, 1
s_mov_b32 s18, 1
s_mov_b32 s19, 1
s_waitcnt vmcnt(0)
s_waitcnt lgkmcnt(0)
s_mov_b64 exec, 1
v_mov_b32 v136, 133128
v_mov_b32 v137, 1
ds_add_u32 v136, v137
s_mov_b32 s79, 0
L_ls_42:
ds_read_b32 v137, v136
s_waitcnt lgkmcnt(0)
v_readfirstlane_b32 s78, v137
s_add_u32 s79, s79, 1
s_cmp_ge_u32 s79, 0x1000000
s_cbranch_scc1 L_end
s_cmp_lt_u32 s78, 4
s_cbranch_scc1 L_ls_42
s_mov_b64 exec, -1
s_atomic_add s16, s[20:21], 8 glc
s_atomic_add s17, s[20:21], 520 glc
s_atomic_add s18, s[20:21], 1032 glc
s_atomic_add s19, s[20:21], 1544 glc
L_end:
s_endpgm
.section .rodata,"a"
.p2align 6
.amdhsa_kernel gated_mix__linear_kernel_hedgehog__dense_activation_gelu__prompt_kernel
  .amdhsa_next_free_vgpr 256
  .amdhsa_next_free_sgpr 102
  .amdhsa_accum_offset 256
  .amdhsa_group_segment_fixed_size 0
  .amdhsa_kernarg_size 104
  .amdhsa_user_sgpr_count 2
  .amdhsa_user_sgpr_kernarg_segment_ptr 1
  .amdhsa_system_sgpr_workgroup_id_x 1
.end_amdhsa_kernel
```
